```python
import torch

def _softmax(x, axis=-1):
    return torch.softmax(x, dim=axis)
def _gelu(x):
    return torch.nn.functional.gelu(x, approximate="tanh")
def _silu(x):
    return torch.nn.functional.silu(x)
def _sigmoid(x):
    return torch.sigmoid(x)
def _layernorm(x, axis=-1, eps=1e-5):
    m = x.mean(dim=axis, keepdim=True)
    v = x.var(dim=axis, keepdim=True, unbiased=False)
    return (x - m) / torch.sqrt(v + eps)
def _scatter_add(tgt, idx, src, axis=0):
    return tgt.clone().index_add_(axis, idx, src)
def _segment_sum(src, seg, n):
    out = torch.zeros((n,) + src.shape[1:], dtype=src.dtype)
    return out.index_add_(0, seg, src)
def _pad(x, pw):
    flat = tuple(v for pair in reversed(pw) for v in pair)
    return torch.nn.functional.pad(x, flat)

kernel_name = 'concat_heads__gqa_block_cached__mha_block_cached__near_ridge'

def setup_inputs():

    _w = (lambda a: (lambda t: t.to(torch.bfloat16) if t.is_floating_point() else t)(torch.as_tensor(a)))
    def _A_setup():
        B, Sq, D = 8, 288, 640
        Hq, Hkv, Sk, Dh = 32, 32, 1024, 128
        assert Hq % Hkv == 0, (Hq, Hkv)
        return {
            "x": _w((lambda *s: torch.randn(*s, dtype=torch.bfloat16) * 0.8)(B, Sq, D)),
            "k_cache": _w((lambda *s: torch.randn(*s, dtype=torch.bfloat16) * 0.8)(B, Hkv, Sk, Dh)),
            "v_cache": _w((lambda *s: torch.randn(*s, dtype=torch.bfloat16) * 0.05)(B, Hkv, Sk, Dh)),
            "wq": _w((lambda *s: torch.randn(*s, dtype=torch.bfloat16) * 0.8)(D, Hq * Dh) * (D ** -0.5)),
            "wo": _w((lambda *s: torch.randn(*s, dtype=torch.bfloat16) * 0.05)(Hq * Dh, D) * ((Hq * Dh) ** -0.5)),
        }
    _A_in = _A_setup()

    def _B_setup():
        B, Sq, D = 8, 288, 640
        H, Sk, Dh = 32, 1024, 128
        return {
            "x": _w((lambda *s: torch.randn(*s, dtype=torch.bfloat16) * 0.8)(B, Sq, D)),
            "k_cache": _w((lambda *s: torch.randn(*s, dtype=torch.bfloat16) * 0.8)(B, H, Sk, Dh)),
            "v_cache": _w((lambda *s: torch.randn(*s, dtype=torch.bfloat16) * 0.05)(B, H, Sk, Dh)),
            "wq": _w((lambda *s: torch.randn(*s, dtype=torch.bfloat16) * 0.8)(D, H * Dh) * (D ** -0.5)),
            "wo": _w((lambda *s: torch.randn(*s, dtype=torch.bfloat16) * 0.05)(H * Dh, D) * ((H * Dh) ** -0.5)),
        }
    _B_in = _B_setup()

    return {
        "A_x": _A_in["x"],
        "A_k_cache": _A_in["k_cache"],
        "A_v_cache": _A_in["v_cache"],
        "A_wq": _A_in["wq"],
        "A_wo": _A_in["wo"],
        "B_x": _B_in["x"],
        "B_k_cache": _B_in["k_cache"],
        "B_v_cache": _B_in["v_cache"],
        "B_wq": _B_in["wq"],
        "B_wo": _B_in["wo"],
    }

def reference(A_x, A_k_cache, A_v_cache, A_wq, A_wo, B_x, B_k_cache, B_v_cache, B_wq, B_wo):
    def _A_ref(x, k_cache, v_cache, wq, wo):
        B, Sq, D = x.shape
        Hq, Dh = 32, 128
        Hkv = k_cache.shape[1]
        rep = Hq // Hkv
        q = (lambda x, *d: x.permute(*d))((x @ wq).reshape(B, Sq, Hq, Dh), 0, 2, 1, 3)
        k = (lambda x, n, axis: torch.repeat_interleave(x, n, dim=axis))(k_cache, rep, axis=1)
        v = (lambda x, n, axis: torch.repeat_interleave(x, n, dim=axis))(v_cache, rep, axis=1)
        scores = torch.einsum("bhqd,bhkd->bhqk", q, k) * (Dh ** -0.5)
        p = _softmax(scores, axis=-1)
        o = torch.einsum("bhqk,bhkd->bhqd", p, v)
        return (lambda x, *d: x.permute(*d))(o, 0, 2, 1, 3).reshape(B, Sq, Hq * Dh) @ wo

    def _B_ref(x, k_cache, v_cache, wq, wo):
        B, Sq, D = x.shape
        H, Dh = 32, 128
        q = (lambda x, *d: x.permute(*d))((x @ wq).reshape(B, Sq, H, Dh), 0, 2, 1, 3)
        scores = torch.einsum("bhqd,bhkd->bhqk", q, k_cache) * (Dh ** -0.5)
        p = _softmax(scores, axis=-1)
        o = torch.einsum("bhqk,bhkd->bhqd", p, v_cache)
        return (lambda x, *d: x.permute(*d))(o, 0, 2, 1, 3).reshape(B, Sq, H * Dh) @ wo

    a = _A_ref(A_x, A_k_cache, A_v_cache, A_wq, A_wo)
    b = _B_ref(B_x, B_k_cache, B_v_cache, B_wq, B_wo)
    return torch.concatenate([a, b], axis=-1)
```

```asm
; @launch kernel=attn_kernel grid=(256,1,1) block=(256,1,1) lds=163840
; @launch kernel=oproj_kernel grid=(256,1,1) block=(256,1,1) lds=147456
.amdgcn_target "amdgcn-amd-amdhsa--gfx950"
.text
.p2align 8
.globl attn_kernel
.type attn_kernel,@function
attn_kernel:
  s_cmp_ge_u32 s2, 256
  s_cbranch_scc1 K1_DONE
  s_load_dwordx16 s[64:79], s[0:1], 0
  s_load_dwordx8 s[80:87], s[0:1], 64
  s_load_dwordx2 s[88:89], s[0:1], 96
  v_lshrrev_b32 v1, 6, v0
  v_and_b32 v2, 63, v0
  v_readfirstlane_b32 s32, v1
  v_and_b32 v3, 15, v2
  v_lshrrev_b32 v4, 4, v2
  v_lshrrev_b32 v5, 2, v3
  v_and_b32 v6, 3, v2
  v_lshlrev_b32 v7, 4, v2
  s_and_b32 s33, s32, 1
  s_and_b32 s37, s2, 7
  s_lshr_b32 s38, s2, 3
  s_lshr_b32 s34, s37, 2
  s_and_b32 s39, s37, 2
  s_lshl_b32 s39, s39, 1
  s_and_b32 s40, s38, 3
  s_add_u32 s35, s39, s40
  s_and_b32 s39, s37, 1
  s_lshl_b32 s39, s39, 3
  s_lshr_b32 s40, s38, 2
  s_add_u32 s36, s39, s40
  s_lshl_b32 s43, s32, 12
  v_lshrrev_b32 v11, 3, v2
  v_and_b32 v12, 7, v2
  v_lshrrev_b32 v13, 1, v11
  s_movk_i32 s37, 1280
  v_mul_lo_u32 v11, v11, s37
  s_mul_i32 s37, s32, 92160
  s_add_u32 s38, s33, 0
  s_and_b32 s38, s38, 1
  s_lshl_b32 s38, s38, 2
  v_or_b32 v14, s38, v13
  v_xor_b32 v14, v14, v12
  v_lshlrev_b32 v14, 4, v14
  v_add_u32 v14, v14, v11
  s_add_u32 s38, s37, 0
  v_add_u32 v40, s38, v14
  s_add_u32 s38, s33, 1
  s_and_b32 s38, s38, 1
  s_lshl_b32 s38, s38, 2
  v_or_b32 v14, s38, v13
  v_xor_b32 v14, v14, v12
  v_lshlrev_b32 v14, 4, v14
  v_add_u32 v14, v14, v11
  s_add_u32 s38, s37, 9216
  v_add_u32 v41, s38, v14
  s_add_u32 s38, s33, 2
  s_and_b32 s38, s38, 1
  s_lshl_b32 s38, s38, 2
  v_or_b32 v14, s38, v13
  v_xor_b32 v14, v14, v12
  v_lshlrev_b32 v14, 4, v14
  v_add_u32 v14, v14, v11
  s_add_u32 s38, s37, 18432
  v_add_u32 v42, s38, v14
  s_add_u32 s38, s33, 3
  s_and_b32 s38, s38, 1
  s_lshl_b32 s38, s38, 2
  v_or_b32 v14, s38, v13
  v_xor_b32 v14, v14, v12
  v_lshlrev_b32 v14, 4, v14
  v_add_u32 v14, v14, v11
  s_add_u32 s38, s37, 27648
  v_add_u32 v43, s38, v14
  s_mul_i32 s45, s32, 9216
  s_add_u32 s45, s45, 65536
  v_lshrrev_b32 v12, 5, v2
  v_and_b32 v13, 31, v2
  s_lshl_b32 s37, s33, 2
  v_or_b32 v14, s37, v12
  v_lshlrev_b32 v12, 13, v12
  s_lshl_b32 s37, s32, 16
  v_add_u32 v12, s37, v12
  v_or_b32 v15, 0, v14
  v_lshlrev_b32 v15, 1, v15
  v_xor_b32 v15, v15, v13
  v_lshlrev_b32 v15, 4, v15
  v_add_u32 v15, v15, v12
  v_add_u32 v45, 0, v15
  v_or_b32 v15, 2, v14
  v_lshlrev_b32 v15, 1, v15
  v_xor_b32 v15, v15, v13
  v_lshlrev_b32 v15, 4, v15
  v_add_u32 v15, v15, v12
  v_add_u32 v46, 15360, v15
  v_or_b32 v15, 0, v14
  v_lshlrev_b32 v15, 1, v15
  v_xor_b32 v15, v15, v13
  v_lshlrev_b32 v15, 4, v15
  v_add_u32 v15, v15, v12
  v_add_u32 v47, 30720, v15
  v_or_b32 v15, 2, v14
  v_lshlrev_b32 v15, 1, v15
  v_xor_b32 v15, v15, v13
  v_lshlrev_b32 v15, 4, v15
  v_add_u32 v15, v15, v12
  v_add_u32 v48, 46080, v15
  s_waitcnt lgkmcnt(0)
  s_cmp_eq_u32 s34, 0
  s_cselect_b64 s[90:91], s[64:65], s[74:75]
  s_cselect_b64 s[96:97], s[70:71], s[80:81]
  s_cselect_b64 s[92:93], s[66:67], s[76:77]
  s_cselect_b64 s[94:95], s[68:69], s[78:79]
  s_mul_i32 s37, s35, 368640
  s_add_u32 s8, s90, s37
  s_addc_u32 s9, s91, 0
  s_mov_b32 s10, 368640
  s_mov_b32 s11, 0x00020000
  s_mov_b32 s12, s96
  s_mov_b32 s13, s97
  s_mov_b32 s14, 5242880
  s_mov_b32 s15, 0x00020000
  s_mov_b32 s41, 0
  s_lshl_b32 s42, s36, 9
  s_add_u32 m0, s43, 0
  s_nop 0
  buffer_load_dwordx4 v45, s[12:15], s42 offen offset:0 nt lds
  buffer_load_dwordx4 v46, s[12:15], s42 offen offset:1024 nt lds
  buffer_load_dwordx4 v47, s[12:15], s42 offen offset:2048 nt lds
  buffer_load_dwordx4 v48, s[12:15], s42 offen offset:3072 nt lds
  s_add_u32 s42, s42, 262144
  s_add_u32 m0, s45, 0
  s_nop 0
  buffer_load_dwordx4 v40, s[8:11], s41 offen offset:0 nt lds
  buffer_load_dwordx4 v41, s[8:11], s41 offen offset:1024 nt lds
  buffer_load_dwordx4 v42, s[8:11], s41 offen offset:2048 nt lds
  buffer_load_dwordx4 v43, s[8:11], s41 offen offset:3072 nt lds
  s_add_u32 m0, s45, 4096
  s_add_u32 s37, s41, 40960
  buffer_load_dwordx4 v40, s[8:11], s37 offen offset:0 nt lds
  buffer_load_dwordx4 v41, s[8:11], s37 offen offset:1024 nt lds
  buffer_load_dwordx4 v42, s[8:11], s37 offen offset:2048 nt lds
  buffer_load_dwordx4 v43, s[8:11], s37 offen offset:3072 nt lds
  s_add_u32 m0, s45, 8192
  s_add_u32 s37, s41, 81920
  buffer_load_dwordx4 v40, s[8:11], s37 offen offset:0 nt lds
  s_add_u32 s41, s41, 128
  s_lshr_b32 s37, s2, 7
  s_cmp_eq_u32 s37, 0
  s_cselect_b64 s[98:99], s[72:73], s[82:83]
  s_and_b32 s38, s2, 127
  s_mul_i32 s39, s38, 40960
  s_add_u32 s28, s98, s39
  s_addc_u32 s29, s99, 0
  s_mov_b32 s30, 40960
  s_mov_b32 s31, 0x00020000
  s_lshl_b32 s39, s37, 3
  s_lshl_b32 s40, s32, 1
  s_add_u32 s39, s39, s40
  s_lshl_b32 s39, s39, 7
  s_add_u32 s39, s39, s38
  s_mul_i32 s46, s39, 5120
  s_add_u32 s46, s46, 37748736
  s_lshl_b32 s37, s35, 5
  s_lshl_b32 s38, s36, 1
  s_add_u32 s37, s37, s38
  s_lshl_b32 s37, s37, 18
  s_add_u32 s16, s92, s37
  s_addc_u32 s17, s93, 0
  s_mov_b32 s18, 524288
  s_mov_b32 s19, 0x00020000
  s_add_u32 s20, s94, s37
  s_addc_u32 s21, s95, 0
  s_mov_b32 s22, 524288
  s_mov_b32 s23, 0x00020000
  buffer_load_dword v50, v7, s[16:19], 0 offen nt
  buffer_load_dword v51, v7, s[20:23], 0 offen nt
  s_mov_b32 s37, 262144
  buffer_load_dword v52, v7, s[16:19], s37 offen nt
  buffer_load_dword v53, v7, s[20:23], s37 offen nt
  s_mov_b32 s24, s88
  s_mov_b32 s25, s89
  s_mov_b32 s26, 48234496
  s_mov_b32 s27, 0x00020000
  s_mov_b32 s51, 0x3e0293ee
  s_mov_b32 s52, 0x53800000
  v_lshlrev_b32 v12, 2, v4
  v_add_u32 v12, v12, v5
  s_movk_i32 s37, 1280
  v_mul_lo_u32 v12, v12, s37
  s_mul_i32 s37, s32, 320
  s_add_u32 s37, s37, 139264
  v_add_u32 v12, s37, v12
  v_lshlrev_b32 v13, 4, v6
  v_add_u32 v8, v12, v13
  v_lshlrev_b32 v14, 3, v6
  v_add_u32 v9, v12, v14
  v_lshrrev_b32 v12, 1, v3
  v_lshlrev_b32 v13, 7, v3
  s_lshl_b32 s37, s32, 13
  s_add_u32 s37, s37, 65536
  s_lshr_b32 s38, s32, 1
  s_lshl_b32 s38, s38, 11
  s_add_u32 s38, s38, 98304
  v_add_u32 v14, 0, v4
  v_xor_b32 v14, v14, v12
  v_lshlrev_b32 v14, 4, v14
  v_add_u32 v14, v14, v13
  v_add_u32 v16, s37, v14
  v_add_u32 v10, s38, v14
  v_add_u32 v14, 4, v4
  v_xor_b32 v14, v14, v12
  v_lshlrev_b32 v14, 4, v14
  v_add_u32 v14, v14, v13
  v_add_u32 v17, s37, v14
  v_add_u32 v11, s38, v14
  v_and_b32 v12, 1, v4
  v_lshlrev_b32 v12, 2, v12
  v_or_b32 v12, v12, v5
  v_lshlrev_b32 v13, 3, v4
  v_add_u32 v13, v13, v5
  v_lshlrev_b32 v13, 9, v13
  s_lshl_b32 s38, s33, 8
  s_xor_b32 s39, s38, 256
  v_lshlrev_b32 v12, 1, v12
  v_add_u32 v14, 0, v6
  v_xor_b32 v14, v14, v12
  v_lshlrev_b32 v14, 4, v14
  v_add_u32 v14, v14, v13
  v_add_u32 v18, s38, v14
  v_add_u32 v26, s39, v14
  v_add_u32 v14, 4, v6
  v_xor_b32 v14, v14, v12
  v_lshlrev_b32 v14, 4, v14
  v_add_u32 v14, v14, v13
  v_add_u32 v19, s38, v14
  v_add_u32 v27, s39, v14
  v_add_u32 v14, 8, v6
  v_xor_b32 v14, v14, v12
  v_lshlrev_b32 v14, 4, v14
  v_add_u32 v14, v14, v13
  v_add_u32 v20, s38, v14
  v_add_u32 v28, s39, v14
  v_add_u32 v14, 12, v6
  v_xor_b32 v14, v14, v12
  v_lshlrev_b32 v14, 4, v14
  v_add_u32 v14, v14, v13
  v_add_u32 v21, s38, v14
  v_add_u32 v29, s39, v14
  v_lshlrev_b32 v12, 8, v4
  v_add_u32 v12, s43, v12
  v_add_u32 v13, 0, v4
  v_xor_b32 v13, v13, v3
  v_lshlrev_b32 v13, 4, v13
  v_add_u32 v34, v13, v12
  v_add_u32 v13, 4, v4
  v_xor_b32 v13, v13, v3
  v_lshlrev_b32 v13, 4, v13
  v_add_u32 v35, v13, v12
  v_add_u32 v13, 8, v4
  v_xor_b32 v13, v13, v3
  v_lshlrev_b32 v13, 4, v13
  v_add_u32 v36, v13, v12
  v_add_u32 v13, 12, v4
  v_xor_b32 v13, v13, v3
  v_lshlrev_b32 v13, 4, v13
  v_add_u32 v37, v13, v12
  v_add_u32 v13, 0, v4
  v_lshlrev_b32 v13, 1, v13
  v_xor_b32 v13, v13, v3
  v_lshlrev_b32 v13, 4, v13
  v_add_u32 v38, v13, v12
  v_add_u32 v13, 4, v4
  v_lshlrev_b32 v13, 1, v13
  v_xor_b32 v13, v13, v3
  v_lshlrev_b32 v13, 4, v13
  v_add_u32 v39, v13, v12
  s_mov_b32 s47, 0
  s_mov_b32 s54, 0
  v_lshlrev_b32 v49, 6, v2
  v_add_u32 v49, s43, v49
  s_mov_b32 s53, 32768
  s_lshl_b32 s37, s33, 13
  s_xor_b32 s38, s37, 8192
  v_lshlrev_b32 v60, 8, v3
  v_add_u32 v61, 0, v4
  v_xor_b32 v61, v61, v3
  v_lshlrev_b32 v61, 4, v61
  v_add_u32 v61, v61, v60
  v_add_u32 v62, s37, v61
  v_accvgpr_write_b32 a192, v62
  v_add_u32 v62, s38, v61
  v_accvgpr_write_b32 a196, v62
  v_add_u32 v61, 4, v4
  v_xor_b32 v61, v61, v3
  v_lshlrev_b32 v61, 4, v61
  v_add_u32 v61, v61, v60
  v_add_u32 v62, s37, v61
  v_accvgpr_write_b32 a193, v62
  v_add_u32 v62, s38, v61
  v_accvgpr_write_b32 a197, v62
  v_add_u32 v61, 8, v4
  v_xor_b32 v61, v61, v3
  v_lshlrev_b32 v61, 4, v61
  v_add_u32 v61, v61, v60
  v_add_u32 v62, s37, v61
  v_accvgpr_write_b32 a194, v62
  v_add_u32 v62, s38, v61
  v_accvgpr_write_b32 a198, v62
  v_add_u32 v61, 12, v4
  v_xor_b32 v61, v61, v3
  v_lshlrev_b32 v61, 4, v61
  v_add_u32 v61, v61, v60
  v_add_u32 v62, s37, v61
  v_accvgpr_write_b32 a195, v62
  v_add_u32 v62, s38, v61
  v_accvgpr_write_b32 a199, v62
  v_lshlrev_b32 v60, 2, v4
  v_add_u32 v60, v60, v5
  v_and_b32 v63, 7, v60
  v_lshlrev_b32 v60, 8, v60
  v_lshlrev_b32 v61, 3, v6
  v_add_u32 v60, v60, v61
  s_add_u32 s37, s37, 65536
  s_add_u32 s38, s38, 65536
  v_xor_b32 v61, 0, v63
  v_lshlrev_b32 v61, 5, v61
  v_add_u32 v61, v61, v60
  v_add_u32 v62, s37, v61
  v_accvgpr_write_b32 a200, v62
  v_add_u32 v62, s38, v61
  v_accvgpr_write_b32 a208, v62
  v_xor_b32 v61, 1, v63
  v_lshlrev_b32 v61, 5, v61
  v_add_u32 v61, v61, v60
  v_add_u32 v62, s37, v61
  v_accvgpr_write_b32 a201, v62
  v_add_u32 v62, s38, v61
  v_accvgpr_write_b32 a209, v62
  v_xor_b32 v61, 2, v63
  v_lshlrev_b32 v61, 5, v61
  v_add_u32 v61, v61, v60
  v_add_u32 v62, s37, v61
  v_accvgpr_write_b32 a202, v62
  v_add_u32 v62, s38, v61
  v_accvgpr_write_b32 a210, v62
  v_xor_b32 v61, 3, v63
  v_lshlrev_b32 v61, 5, v61
  v_add_u32 v61, v61, v60
  v_add_u32 v62, s37, v61
  v_accvgpr_write_b32 a203, v62
  v_add_u32 v62, s38, v61
  v_accvgpr_write_b32 a211, v62
  v_xor_b32 v61, 4, v63
  v_lshlrev_b32 v61, 5, v61
  v_add_u32 v61, v61, v60
  v_add_u32 v62, s37, v61
  v_accvgpr_write_b32 a204, v62
  v_add_u32 v62, s38, v61
  v_accvgpr_write_b32 a212, v62
  v_xor_b32 v61, 5, v63
  v_lshlrev_b32 v61, 5, v61
  v_add_u32 v61, v61, v60
  v_add_u32 v62, s37, v61
  v_accvgpr_write_b32 a205, v62
  v_add_u32 v62, s38, v61
  v_accvgpr_write_b32 a213, v62
  v_xor_b32 v61, 6, v63
  v_lshlrev_b32 v61, 5, v61
  v_add_u32 v61, v61, v60
  v_add_u32 v62, s37, v61
  v_accvgpr_write_b32 a206, v62
  v_add_u32 v62, s38, v61
  v_accvgpr_write_b32 a214, v62
  v_xor_b32 v61, 7, v63
  v_lshlrev_b32 v61, 5, v61
  v_add_u32 v61, v61, v60
  v_add_u32 v62, s37, v61
  v_accvgpr_write_b32 a207, v62
  v_add_u32 v62, s38, v61
  v_accvgpr_write_b32 a215, v62
  s_lshl_b32 s37, s32, 2
  s_add_u32 s37, s37, 0
  s_cmp_ge_u32 s37, 9
  s_cselect_b32 s38, 1, 0
  s_mul_i32 s39, s38, 9
  s_sub_u32 s37, s37, s39
  s_lshl_b32 s39, s34, 4
  s_lshl_b32 s40, s35, 1
  s_add_u32 s39, s39, s40
  s_add_u32 s39, s39, s38
  s_mul_i32 s39, s39, 1179648
  s_lshl_b32 s37, s37, 10
  s_add_u32 s56, s39, s37
  s_lshl_b32 s37, s32, 2
  s_add_u32 s37, s37, 1
  s_cmp_ge_u32 s37, 9
  s_cselect_b32 s38, 1, 0
  s_mul_i32 s39, s38, 9
  s_sub_u32 s37, s37, s39
  s_lshl_b32 s39, s34, 4
  s_lshl_b32 s40, s35, 1
  s_add_u32 s39, s39, s40
  s_add_u32 s39, s39, s38
  s_mul_i32 s39, s39, 1179648
  s_lshl_b32 s37, s37, 10
  s_add_u32 s57, s39, s37
  s_lshl_b32 s37, s32, 2
  s_add_u32 s37, s37, 2
  s_cmp_ge_u32 s37, 9
  s_cselect_b32 s38, 1, 0
  s_mul_i32 s39, s38, 9
  s_sub_u32 s37, s37, s39
  s_lshl_b32 s39, s34, 4
  s_lshl_b32 s40, s35, 1
  s_add_u32 s39, s39, s40
  s_add_u32 s39, s39, s38
  s_mul_i32 s39, s39, 1179648
  s_lshl_b32 s37, s37, 10
  s_add_u32 s58, s39, s37
  s_lshl_b32 s37, s32, 2
  s_add_u32 s37, s37, 3
  s_cmp_ge_u32 s37, 9
  s_cselect_b32 s38, 1, 0
  s_mul_i32 s39, s38, 9
  s_sub_u32 s37, s37, s39
  s_lshl_b32 s39, s34, 4
  s_lshl_b32 s40, s35, 1
  s_add_u32 s39, s39, s40
  s_add_u32 s39, s39, s38
  s_mul_i32 s39, s39, 1179648
  s_lshl_b32 s37, s37, 10
  s_add_u32 s59, s39, s37
  s_lshr_b32 s37, s32, 1
  s_add_u32 s37, s37, 16
  s_cmp_ge_u32 s37, 9
  s_cselect_b32 s38, 1, 0
  s_mul_i32 s39, s38, 9
  s_sub_u32 s37, s37, s39
  s_lshl_b32 s39, s34, 4
  s_lshl_b32 s40, s35, 1
  s_add_u32 s39, s39, s40
  s_add_u32 s39, s39, s38
  s_mul_i32 s39, s39, 1179648
  s_lshl_b32 s37, s37, 10
  s_add_u32 s60, s39, s37
  s_lshl_b32 s37, s36, 3
  s_mul_i32 s50, s37, 9216
  s_mul_i32 s39, s32, 5120
  s_add_u32 m0, s39, 139264
  s_add_u32 s40, s39, 0
  buffer_load_dwordx4 v7, s[28:31], s40 offen offset:0 nt lds
  buffer_load_dwordx4 v7, s[28:31], s40 offen offset:1024 nt lds
  buffer_load_dwordx4 v7, s[28:31], s40 offen offset:2048 nt lds
  buffer_load_dwordx4 v7, s[28:31], s40 offen offset:3072 nt lds
  s_add_u32 m0, s39, 143360
  s_add_u32 s40, s40, 4096
  buffer_load_dwordx4 v7, s[28:31], s40 offen nt lds
  s_add_u32 m0, s43, 16384
  s_nop 0
  buffer_load_dwordx4 v45, s[12:15], s42 offen offset:0 nt lds
  buffer_load_dwordx4 v46, s[12:15], s42 offen offset:1024 nt lds
  buffer_load_dwordx4 v47, s[12:15], s42 offen offset:2048 nt lds
  buffer_load_dwordx4 v48, s[12:15], s42 offen offset:3072 nt lds
  s_add_u32 s42, s42, 262144
  s_add_u32 m0, s45, 36864
  s_nop 0
  buffer_load_dwordx4 v40, s[8:11], s41 offen offset:0 nt lds
  buffer_load_dwordx4 v41, s[8:11], s41 offen offset:1024 nt lds
  buffer_load_dwordx4 v42, s[8:11], s41 offen offset:2048 nt lds
  buffer_load_dwordx4 v43, s[8:11], s41 offen offset:3072 nt lds
  s_add_u32 m0, s45, 40960
  s_add_u32 s37, s41, 40960
  buffer_load_dwordx4 v40, s[8:11], s37 offen offset:0 nt lds
  buffer_load_dwordx4 v41, s[8:11], s37 offen offset:1024 nt lds
  buffer_load_dwordx4 v42, s[8:11], s37 offen offset:2048 nt lds
  buffer_load_dwordx4 v43, s[8:11], s37 offen offset:3072 nt lds
  s_add_u32 m0, s45, 45056
  s_add_u32 s37, s41, 81920
  buffer_load_dwordx4 v40, s[8:11], s37 offen offset:0 nt lds
  s_add_u32 s41, s41, 128
  s_add_u32 m0, s43, 32768
  s_nop 0
  buffer_load_dwordx4 v45, s[12:15], s42 offen offset:0 nt lds
  buffer_load_dwordx4 v46, s[12:15], s42 offen offset:1024 nt lds
  buffer_load_dwordx4 v47, s[12:15], s42 offen offset:2048 nt lds
  buffer_load_dwordx4 v48, s[12:15], s42 offen offset:3072 nt lds
  s_add_u32 s42, s42, 262144
  s_add_u32 m0, s43, 49152
  s_nop 0
  buffer_load_dwordx4 v45, s[12:15], s42 offen offset:0 nt lds
  buffer_load_dwordx4 v46, s[12:15], s42 offen offset:1024 nt lds
  buffer_load_dwordx4 v47, s[12:15], s42 offen offset:2048 nt lds
  buffer_load_dwordx4 v48, s[12:15], s42 offen offset:3072 nt lds
  s_add_u32 s42, s42, 262144
  s_waitcnt vmcnt(30)
  s_barrier
  ds_read_b128 a[112:115], v16 offset:0
  ds_read_b128 a[116:119], v16 offset:2048
  ds_read_b128 a[120:123], v16 offset:4096
  ds_read_b128 a[124:127], v16 offset:6144
  ds_read_b128 a[128:131], v10 offset:0
  ds_read_b64_tr_b16 a[96:97], v18 offset:0
  ds_read_b64_tr_b16 a[98:99], v18 offset:2048
  ds_read_b64_tr_b16 a[100:101], v18 offset:8
  ds_read_b64_tr_b16 a[102:103], v18 offset:2056
  ds_read_b64_tr_b16 a[104:105], v19 offset:0
  ds_read_b64_tr_b16 a[106:107], v19 offset:2048
  ds_read_b64_tr_b16 a[108:109], v19 offset:8
  ds_read_b64_tr_b16 a[110:111], v19 offset:2056
  s_waitcnt lgkmcnt(4)
  v_mfma_f32_16x16x32_bf16 v[192:195], a[96:99], a[112:115], 0
  v_mfma_f32_16x16x32_bf16 v[196:199], a[96:99], a[116:119], 0
  v_mfma_f32_16x16x32_bf16 v[200:203], a[96:99], a[120:123], 0
  v_mfma_f32_16x16x32_bf16 v[204:207], a[96:99], a[124:127], 0
  v_mfma_f32_16x16x32_bf16 v[208:211], a[96:99], a[128:131], 0
  ds_read_b64_tr_b16 a[96:97], v20 offset:0
  ds_read_b64_tr_b16 a[98:99], v20 offset:2048
  v_mfma_f32_16x16x32_bf16 v[212:215], a[100:103], a[112:115], 0
  v_mfma_f32_16x16x32_bf16 v[216:219], a[100:103], a[116:119], 0
  v_mfma_f32_16x16x32_bf16 v[220:223], a[100:103], a[120:123], 0
  v_mfma_f32_16x16x32_bf16 v[224:227], a[100:103], a[124:127], 0
  v_mfma_f32_16x16x32_bf16 v[228:231], a[100:103], a[128:131], 0
  ds_read_b64_tr_b16 a[100:101], v20 offset:8
  s_waitcnt lgkmcnt(3)
  v_mfma_f32_16x16x32_bf16 v[232:235], a[104:107], a[112:115], 0
  ds_read_b64_tr_b16 a[102:103], v20 offset:2056
  v_mfma_f32_16x16x32_bf16 v[236:239], a[104:107], a[116:119], 0
  v_mfma_f32_16x16x32_bf16 v[240:243], a[104:107], a[120:123], 0
  v_mfma_f32_16x16x32_bf16 v[244:247], a[104:107], a[124:127], 0
  v_mfma_f32_16x16x32_bf16 v[248:251], a[104:107], a[128:131], 0
  ds_read_b64_tr_b16 a[104:105], v21 offset:0
  ds_read_b64_tr_b16 a[106:107], v21 offset:2048
  v_mfma_f32_16x16x32_bf16 v[252:255], a[108:111], a[112:115], 0
  v_mfma_f32_16x16x32_bf16 a[0:3], a[108:111], a[116:119], 0
  v_mfma_f32_16x16x32_bf16 a[4:7], a[108:111], a[120:123], 0
  v_mfma_f32_16x16x32_bf16 a[8:11], a[108:111], a[124:127], 0
  v_mfma_f32_16x16x32_bf16 a[12:15], a[108:111], a[128:131], 0
  ds_read_b64_tr_b16 a[108:109], v21 offset:8
  s_waitcnt lgkmcnt(3)
  v_mfma_f32_16x16x32_bf16 a[16:19], a[96:99], a[112:115], 0
  ds_read_b64_tr_b16 a[110:111], v21 offset:2056
  v_mfma_f32_16x16x32_bf16 a[20:23], a[96:99], a[116:119], 0
  v_mfma_f32_16x16x32_bf16 a[24:27], a[96:99], a[120:123], 0
  v_mfma_f32_16x16x32_bf16 a[28:31], a[96:99], a[124:127], 0
  v_mfma_f32_16x16x32_bf16 a[32:35], a[96:99], a[128:131], 0
  ds_read_b64_tr_b16 a[96:97], v26 offset:0
  ds_read_b64_tr_b16 a[98:99], v26 offset:2048
  v_mfma_f32_16x16x32_bf16 a[36:39], a[100:103], a[112:115], 0
  v_mfma_f32_16x16x32_bf16 a[40:43], a[100:103], a[116:119], 0
  v_mfma_f32_16x16x32_bf16 a[44:47], a[100:103], a[120:123], 0
  v_mfma_f32_16x16x32_bf16 a[48:51], a[100:103], a[124:127], 0
  v_mfma_f32_16x16x32_bf16 a[52:55], a[100:103], a[128:131], 0
  ds_read_b64_tr_b16 a[100:101], v26 offset:8
  s_waitcnt lgkmcnt(3)
  v_mfma_f32_16x16x32_bf16 a[56:59], a[104:107], a[112:115], 0
  ds_read_b64_tr_b16 a[102:103], v26 offset:2056
  v_mfma_f32_16x16x32_bf16 a[60:63], a[104:107], a[116:119], 0
  v_mfma_f32_16x16x32_bf16 a[64:67], a[104:107], a[120:123], 0
  v_mfma_f32_16x16x32_bf16 a[68:71], a[104:107], a[124:127], 0
  v_mfma_f32_16x16x32_bf16 a[72:75], a[104:107], a[128:131], 0
  ds_read_b64_tr_b16 a[104:105], v27 offset:0
  ds_read_b64_tr_b16 a[106:107], v27 offset:2048
  v_mfma_f32_16x16x32_bf16 a[76:79], a[108:111], a[112:115], 0
  v_mfma_f32_16x16x32_bf16 a[80:83], a[108:111], a[116:119], 0
  v_mfma_f32_16x16x32_bf16 a[84:87], a[108:111], a[120:123], 0
  v_mfma_f32_16x16x32_bf16 a[88:91], a[108:111], a[124:127], 0
  v_mfma_f32_16x16x32_bf16 a[92:95], a[108:111], a[128:131], 0
  ds_read_b64_tr_b16 a[108:109], v27 offset:8
  s_waitcnt lgkmcnt(3)
  v_mfma_f32_16x16x32_bf16 v[64:67], a[96:99], a[112:115], 0
  ds_read_b64_tr_b16 a[110:111], v27 offset:2056
  v_mfma_f32_16x16x32_bf16 v[68:71], a[96:99], a[116:119], 0
  v_mfma_f32_16x16x32_bf16 v[72:75], a[96:99], a[120:123], 0
  v_mfma_f32_16x16x32_bf16 v[76:79], a[96:99], a[124:127], 0
  ds_read_b64_tr_b16 a[96:97], v28 offset:0
  ds_read_b64_tr_b16 a[98:99], v28 offset:2048
  v_mfma_f32_16x16x32_bf16 v[80:83], a[100:103], a[112:115], 0
  v_mfma_f32_16x16x32_bf16 v[84:87], a[100:103], a[116:119], 0
  v_mfma_f32_16x16x32_bf16 v[88:91], a[100:103], a[120:123], 0
  v_mfma_f32_16x16x32_bf16 v[92:95], a[100:103], a[124:127], 0
  ds_read_b64_tr_b16 a[100:101], v28 offset:8
  s_waitcnt lgkmcnt(3)
  v_mfma_f32_16x16x32_bf16 v[96:99], a[104:107], a[112:115], 0
  ds_read_b64_tr_b16 a[102:103], v28 offset:2056
  v_mfma_f32_16x16x32_bf16 v[100:103], a[104:107], a[116:119], 0
  v_mfma_f32_16x16x32_bf16 v[104:107], a[104:107], a[120:123], 0
  v_mfma_f32_16x16x32_bf16 v[108:111], a[104:107], a[124:127], 0
  ds_read_b64_tr_b16 a[104:105], v29 offset:0
  ds_read_b64_tr_b16 a[106:107], v29 offset:2048
  v_mfma_f32_16x16x32_bf16 v[112:115], a[108:111], a[112:115], 0
  v_mfma_f32_16x16x32_bf16 v[116:119], a[108:111], a[116:119], 0
  v_mfma_f32_16x16x32_bf16 v[120:123], a[108:111], a[120:123], 0
  v_mfma_f32_16x16x32_bf16 v[124:127], a[108:111], a[124:127], 0
  ds_read_b64_tr_b16 a[108:109], v29 offset:8
  s_waitcnt lgkmcnt(3)
  v_mfma_f32_16x16x32_bf16 v[128:131], a[96:99], a[112:115], 0
  ds_read_b64_tr_b16 a[110:111], v29 offset:2056
  v_mfma_f32_16x16x32_bf16 v[132:135], a[96:99], a[116:119], 0
  v_mfma_f32_16x16x32_bf16 v[136:139], a[96:99], a[120:123], 0
  s_waitcnt vmcnt(17)
  s_waitcnt lgkmcnt(0)
  s_barrier
  v_mfma_f32_16x16x32_bf16 v[140:143], a[96:99], a[124:127], 0
  ds_read_b128 a[132:135], v17 offset:0
  ds_read_b128 a[136:139], v17 offset:2048
  v_mfma_f32_16x16x32_bf16 v[144:147], a[100:103], a[112:115], 0
  ds_read_b128 a[140:143], v17 offset:4096
  ds_read_b128 a[144:147], v17 offset:6144
  v_mfma_f32_16x16x32_bf16 v[148:151], a[100:103], a[116:119], 0
  ds_read_b128 a[148:151], v11 offset:0
  ds_read_b64_tr_b16 a[96:97], v18 offset:16384
  v_mfma_f32_16x16x32_bf16 v[152:155], a[100:103], a[120:123], 0
  ds_read_b64_tr_b16 a[98:99], v18 offset:18432
  ds_read_b64_tr_b16 a[152:153], v8 offset:0
  v_mfma_f32_16x16x32_bf16 v[156:159], a[100:103], a[124:127], 0
  ds_read_b64_tr_b16 a[100:101], v18 offset:16392
  v_mfma_f32_16x16x32_bf16 v[160:163], a[104:107], a[112:115], 0
  ds_read_b64_tr_b16 a[102:103], v18 offset:18440
  ds_read_b64_tr_b16 a[156:157], v8 offset:8
  v_mfma_f32_16x16x32_bf16 v[164:167], a[104:107], a[116:119], 0
  ds_read_b64_tr_b16 a[160:161], v8 offset:64
  ds_read_b64_tr_b16 a[164:165], v8 offset:72
  v_mfma_f32_16x16x32_bf16 v[168:171], a[104:107], a[120:123], 0
  ds_read_b64_tr_b16 a[168:169], v9 offset:128
  ds_read_b64_tr_b16 a[172:173], v8 offset:160
  v_mfma_f32_16x16x32_bf16 v[172:175], a[104:107], a[124:127], 0
  ds_read_b64_tr_b16 a[104:105], v19 offset:16384
  ds_read_b64_tr_b16 a[106:107], v19 offset:18432
  v_mfma_f32_16x16x32_bf16 v[176:179], a[108:111], a[112:115], 0
  ds_read_b64_tr_b16 a[176:177], v8 offset:168
  ds_read_b64_tr_b16 a[180:181], v8 offset:224
  v_mfma_f32_16x16x32_bf16 v[180:183], a[108:111], a[116:119], 0
  ds_read_b64_tr_b16 a[184:185], v8 offset:232
  ds_read_b64_tr_b16 a[188:189], v9 offset:288
  v_mfma_f32_16x16x32_bf16 v[184:187], a[108:111], a[120:123], 0
  v_mfma_f32_16x16x32_bf16 v[188:191], a[108:111], a[124:127], 0
  ds_read_b64_tr_b16 a[108:109], v19 offset:16392
  ds_read_b64_tr_b16 a[110:111], v19 offset:18440
  s_mov_b32 s44, 4
K1_QLOOP:
  s_waitcnt lgkmcnt(4)
  v_mfma_f32_16x16x32_bf16 v[192:195], a[96:99], a[132:135], v[192:195]
  v_mfma_f32_16x16x32_bf16 v[196:199], a[96:99], a[136:139], v[196:199]
  s_add_u32 m0, s43, 0
  s_nop 0
  buffer_load_dwordx4 v45, s[12:15], s42 offen offset:0 nt lds
  v_mfma_f32_16x16x32_bf16 v[200:203], a[96:99], a[140:143], v[200:203]
  v_mfma_f32_16x16x32_bf16 v[204:207], a[96:99], a[144:147], v[204:207]
  v_mfma_f32_16x16x32_bf16 v[208:211], a[96:99], a[148:151], v[208:211]
  ds_read_b64_tr_b16 a[96:97], v20 offset:16384
  ds_read_b64_tr_b16 a[98:99], v20 offset:18432
  v_mfma_f32_16x16x32_bf16 v[212:215], a[100:103], a[132:135], v[212:215]
  v_mfma_f32_16x16x32_bf16 v[216:219], a[100:103], a[136:139], v[216:219]
  buffer_load_dwordx4 v46, s[12:15], s42 offen offset:1024 nt lds
  v_mfma_f32_16x16x32_bf16 v[220:223], a[100:103], a[140:143], v[220:223]
  v_mfma_f32_16x16x32_bf16 v[224:227], a[100:103], a[144:147], v[224:227]
  v_mfma_f32_16x16x32_bf16 v[228:231], a[100:103], a[148:151], v[228:231]
  ds_read_b64_tr_b16 a[100:101], v20 offset:16392
  s_waitcnt lgkmcnt(3)
  v_mfma_f32_16x16x32_bf16 v[232:235], a[104:107], a[132:135], v[232:235]
  ds_read_b64_tr_b16 a[102:103], v20 offset:18440
  v_mfma_f32_16x16x32_bf16 v[236:239], a[104:107], a[136:139], v[236:239]
  buffer_load_dwordx4 v47, s[12:15], s42 offen offset:2048 nt lds
  v_mfma_f32_16x16x32_bf16 v[240:243], a[104:107], a[140:143], v[240:243]
  v_mfma_f32_16x16x32_bf16 v[244:247], a[104:107], a[144:147], v[244:247]
  v_mfma_f32_16x16x32_bf16 v[248:251], a[104:107], a[148:151], v[248:251]
  ds_read_b64_tr_b16 a[104:105], v21 offset:16384
  ds_read_b64_tr_b16 a[106:107], v21 offset:18432
  v_mfma_f32_16x16x32_bf16 v[252:255], a[108:111], a[132:135], v[252:255]
  v_mfma_f32_16x16x32_bf16 a[0:3], a[108:111], a[136:139], a[0:3]
  buffer_load_dwordx4 v48, s[12:15], s42 offen offset:3072 nt lds
  s_add_u32 s42, s42, 262144
  v_mfma_f32_16x16x32_bf16 a[4:7], a[108:111], a[140:143], a[4:7]
  v_mfma_f32_16x16x32_bf16 a[8:11], a[108:111], a[144:147], a[8:11]
  v_mfma_f32_16x16x32_bf16 a[12:15], a[108:111], a[148:151], a[12:15]
  ds_read_b64_tr_b16 a[108:109], v21 offset:16392
  s_waitcnt lgkmcnt(3)
  v_mfma_f32_16x16x32_bf16 a[16:19], a[96:99], a[132:135], a[16:19]
  ds_read_b64_tr_b16 a[110:111], v21 offset:18440
  v_mfma_f32_16x16x32_bf16 a[20:23], a[96:99], a[136:139], a[20:23]
  v_mfma_f32_16x16x32_bf16 a[24:27], a[96:99], a[140:143], a[24:27]
  v_mfma_f32_16x16x32_bf16 a[28:31], a[96:99], a[144:147], a[28:31]
  v_mfma_f32_16x16x32_bf16 a[32:35], a[96:99], a[148:151], a[32:35]
  ds_read_b64_tr_b16 a[96:97], v26 offset:16384
  ds_read_b64_tr_b16 a[98:99], v26 offset:18432
  v_mfma_f32_16x16x32_bf16 a[36:39], a[100:103], a[132:135], a[36:39]
  v_mfma_f32_16x16x32_bf16 a[40:43], a[100:103], a[136:139], a[40:43]
  v_mfma_f32_16x16x32_bf16 a[44:47], a[100:103], a[140:143], a[44:47]
  v_mfma_f32_16x16x32_bf16 a[48:51], a[100:103], a[144:147], a[48:51]
  v_mfma_f32_16x16x32_bf16 a[52:55], a[100:103], a[148:151], a[52:55]
  ds_read_b64_tr_b16 a[100:101], v26 offset:16392
  s_waitcnt lgkmcnt(3)
  v_mfma_f32_16x16x32_bf16 a[56:59], a[104:107], a[132:135], a[56:59]
  ds_read_b64_tr_b16 a[102:103], v26 offset:18440
  v_mfma_f32_16x16x32_bf16 a[60:63], a[104:107], a[136:139], a[60:63]
  v_mfma_f32_16x16x32_bf16 a[64:67], a[104:107], a[140:143], a[64:67]
  v_mfma_f32_16x16x32_bf16 a[68:71], a[104:107], a[144:147], a[68:71]
  v_mfma_f32_16x16x32_bf16 a[72:75], a[104:107], a[148:151], a[72:75]
  ds_read_b64_tr_b16 a[104:105], v27 offset:16384
  ds_read_b64_tr_b16 a[106:107], v27 offset:18432
  v_mfma_f32_16x16x32_bf16 a[76:79], a[108:111], a[132:135], a[76:79]
  v_mfma_f32_16x16x32_bf16 a[80:83], a[108:111], a[136:139], a[80:83]
  v_mfma_f32_16x16x32_bf16 a[84:87], a[108:111], a[140:143], a[84:87]
  v_mfma_f32_16x16x32_bf16 a[88:91], a[108:111], a[144:147], a[88:91]
  v_mfma_f32_16x16x32_bf16 a[92:95], a[108:111], a[148:151], a[92:95]
  ds_read_b64_tr_b16 a[108:109], v27 offset:16392
  s_waitcnt lgkmcnt(3)
  v_mfma_f32_16x16x32_bf16 v[64:67], a[96:99], a[132:135], v[64:67]
  ds_read_b64_tr_b16 a[110:111], v27 offset:18440
  v_mfma_f32_16x16x32_bf16 v[68:71], a[96:99], a[136:139], v[68:71]
  v_mfma_f32_16x16x32_bf16 v[72:75], a[96:99], a[140:143], v[72:75]
  v_mfma_f32_16x16x32_bf16 v[76:79], a[96:99], a[144:147], v[76:79]
  ds_read_b64_tr_b16 a[96:97], v28 offset:16384
  ds_read_b64_tr_b16 a[98:99], v28 offset:18432
  v_mfma_f32_16x16x32_bf16 v[80:83], a[100:103], a[132:135], v[80:83]
  v_mfma_f32_16x16x32_bf16 v[84:87], a[100:103], a[136:139], v[84:87]
  v_mfma_f32_16x16x32_bf16 v[88:91], a[100:103], a[140:143], v[88:91]
  v_mfma_f32_16x16x32_bf16 v[92:95], a[100:103], a[144:147], v[92:95]
  ds_read_b64_tr_b16 a[100:101], v28 offset:16392
  s_waitcnt lgkmcnt(3)
  v_mfma_f32_16x16x32_bf16 v[96:99], a[104:107], a[132:135], v[96:99]
  ds_read_b64_tr_b16 a[102:103], v28 offset:18440
  v_mfma_f32_16x16x32_bf16 v[100:103], a[104:107], a[136:139], v[100:103]
  v_mfma_f32_16x16x32_bf16 v[104:107], a[104:107], a[140:143], v[104:107]
  v_mfma_f32_16x16x32_bf16 v[108:111], a[104:107], a[144:147], v[108:111]
  ds_read_b64_tr_b16 a[104:105], v29 offset:16384
  ds_read_b64_tr_b16 a[106:107], v29 offset:18432
  v_mfma_f32_16x16x32_bf16 v[112:115], a[108:111], a[132:135], v[112:115]
  v_mfma_f32_16x16x32_bf16 v[116:119], a[108:111], a[136:139], v[116:119]
  v_mfma_f32_16x16x32_bf16 v[120:123], a[108:111], a[140:143], v[120:123]
  v_mfma_f32_16x16x32_bf16 v[124:127], a[108:111], a[144:147], v[124:127]
  ds_read_b64_tr_b16 a[108:109], v29 offset:16392
  s_waitcnt lgkmcnt(3)
  v_mfma_f32_16x16x32_bf16 v[128:131], a[96:99], a[132:135], v[128:131]
  ds_read_b64_tr_b16 a[110:111], v29 offset:18440
  v_mfma_f32_16x16x32_bf16 v[132:135], a[96:99], a[136:139], v[132:135]
  v_mfma_f32_16x16x32_bf16 v[136:139], a[96:99], a[140:143], v[136:139]
  s_waitcnt vmcnt(8)
  s_waitcnt lgkmcnt(0)
  s_barrier
  v_mfma_f32_16x16x32_bf16 v[140:143], a[96:99], a[144:147], v[140:143]
  ds_read_b128 a[112:115], v16 offset:36864
  ds_read_b128 a[116:119], v16 offset:38912
  v_mfma_f32_16x16x32_bf16 v[144:147], a[100:103], a[132:135], v[144:147]
  ds_read_b128 a[120:123], v16 offset:40960
  ds_read_b128 a[124:127], v16 offset:43008
  v_mfma_f32_16x16x32_bf16 v[148:151], a[100:103], a[136:139], v[148:151]
  ds_read_b128 a[128:131], v10 offset:36864
  ds_read_b64_tr_b16 a[96:97], v18 offset:32768
  v_mfma_f32_16x16x32_bf16 v[152:155], a[100:103], a[140:143], v[152:155]
  ds_read_b64_tr_b16 a[98:99], v18 offset:34816
  v_mfma_f32_16x16x32_bf16 v[156:159], a[100:103], a[144:147], v[156:159]
  ds_read_b64_tr_b16 a[100:101], v18 offset:32776
  v_mfma_f32_16x16x32_bf16 v[160:163], a[104:107], a[132:135], v[160:163]
  ds_read_b64_tr_b16 a[102:103], v18 offset:34824
  v_mfma_f32_16x16x32_bf16 v[164:167], a[104:107], a[136:139], v[164:167]
  v_mfma_f32_16x16x32_bf16 v[168:171], a[104:107], a[140:143], v[168:171]
  v_mfma_f32_16x16x32_bf16 v[172:175], a[104:107], a[144:147], v[172:175]
  ds_read_b64_tr_b16 a[104:105], v19 offset:32768
  ds_read_b64_tr_b16 a[106:107], v19 offset:34816
  v_mfma_f32_16x16x32_bf16 v[176:179], a[108:111], a[132:135], v[176:179]
  v_mfma_f32_16x16x32_bf16 v[180:183], a[108:111], a[136:139], v[180:183]
  v_mfma_f32_16x16x32_bf16 v[184:187], a[108:111], a[140:143], v[184:187]
  v_mfma_f32_16x16x32_bf16 v[188:191], a[108:111], a[144:147], v[188:191]
  ds_read_b64_tr_b16 a[108:109], v19 offset:32776
  ds_read_b64_tr_b16 a[110:111], v19 offset:34824
  s_waitcnt lgkmcnt(4)
  v_mfma_f32_16x16x32_bf16 v[192:195], a[96:99], a[112:115], v[192:195]
  v_mfma_f32_16x16x32_bf16 v[196:199], a[96:99], a[116:119], v[196:199]
  s_add_u32 m0, s45, 0
  s_nop 0
  buffer_load_dwordx4 v40, s[8:11], s41 offen offset:0 nt lds
  v_mfma_f32_16x16x32_bf16 v[200:203], a[96:99], a[120:123], v[200:203]
  v_mfma_f32_16x16x32_bf16 v[204:207], a[96:99], a[124:127], v[204:207]
  v_mfma_f32_16x16x32_bf16 v[208:211], a[96:99], a[128:131], v[208:211]
  ds_read_b64_tr_b16 a[96:97], v20 offset:32768
  ds_read_b64_tr_b16 a[98:99], v20 offset:34816
  v_mfma_f32_16x16x32_bf16 v[212:215], a[100:103], a[112:115], v[212:215]
  v_mfma_f32_16x16x32_bf16 v[216:219], a[100:103], a[116:119], v[216:219]
  buffer_load_dwordx4 v41, s[8:11], s41 offen offset:1024 nt lds
  v_mfma_f32_16x16x32_bf16 v[220:223], a[100:103], a[120:123], v[220:223]
  v_mfma_f32_16x16x32_bf16 v[224:227], a[100:103], a[124:127], v[224:227]
  v_mfma_f32_16x16x32_bf16 v[228:231], a[100:103], a[128:131], v[228:231]
  ds_read_b64_tr_b16 a[100:101], v20 offset:32776
  s_waitcnt lgkmcnt(3)
  v_mfma_f32_16x16x32_bf16 v[232:235], a[104:107], a[112:115], v[232:235]
  ds_read_b64_tr_b16 a[102:103], v20 offset:34824
  v_mfma_f32_16x16x32_bf16 v[236:239], a[104:107], a[116:119], v[236:239]
  buffer_load_dwordx4 v42, s[8:11], s41 offen offset:2048 nt lds
  v_mfma_f32_16x16x32_bf16 v[240:243], a[104:107], a[120:123], v[240:243]
  v_mfma_f32_16x16x32_bf16 v[244:247], a[104:107], a[124:127], v[244:247]
  v_mfma_f32_16x16x32_bf16 v[248:251], a[104:107], a[128:131], v[248:251]
  ds_read_b64_tr_b16 a[104:105], v21 offset:32768
  ds_read_b64_tr_b16 a[106:107], v21 offset:34816
  v_mfma_f32_16x16x32_bf16 v[252:255], a[108:111], a[112:115], v[252:255]
  v_mfma_f32_16x16x32_bf16 a[0:3], a[108:111], a[116:119], a[0:3]
  buffer_load_dwordx4 v43, s[8:11], s41 offen offset:3072 nt lds
  v_mfma_f32_16x16x32_bf16 a[4:7], a[108:111], a[120:123], a[4:7]
  v_mfma_f32_16x16x32_bf16 a[8:11], a[108:111], a[124:127], a[8:11]
  v_mfma_f32_16x16x32_bf16 a[12:15], a[108:111], a[128:131], a[12:15]
  ds_read_b64_tr_b16 a[108:109], v21 offset:32776
  s_waitcnt lgkmcnt(3)
  v_mfma_f32_16x16x32_bf16 a[16:19], a[96:99], a[112:115], a[16:19]
  ds_read_b64_tr_b16 a[110:111], v21 offset:34824
  v_mfma_f32_16x16x32_bf16 a[20:23], a[96:99], a[116:119], a[20:23]
  s_add_u32 m0, s45, 4096
  s_add_u32 s37, s41, 40960
  v_mfma_f32_16x16x32_bf16 a[24:27], a[96:99], a[120:123], a[24:27]
  buffer_load_dwordx4 v40, s[8:11], s37 offen offset:0 nt lds
  v_mfma_f32_16x16x32_bf16 a[28:31], a[96:99], a[124:127], a[28:31]
  v_mfma_f32_16x16x32_bf16 a[32:35], a[96:99], a[128:131], a[32:35]
  ds_read_b64_tr_b16 a[96:97], v26 offset:32768
  ds_read_b64_tr_b16 a[98:99], v26 offset:34816
  v_mfma_f32_16x16x32_bf16 a[36:39], a[100:103], a[112:115], a[36:39]
  v_mfma_f32_16x16x32_bf16 a[40:43], a[100:103], a[116:119], a[40:43]
  v_mfma_f32_16x16x32_bf16 a[44:47], a[100:103], a[120:123], a[44:47]
  buffer_load_dwordx4 v41, s[8:11], s37 offen offset:1024 nt lds
  v_mfma_f32_16x16x32_bf16 a[48:51], a[100:103], a[124:127], a[48:51]
  v_mfma_f32_16x16x32_bf16 a[52:55], a[100:103], a[128:131], a[52:55]
  ds_read_b64_tr_b16 a[100:101], v26 offset:32776
  s_waitcnt lgkmcnt(3)
  v_mfma_f32_16x16x32_bf16 a[56:59], a[104:107], a[112:115], a[56:59]
  ds_read_b64_tr_b16 a[102:103], v26 offset:34824
  v_mfma_f32_16x16x32_bf16 a[60:63], a[104:107], a[116:119], a[60:63]
  v_mfma_f32_16x16x32_bf16 a[64:67], a[104:107], a[120:123], a[64:67]
  buffer_load_dwordx4 v42, s[8:11], s37 offen offset:2048 nt lds
  v_mfma_f32_16x16x32_bf16 a[68:71], a[104:107], a[124:127], a[68:71]
  v_mfma_f32_16x16x32_bf16 a[72:75], a[104:107], a[128:131], a[72:75]
  ds_read_b64_tr_b16 a[104:105], v27 offset:32768
  ds_read_b64_tr_b16 a[106:107], v27 offset:34816
  v_mfma_f32_16x16x32_bf16 a[76:79], a[108:111], a[112:115], a[76:79]
  v_mfma_f32_16x16x32_bf16 a[80:83], a[108:111], a[116:119], a[80:83]
  v_mfma_f32_16x16x32_bf16 a[84:87], a[108:111], a[120:123], a[84:87]
  buffer_load_dwordx4 v43, s[8:11], s37 offen offset:3072 nt lds
  v_mfma_f32_16x16x32_bf16 a[88:91], a[108:111], a[124:127], a[88:91]
  v_mfma_f32_16x16x32_bf16 a[92:95], a[108:111], a[128:131], a[92:95]
  ds_read_b64_tr_b16 a[108:109], v27 offset:32776
  s_waitcnt lgkmcnt(3)
  v_mfma_f32_16x16x32_bf16 v[64:67], a[96:99], a[112:115], v[64:67]
  ds_read_b64_tr_b16 a[110:111], v27 offset:34824
  v_mfma_f32_16x16x32_bf16 v[68:71], a[96:99], a[116:119], v[68:71]
  v_mfma_f32_16x16x32_bf16 v[72:75], a[96:99], a[120:123], v[72:75]
  s_add_u32 m0, s45, 8192
  s_add_u32 s37, s41, 81920
  v_mfma_f32_16x16x32_bf16 v[76:79], a[96:99], a[124:127], v[76:79]
  ds_read_b64_tr_b16 a[96:97], v28 offset:32768
  ds_read_b64_tr_b16 a[98:99], v28 offset:34816
  v_mfma_f32_16x16x32_bf16 v[80:83], a[100:103], a[112:115], v[80:83]
  buffer_load_dwordx4 v40, s[8:11], s37 offen offset:0 nt lds
  s_add_u32 s41, s41, 128
  v_mfma_f32_16x16x32_bf16 v[84:87], a[100:103], a[116:119], v[84:87]
  v_mfma_f32_16x16x32_bf16 v[88:91], a[100:103], a[120:123], v[88:91]
  v_mfma_f32_16x16x32_bf16 v[92:95], a[100:103], a[124:127], v[92:95]
  ds_read_b64_tr_b16 a[100:101], v28 offset:32776
  s_waitcnt lgkmcnt(3)
  v_mfma_f32_16x16x32_bf16 v[96:99], a[104:107], a[112:115], v[96:99]
  ds_read_b64_tr_b16 a[102:103], v28 offset:34824
  v_mfma_f32_16x16x32_bf16 v[100:103], a[104:107], a[116:119], v[100:103]
  s_add_u32 m0, s43, 16384
  s_nop 0
  buffer_load_dwordx4 v45, s[12:15], s42 offen offset:0 nt lds
  v_mfma_f32_16x16x32_bf16 v[104:107], a[104:107], a[120:123], v[104:107]
  v_mfma_f32_16x16x32_bf16 v[108:111], a[104:107], a[124:127], v[108:111]
  ds_read_b64_tr_b16 a[104:105], v29 offset:32768
  ds_read_b64_tr_b16 a[106:107], v29 offset:34816
  v_mfma_f32_16x16x32_bf16 v[112:115], a[108:111], a[112:115], v[112:115]
  v_mfma_f32_16x16x32_bf16 v[116:119], a[108:111], a[116:119], v[116:119]
  v_mfma_f32_16x16x32_bf16 v[120:123], a[108:111], a[120:123], v[120:123]
  buffer_load_dwordx4 v46, s[12:15], s42 offen offset:1024 nt lds
  v_mfma_f32_16x16x32_bf16 v[124:127], a[108:111], a[124:127], v[124:127]
  ds_read_b64_tr_b16 a[108:109], v29 offset:32776
  s_waitcnt lgkmcnt(3)
  v_mfma_f32_16x16x32_bf16 v[128:131], a[96:99], a[112:115], v[128:131]
  ds_read_b64_tr_b16 a[110:111], v29 offset:34824
  v_mfma_f32_16x16x32_bf16 v[132:135], a[96:99], a[116:119], v[132:135]
  v_mfma_f32_16x16x32_bf16 v[136:139], a[96:99], a[120:123], v[136:139]
  s_waitcnt vmcnt(15)
  s_waitcnt lgkmcnt(0)
  s_barrier
  v_mfma_f32_16x16x32_bf16 v[140:143], a[96:99], a[124:127], v[140:143]
  ds_read_b128 a[132:135], v17 offset:36864
  ds_read_b128 a[136:139], v17 offset:38912
  v_mfma_f32_16x16x32_bf16 v[144:147], a[100:103], a[112:115], v[144:147]
  ds_read_b128 a[140:143], v17 offset:40960
  ds_read_b128 a[144:147], v17 offset:43008
  v_mfma_f32_16x16x32_bf16 v[148:151], a[100:103], a[116:119], v[148:151]
  ds_read_b128 a[148:151], v11 offset:36864
  ds_read_b64_tr_b16 a[96:97], v18 offset:49152
  v_mfma_f32_16x16x32_bf16 v[152:155], a[100:103], a[120:123], v[152:155]
  ds_read_b64_tr_b16 a[98:99], v18 offset:51200
  buffer_load_dwordx4 v47, s[12:15], s42 offen offset:2048 nt lds
  v_mfma_f32_16x16x32_bf16 v[156:159], a[100:103], a[124:127], v[156:159]
  ds_read_b64_tr_b16 a[100:101], v18 offset:49160
  v_mfma_f32_16x16x32_bf16 v[160:163], a[104:107], a[112:115], v[160:163]
  ds_read_b64_tr_b16 a[102:103], v18 offset:51208
  v_mfma_f32_16x16x32_bf16 v[164:167], a[104:107], a[116:119], v[164:167]
  v_mfma_f32_16x16x32_bf16 v[168:171], a[104:107], a[120:123], v[168:171]
  v_mfma_f32_16x16x32_bf16 v[172:175], a[104:107], a[124:127], v[172:175]
  ds_read_b64_tr_b16 a[104:105], v19 offset:49152
  ds_read_b64_tr_b16 a[106:107], v19 offset:51200
  v_mfma_f32_16x16x32_bf16 v[176:179], a[108:111], a[112:115], v[176:179]
  buffer_load_dwordx4 v48, s[12:15], s42 offen offset:3072 nt lds
  s_add_u32 s42, s42, 262144
  v_mfma_f32_16x16x32_bf16 v[180:183], a[108:111], a[116:119], v[180:183]
  v_mfma_f32_16x16x32_bf16 v[184:187], a[108:111], a[120:123], v[184:187]
  v_mfma_f32_16x16x32_bf16 v[188:191], a[108:111], a[124:127], v[188:191]
  ds_read_b64_tr_b16 a[108:109], v19 offset:49160
  ds_read_b64_tr_b16 a[110:111], v19 offset:51208
  s_waitcnt lgkmcnt(4)
  v_mfma_f32_16x16x32_bf16 v[192:195], a[96:99], a[132:135], v[192:195]
  v_mfma_f32_16x16x32_bf16 v[196:199], a[96:99], a[136:139], v[196:199]
  s_add_u32 m0, s43, 32768
  s_nop 0
  buffer_load_dwordx4 v45, s[12:15], s42 offen offset:0 nt lds
  v_mfma_f32_16x16x32_bf16 v[200:203], a[96:99], a[140:143], v[200:203]
  v_mfma_f32_16x16x32_bf16 v[204:207], a[96:99], a[144:147], v[204:207]
  v_mfma_f32_16x16x32_bf16 v[208:211], a[96:99], a[148:151], v[208:211]
  ds_read_b64_tr_b16 a[96:97], v20 offset:49152
  ds_read_b64_tr_b16 a[98:99], v20 offset:51200
  v_mfma_f32_16x16x32_bf16 v[212:215], a[100:103], a[132:135], v[212:215]
  v_mfma_f32_16x16x32_bf16 v[216:219], a[100:103], a[136:139], v[216:219]
  buffer_load_dwordx4 v46, s[12:15], s42 offen offset:1024 nt lds
  v_mfma_f32_16x16x32_bf16 v[220:223], a[100:103], a[140:143], v[220:223]
  v_mfma_f32_16x16x32_bf16 v[224:227], a[100:103], a[144:147], v[224:227]
  v_mfma_f32_16x16x32_bf16 v[228:231], a[100:103], a[148:151], v[228:231]
  ds_read_b64_tr_b16 a[100:101], v20 offset:49160
  s_waitcnt lgkmcnt(3)
  v_mfma_f32_16x16x32_bf16 v[232:235], a[104:107], a[132:135], v[232:235]
  ds_read_b64_tr_b16 a[102:103], v20 offset:51208
  v_mfma_f32_16x16x32_bf16 v[236:239], a[104:107], a[136:139], v[236:239]
  buffer_load_dwordx4 v47, s[12:15], s42 offen offset:2048 nt lds
  v_mfma_f32_16x16x32_bf16 v[240:243], a[104:107], a[140:143], v[240:243]
  v_mfma_f32_16x16x32_bf16 v[244:247], a[104:107], a[144:147], v[244:247]
  v_mfma_f32_16x16x32_bf16 v[248:251], a[104:107], a[148:151], v[248:251]
  ds_read_b64_tr_b16 a[104:105], v21 offset:49152
  ds_read_b64_tr_b16 a[106:107], v21 offset:51200
  v_mfma_f32_16x16x32_bf16 v[252:255], a[108:111], a[132:135], v[252:255]
  v_mfma_f32_16x16x32_bf16 a[0:3], a[108:111], a[136:139], a[0:3]
  buffer_load_dwordx4 v48, s[12:15], s42 offen offset:3072 nt lds
  s_add_u32 s42, s42, 262144
  v_mfma_f32_16x16x32_bf16 a[4:7], a[108:111], a[140:143], a[4:7]
  v_mfma_f32_16x16x32_bf16 a[8:11], a[108:111], a[144:147], a[8:11]
  v_mfma_f32_16x16x32_bf16 a[12:15], a[108:111], a[148:151], a[12:15]
  ds_read_b64_tr_b16 a[108:109], v21 offset:49160
  s_waitcnt lgkmcnt(3)
  v_mfma_f32_16x16x32_bf16 a[16:19], a[96:99], a[132:135], a[16:19]
  ds_read_b64_tr_b16 a[110:111], v21 offset:51208
  v_mfma_f32_16x16x32_bf16 a[20:23], a[96:99], a[136:139], a[20:23]
  v_mfma_f32_16x16x32_bf16 a[24:27], a[96:99], a[140:143], a[24:27]
  v_mfma_f32_16x16x32_bf16 a[28:31], a[96:99], a[144:147], a[28:31]
  v_mfma_f32_16x16x32_bf16 a[32:35], a[96:99], a[148:151], a[32:35]
  ds_read_b64_tr_b16 a[96:97], v26 offset:49152
  ds_read_b64_tr_b16 a[98:99], v26 offset:51200
  v_mfma_f32_16x16x32_bf16 a[36:39], a[100:103], a[132:135], a[36:39]
  v_mfma_f32_16x16x32_bf16 a[40:43], a[100:103], a[136:139], a[40:43]
  v_mfma_f32_16x16x32_bf16 a[44:47], a[100:103], a[140:143], a[44:47]
  v_mfma_f32_16x16x32_bf16 a[48:51], a[100:103], a[144:147], a[48:51]
  v_mfma_f32_16x16x32_bf16 a[52:55], a[100:103], a[148:151], a[52:55]
  ds_read_b64_tr_b16 a[100:101], v26 offset:49160
  s_waitcnt lgkmcnt(3)
  v_mfma_f32_16x16x32_bf16 a[56:59], a[104:107], a[132:135], a[56:59]
  ds_read_b64_tr_b16 a[102:103], v26 offset:51208
  v_mfma_f32_16x16x32_bf16 a[60:63], a[104:107], a[136:139], a[60:63]
  v_mfma_f32_16x16x32_bf16 a[64:67], a[104:107], a[140:143], a[64:67]
  v_mfma_f32_16x16x32_bf16 a[68:71], a[104:107], a[144:147], a[68:71]
  v_mfma_f32_16x16x32_bf16 a[72:75], a[104:107], a[148:151], a[72:75]
  ds_read_b64_tr_b16 a[104:105], v27 offset:49152
  ds_read_b64_tr_b16 a[106:107], v27 offset:51200
  v_mfma_f32_16x16x32_bf16 a[76:79], a[108:111], a[132:135], a[76:79]
  v_mfma_f32_16x16x32_bf16 a[80:83], a[108:111], a[136:139], a[80:83]
  v_mfma_f32_16x16x32_bf16 a[84:87], a[108:111], a[140:143], a[84:87]
  v_mfma_f32_16x16x32_bf16 a[88:91], a[108:111], a[144:147], a[88:91]
  v_mfma_f32_16x16x32_bf16 a[92:95], a[108:111], a[148:151], a[92:95]
  ds_read_b64_tr_b16 a[108:109], v27 offset:49160
  s_waitcnt lgkmcnt(3)
  v_mfma_f32_16x16x32_bf16 v[64:67], a[96:99], a[132:135], v[64:67]
  ds_read_b64_tr_b16 a[110:111], v27 offset:51208
  v_mfma_f32_16x16x32_bf16 v[68:71], a[96:99], a[136:139], v[68:71]
  v_mfma_f32_16x16x32_bf16 v[72:75], a[96:99], a[140:143], v[72:75]
  v_mfma_f32_16x16x32_bf16 v[76:79], a[96:99], a[144:147], v[76:79]
  ds_read_b64_tr_b16 a[96:97], v28 offset:49152
  ds_read_b64_tr_b16 a[98:99], v28 offset:51200
  v_mfma_f32_16x16x32_bf16 v[80:83], a[100:103], a[132:135], v[80:83]
  v_mfma_f32_16x16x32_bf16 v[84:87], a[100:103], a[136:139], v[84:87]
  v_mfma_f32_16x16x32_bf16 v[88:91], a[100:103], a[140:143], v[88:91]
  v_mfma_f32_16x16x32_bf16 v[92:95], a[100:103], a[144:147], v[92:95]
  ds_read_b64_tr_b16 a[100:101], v28 offset:49160
  s_waitcnt lgkmcnt(3)
  v_mfma_f32_16x16x32_bf16 v[96:99], a[104:107], a[132:135], v[96:99]
  ds_read_b64_tr_b16 a[102:103], v28 offset:51208
  v_mfma_f32_16x16x32_bf16 v[100:103], a[104:107], a[136:139], v[100:103]
  v_mfma_f32_16x16x32_bf16 v[104:107], a[104:107], a[140:143], v[104:107]
  v_mfma_f32_16x16x32_bf16 v[108:111], a[104:107], a[144:147], v[108:111]
  ds_read_b64_tr_b16 a[104:105], v29 offset:49152
  ds_read_b64_tr_b16 a[106:107], v29 offset:51200
  v_mfma_f32_16x16x32_bf16 v[112:115], a[108:111], a[132:135], v[112:115]
  v_mfma_f32_16x16x32_bf16 v[116:119], a[108:111], a[136:139], v[116:119]
  v_mfma_f32_16x16x32_bf16 v[120:123], a[108:111], a[140:143], v[120:123]
  v_mfma_f32_16x16x32_bf16 v[124:127], a[108:111], a[144:147], v[124:127]
  ds_read_b64_tr_b16 a[108:109], v29 offset:49160
  s_waitcnt lgkmcnt(3)
  v_mfma_f32_16x16x32_bf16 v[128:131], a[96:99], a[132:135], v[128:131]
  ds_read_b64_tr_b16 a[110:111], v29 offset:51208
  v_mfma_f32_16x16x32_bf16 v[132:135], a[96:99], a[136:139], v[132:135]
  v_mfma_f32_16x16x32_bf16 v[136:139], a[96:99], a[140:143], v[136:139]
  s_waitcnt vmcnt(8)
  s_waitcnt lgkmcnt(0)
  s_barrier
  v_mfma_f32_16x16x32_bf16 v[140:143], a[96:99], a[144:147], v[140:143]
  ds_read_b128 a[112:115], v16 offset:0
  ds_read_b128 a[116:119], v16 offset:2048
  v_mfma_f32_16x16x32_bf16 v[144:147], a[100:103], a[132:135], v[144:147]
  ds_read_b128 a[120:123], v16 offset:4096
  ds_read_b128 a[124:127], v16 offset:6144
  v_mfma_f32_16x16x32_bf16 v[148:151], a[100:103], a[136:139], v[148:151]
  ds_read_b128 a[128:131], v10 offset:0
  ds_read_b64_tr_b16 a[96:97], v18 offset:0
  v_mfma_f32_16x16x32_bf16 v[152:155], a[100:103], a[140:143], v[152:155]
  ds_read_b64_tr_b16 a[98:99], v18 offset:2048
  v_mfma_f32_16x16x32_bf16 v[156:159], a[100:103], a[144:147], v[156:159]
  ds_read_b64_tr_b16 a[100:101], v18 offset:8
  v_mfma_f32_16x16x32_bf16 v[160:163], a[104:107], a[132:135], v[160:163]
  ds_read_b64_tr_b16 a[102:103], v18 offset:2056
  v_mfma_f32_16x16x32_bf16 v[164:167], a[104:107], a[136:139], v[164:167]
  v_mfma_f32_16x16x32_bf16 v[168:171], a[104:107], a[140:143], v[168:171]
  v_mfma_f32_16x16x32_bf16 v[172:175], a[104:107], a[144:147], v[172:175]
  ds_read_b64_tr_b16 a[104:105], v19 offset:0
  ds_read_b64_tr_b16 a[106:107], v19 offset:2048
  v_mfma_f32_16x16x32_bf16 v[176:179], a[108:111], a[132:135], v[176:179]
  v_mfma_f32_16x16x32_bf16 v[180:183], a[108:111], a[136:139], v[180:183]
  v_mfma_f32_16x16x32_bf16 v[184:187], a[108:111], a[140:143], v[184:187]
  v_mfma_f32_16x16x32_bf16 v[188:191], a[108:111], a[144:147], v[188:191]
  ds_read_b64_tr_b16 a[108:109], v19 offset:8
  ds_read_b64_tr_b16 a[110:111], v19 offset:2056
  s_waitcnt lgkmcnt(4)
  v_mfma_f32_16x16x32_bf16 v[192:195], a[96:99], a[112:115], v[192:195]
  v_mfma_f32_16x16x32_bf16 v[196:199], a[96:99], a[116:119], v[196:199]
  s_add_u32 m0, s45, 36864
  s_nop 0
  buffer_load_dwordx4 v40, s[8:11], s41 offen offset:0 nt lds
  v_mfma_f32_16x16x32_bf16 v[200:203], a[96:99], a[120:123], v[200:203]
  v_mfma_f32_16x16x32_bf16 v[204:207], a[96:99], a[124:127], v[204:207]
  v_mfma_f32_16x16x32_bf16 v[208:211], a[96:99], a[128:131], v[208:211]
  ds_read_b64_tr_b16 a[96:97], v20 offset:0
  ds_read_b64_tr_b16 a[98:99], v20 offset:2048
  v_mfma_f32_16x16x32_bf16 v[212:215], a[100:103], a[112:115], v[212:215]
  v_mfma_f32_16x16x32_bf16 v[216:219], a[100:103], a[116:119], v[216:219]
  buffer_load_dwordx4 v41, s[8:11], s41 offen offset:1024 nt lds
  v_mfma_f32_16x16x32_bf16 v[220:223], a[100:103], a[120:123], v[220:223]
  v_mfma_f32_16x16x32_bf16 v[224:227], a[100:103], a[124:127], v[224:227]
  v_mfma_f32_16x16x32_bf16 v[228:231], a[100:103], a[128:131], v[228:231]
  ds_read_b64_tr_b16 a[100:101], v20 offset:8
  s_waitcnt lgkmcnt(3)
  v_mfma_f32_16x16x32_bf16 v[232:235], a[104:107], a[112:115], v[232:235]
  ds_read_b64_tr_b16 a[102:103], v20 offset:2056
  v_mfma_f32_16x16x32_bf16 v[236:239], a[104:107], a[116:119], v[236:239]
  buffer_load_dwordx4 v42, s[8:11], s41 offen offset:2048 nt lds
  v_mfma_f32_16x16x32_bf16 v[240:243], a[104:107], a[120:123], v[240:243]
  v_mfma_f32_16x16x32_bf16 v[244:247], a[104:107], a[124:127], v[244:247]
  v_mfma_f32_16x16x32_bf16 v[248:251], a[104:107], a[128:131], v[248:251]
  ds_read_b64_tr_b16 a[104:105], v21 offset:0
  ds_read_b64_tr_b16 a[106:107], v21 offset:2048
  v_mfma_f32_16x16x32_bf16 v[252:255], a[108:111], a[112:115], v[252:255]
  v_mfma_f32_16x16x32_bf16 a[0:3], a[108:111], a[116:119], a[0:3]
  buffer_load_dwordx4 v43, s[8:11], s41 offen offset:3072 nt lds
  v_mfma_f32_16x16x32_bf16 a[4:7], a[108:111], a[120:123], a[4:7]
  v_mfma_f32_16x16x32_bf16 a[8:11], a[108:111], a[124:127], a[8:11]
  v_mfma_f32_16x16x32_bf16 a[12:15], a[108:111], a[128:131], a[12:15]
  ds_read_b64_tr_b16 a[108:109], v21 offset:8
  s_waitcnt lgkmcnt(3)
  v_mfma_f32_16x16x32_bf16 a[16:19], a[96:99], a[112:115], a[16:19]
  ds_read_b64_tr_b16 a[110:111], v21 offset:2056
  v_mfma_f32_16x16x32_bf16 a[20:23], a[96:99], a[116:119], a[20:23]
  s_add_u32 m0, s45, 40960
  s_add_u32 s37, s41, 40960
  v_mfma_f32_16x16x32_bf16 a[24:27], a[96:99], a[120:123], a[24:27]
  buffer_load_dwordx4 v40, s[8:11], s37 offen offset:0 nt lds
  v_mfma_f32_16x16x32_bf16 a[28:31], a[96:99], a[124:127], a[28:31]
  v_mfma_f32_16x16x32_bf16 a[32:35], a[96:99], a[128:131], a[32:35]
  ds_read_b64_tr_b16 a[96:97], v26 offset:0
  ds_read_b64_tr_b16 a[98:99], v26 offset:2048
  v_mfma_f32_16x16x32_bf16 a[36:39], a[100:103], a[112:115], a[36:39]
  v_mfma_f32_16x16x32_bf16 a[40:43], a[100:103], a[116:119], a[40:43]
  v_mfma_f32_16x16x32_bf16 a[44:47], a[100:103], a[120:123], a[44:47]
  buffer_load_dwordx4 v41, s[8:11], s37 offen offset:1024 nt lds
  v_mfma_f32_16x16x32_bf16 a[48:51], a[100:103], a[124:127], a[48:51]
  v_mfma_f32_16x16x32_bf16 a[52:55], a[100:103], a[128:131], a[52:55]
  ds_read_b64_tr_b16 a[100:101], v26 offset:8
  s_waitcnt lgkmcnt(3)
  v_mfma_f32_16x16x32_bf16 a[56:59], a[104:107], a[112:115], a[56:59]
  ds_read_b64_tr_b16 a[102:103], v26 offset:2056
  v_mfma_f32_16x16x32_bf16 a[60:63], a[104:107], a[116:119], a[60:63]
  v_mfma_f32_16x16x32_bf16 a[64:67], a[104:107], a[120:123], a[64:67]
  buffer_load_dwordx4 v42, s[8:11], s37 offen offset:2048 nt lds
  v_mfma_f32_16x16x32_bf16 a[68:71], a[104:107], a[124:127], a[68:71]
  v_mfma_f32_16x16x32_bf16 a[72:75], a[104:107], a[128:131], a[72:75]
  ds_read_b64_tr_b16 a[104:105], v27 offset:0
  ds_read_b64_tr_b16 a[106:107], v27 offset:2048
  v_mfma_f32_16x16x32_bf16 a[76:79], a[108:111], a[112:115], a[76:79]
  v_mfma_f32_16x16x32_bf16 a[80:83], a[108:111], a[116:119], a[80:83]
  v_mfma_f32_16x16x32_bf16 a[84:87], a[108:111], a[120:123], a[84:87]
  buffer_load_dwordx4 v43, s[8:11], s37 offen offset:3072 nt lds
  v_mfma_f32_16x16x32_bf16 a[88:91], a[108:111], a[124:127], a[88:91]
  v_mfma_f32_16x16x32_bf16 a[92:95], a[108:111], a[128:131], a[92:95]
  ds_read_b64_tr_b16 a[108:109], v27 offset:8
  s_waitcnt lgkmcnt(3)
  v_mfma_f32_16x16x32_bf16 v[64:67], a[96:99], a[112:115], v[64:67]
  ds_read_b64_tr_b16 a[110:111], v27 offset:2056
  v_mfma_f32_16x16x32_bf16 v[68:71], a[96:99], a[116:119], v[68:71]
  v_mfma_f32_16x16x32_bf16 v[72:75], a[96:99], a[120:123], v[72:75]
  s_add_u32 m0, s45, 45056
  s_add_u32 s37, s41, 81920
  v_mfma_f32_16x16x32_bf16 v[76:79], a[96:99], a[124:127], v[76:79]
  ds_read_b64_tr_b16 a[96:97], v28 offset:0
  ds_read_b64_tr_b16 a[98:99], v28 offset:2048
  v_mfma_f32_16x16x32_bf16 v[80:83], a[100:103], a[112:115], v[80:83]
  buffer_load_dwordx4 v40, s[8:11], s37 offen offset:0 nt lds
  s_add_u32 s41, s41, 128
  v_mfma_f32_16x16x32_bf16 v[84:87], a[100:103], a[116:119], v[84:87]
  v_mfma_f32_16x16x32_bf16 v[88:91], a[100:103], a[120:123], v[88:91]
  v_mfma_f32_16x16x32_bf16 v[92:95], a[100:103], a[124:127], v[92:95]
  ds_read_b64_tr_b16 a[100:101], v28 offset:8
  s_waitcnt lgkmcnt(3)
  v_mfma_f32_16x16x32_bf16 v[96:99], a[104:107], a[112:115], v[96:99]
  ds_read_b64_tr_b16 a[102:103], v28 offset:2056
  v_mfma_f32_16x16x32_bf16 v[100:103], a[104:107], a[116:119], v[100:103]
  s_add_u32 m0, s43, 49152
  s_nop 0
  buffer_load_dwordx4 v45, s[12:15], s42 offen offset:0 nt lds
  v_mfma_f32_16x16x32_bf16 v[104:107], a[104:107], a[120:123], v[104:107]
  v_mfma_f32_16x16x32_bf16 v[108:111], a[104:107], a[124:127], v[108:111]
  ds_read_b64_tr_b16 a[104:105], v29 offset:0
  ds_read_b64_tr_b16 a[106:107], v29 offset:2048
  v_mfma_f32_16x16x32_bf16 v[112:115], a[108:111], a[112:115], v[112:115]
  v_mfma_f32_16x16x32_bf16 v[116:119], a[108:111], a[116:119], v[116:119]
  v_mfma_f32_16x16x32_bf16 v[120:123], a[108:111], a[120:123], v[120:123]
  buffer_load_dwordx4 v46, s[12:15], s42 offen offset:1024 nt lds
  v_mfma_f32_16x16x32_bf16 v[124:127], a[108:111], a[124:127], v[124:127]
  ds_read_b64_tr_b16 a[108:109], v29 offset:8
  s_waitcnt lgkmcnt(3)
  v_mfma_f32_16x16x32_bf16 v[128:131], a[96:99], a[112:115], v[128:131]
  ds_read_b64_tr_b16 a[110:111], v29 offset:2056
  v_mfma_f32_16x16x32_bf16 v[132:135], a[96:99], a[116:119], v[132:135]
  v_mfma_f32_16x16x32_bf16 v[136:139], a[96:99], a[120:123], v[136:139]
  s_waitcnt vmcnt(15)
  s_waitcnt lgkmcnt(0)
  s_barrier
  v_mfma_f32_16x16x32_bf16 v[140:143], a[96:99], a[124:127], v[140:143]
  ds_read_b128 a[132:135], v17 offset:0
  ds_read_b128 a[136:139], v17 offset:2048
  v_mfma_f32_16x16x32_bf16 v[144:147], a[100:103], a[112:115], v[144:147]
  ds_read_b128 a[140:143], v17 offset:4096
  ds_read_b128 a[144:147], v17 offset:6144
  v_mfma_f32_16x16x32_bf16 v[148:151], a[100:103], a[116:119], v[148:151]
  ds_read_b128 a[148:151], v11 offset:0
  ds_read_b64_tr_b16 a[96:97], v18 offset:16384
  v_mfma_f32_16x16x32_bf16 v[152:155], a[100:103], a[120:123], v[152:155]
  ds_read_b64_tr_b16 a[98:99], v18 offset:18432
  buffer_load_dwordx4 v47, s[12:15], s42 offen offset:2048 nt lds
  v_mfma_f32_16x16x32_bf16 v[156:159], a[100:103], a[124:127], v[156:159]
  ds_read_b64_tr_b16 a[100:101], v18 offset:16392
  v_mfma_f32_16x16x32_bf16 v[160:163], a[104:107], a[112:115], v[160:163]
  ds_read_b64_tr_b16 a[102:103], v18 offset:18440
  v_mfma_f32_16x16x32_bf16 v[164:167], a[104:107], a[116:119], v[164:167]
  v_mfma_f32_16x16x32_bf16 v[168:171], a[104:107], a[120:123], v[168:171]
  v_mfma_f32_16x16x32_bf16 v[172:175], a[104:107], a[124:127], v[172:175]
  ds_read_b64_tr_b16 a[104:105], v19 offset:16384
  ds_read_b64_tr_b16 a[106:107], v19 offset:18432
  v_mfma_f32_16x16x32_bf16 v[176:179], a[108:111], a[112:115], v[176:179]
  buffer_load_dwordx4 v48, s[12:15], s42 offen offset:3072 nt lds
  s_add_u32 s42, s42, 262144
  v_mfma_f32_16x16x32_bf16 v[180:183], a[108:111], a[116:119], v[180:183]
  v_mfma_f32_16x16x32_bf16 v[184:187], a[108:111], a[120:123], v[184:187]
  v_mfma_f32_16x16x32_bf16 v[188:191], a[108:111], a[124:127], v[188:191]
  ds_read_b64_tr_b16 a[108:109], v19 offset:16392
  ds_read_b64_tr_b16 a[110:111], v19 offset:18440
  s_sub_u32 s44, s44, 1
  s_cmp_lg_u32 s44, 0
  s_cbranch_scc1 K1_QLOOP
  s_waitcnt lgkmcnt(4)
  v_mfma_f32_16x16x32_bf16 v[192:195], a[96:99], a[132:135], v[192:195]
  v_mfma_f32_16x16x32_bf16 v[196:199], a[96:99], a[136:139], v[196:199]
  s_mul_i32 s39, s32, 5120
  s_add_u32 m0, s39, 139264
  v_mfma_f32_16x16x32_bf16 v[200:203], a[96:99], a[140:143], v[200:203]
  s_add_u32 s40, s39, 20480
  v_mfma_f32_16x16x32_bf16 v[204:207], a[96:99], a[144:147], v[204:207]
  v_mfma_f32_16x16x32_bf16 v[208:211], a[96:99], a[148:151], v[208:211]
  ds_read_b64_tr_b16 a[96:97], v20 offset:16384
  ds_read_b64_tr_b16 a[98:99], v20 offset:18432
  v_mfma_f32_16x16x32_bf16 v[212:215], a[100:103], a[132:135], v[212:215]
  v_mfma_f32_16x16x32_bf16 v[216:219], a[100:103], a[136:139], v[216:219]
  v_mfma_f32_16x16x32_bf16 v[220:223], a[100:103], a[140:143], v[220:223]
  buffer_load_dwordx4 v7, s[28:31], s40 offen offset:0 nt lds
  v_mfma_f32_16x16x32_bf16 v[224:227], a[100:103], a[144:147], v[224:227]
  v_mfma_f32_16x16x32_bf16 v[228:231], a[100:103], a[148:151], v[228:231]
  ds_read_b64_tr_b16 a[100:101], v20 offset:16392
  s_waitcnt lgkmcnt(3)
  v_mfma_f32_16x16x32_bf16 v[232:235], a[104:107], a[132:135], v[232:235]
  ds_read_b64_tr_b16 a[102:103], v20 offset:18440
  v_mfma_f32_16x16x32_bf16 v[236:239], a[104:107], a[136:139], v[236:239]
  v_mfma_f32_16x16x32_bf16 v[240:243], a[104:107], a[140:143], v[240:243]
  buffer_load_dwordx4 v7, s[28:31], s40 offen offset:1024 nt lds
  v_mfma_f32_16x16x32_bf16 v[244:247], a[104:107], a[144:147], v[244:247]
  v_mfma_f32_16x16x32_bf16 v[248:251], a[104:107], a[148:151], v[248:251]
  ds_read_b64_tr_b16 a[104:105], v21 offset:16384
  ds_read_b64_tr_b16 a[106:107], v21 offset:18432
  v_mfma_f32_16x16x32_bf16 v[252:255], a[108:111], a[132:135], v[252:255]
  v_mfma_f32_16x16x32_bf16 a[0:3], a[108:111], a[136:139], a[0:3]
  v_mfma_f32_16x16x32_bf16 a[4:7], a[108:111], a[140:143], a[4:7]
  buffer_load_dwordx4 v7, s[28:31], s40 offen offset:2048 nt lds
  v_mfma_f32_16x16x32_bf16 a[8:11], a[108:111], a[144:147], a[8:11]
  v_mfma_f32_16x16x32_bf16 a[12:15], a[108:111], a[148:151], a[12:15]
  ds_read_b64_tr_b16 a[108:109], v21 offset:16392
  s_waitcnt lgkmcnt(3)
  v_mfma_f32_16x16x32_bf16 a[16:19], a[96:99], a[132:135], a[16:19]
  ds_read_b64_tr_b16 a[110:111], v21 offset:18440
  v_mfma_f32_16x16x32_bf16 a[20:23], a[96:99], a[136:139], a[20:23]
  v_mfma_f32_16x16x32_bf16 a[24:27], a[96:99], a[140:143], a[24:27]
  buffer_load_dwordx4 v7, s[28:31], s40 offen offset:3072 nt lds
  v_mfma_f32_16x16x32_bf16 a[28:31], a[96:99], a[144:147], a[28:31]
  v_mfma_f32_16x16x32_bf16 a[32:35], a[96:99], a[148:151], a[32:35]
  ds_read_b64_tr_b16 a[96:97], v26 offset:16384
  ds_read_b64_tr_b16 a[98:99], v26 offset:18432
  v_mfma_f32_16x16x32_bf16 a[36:39], a[100:103], a[132:135], a[36:39]
  v_mfma_f32_16x16x32_bf16 a[40:43], a[100:103], a[136:139], a[40:43]
  v_mfma_f32_16x16x32_bf16 a[44:47], a[100:103], a[140:143], a[44:47]
  s_add_u32 m0, s39, 143360
  s_add_u32 s40, s40, 4096
  v_mfma_f32_16x16x32_bf16 a[48:51], a[100:103], a[144:147], a[48:51]
  buffer_load_dwordx4 v7, s[28:31], s40 offen nt lds
  v_mfma_f32_16x16x32_bf16 a[52:55], a[100:103], a[148:151], a[52:55]
  ds_read_b64_tr_b16 a[100:101], v26 offset:16392
  s_waitcnt lgkmcnt(3)
  v_mfma_f32_16x16x32_bf16 a[56:59], a[104:107], a[132:135], a[56:59]
  ds_read_b64_tr_b16 a[102:103], v26 offset:18440
  v_mfma_f32_16x16x32_bf16 a[60:63], a[104:107], a[136:139], a[60:63]
  v_mfma_f32_16x16x32_bf16 a[64:67], a[104:107], a[140:143], a[64:67]
  v_mfma_f32_16x16x32_bf16 a[68:71], a[104:107], a[144:147], a[68:71]
  s_add_u32 m0, s43, 0
  s_nop 0
  buffer_load_dwordx4 v34, s[16:19], s47 offen offset:0 nt lds
  v_mfma_f32_16x16x32_bf16 a[72:75], a[104:107], a[148:151], a[72:75]
  ds_read_b64_tr_b16 a[104:105], v27 offset:16384
  ds_read_b64_tr_b16 a[106:107], v27 offset:18432
  v_mfma_f32_16x16x32_bf16 a[76:79], a[108:111], a[132:135], a[76:79]
  v_mfma_f32_16x16x32_bf16 a[80:83], a[108:111], a[136:139], a[80:83]
  v_mfma_f32_16x16x32_bf16 a[84:87], a[108:111], a[140:143], a[84:87]
  v_mfma_f32_16x16x32_bf16 a[88:91], a[108:111], a[144:147], a[88:91]
  buffer_load_dwordx4 v35, s[16:19], s47 offen offset:1024 nt lds
  v_mfma_f32_16x16x32_bf16 a[92:95], a[108:111], a[148:151], a[92:95]
  ds_read_b64_tr_b16 a[108:109], v27 offset:16392
  s_waitcnt lgkmcnt(3)
  v_mfma_f32_16x16x32_bf16 v[64:67], a[96:99], a[132:135], v[64:67]
  ds_read_b64_tr_b16 a[110:111], v27 offset:18440
  v_mfma_f32_16x16x32_bf16 v[68:71], a[96:99], a[136:139], v[68:71]
  v_mfma_f32_16x16x32_bf16 v[72:75], a[96:99], a[140:143], v[72:75]
  v_mfma_f32_16x16x32_bf16 v[76:79], a[96:99], a[144:147], v[76:79]
  ds_read_b64_tr_b16 a[96:97], v28 offset:16384
  ds_read_b64_tr_b16 a[98:99], v28 offset:18432
  v_mfma_f32_16x16x32_bf16 v[80:83], a[100:103], a[132:135], v[80:83]
  buffer_load_dwordx4 v36, s[16:19], s47 offen offset:2048 nt lds
  v_mfma_f32_16x16x32_bf16 v[84:87], a[100:103], a[136:139], v[84:87]
  v_mfma_f32_16x16x32_bf16 v[88:91], a[100:103], a[140:143], v[88:91]
  v_mfma_f32_16x16x32_bf16 v[92:95], a[100:103], a[144:147], v[92:95]
  ds_read_b64_tr_b16 a[100:101], v28 offset:16392
  s_waitcnt lgkmcnt(3)
  v_mfma_f32_16x16x32_bf16 v[96:99], a[104:107], a[132:135], v[96:99]
  ds_read_b64_tr_b16 a[102:103], v28 offset:18440
  v_mfma_f32_16x16x32_bf16 v[100:103], a[104:107], a[136:139], v[100:103]
  buffer_load_dwordx4 v37, s[16:19], s47 offen offset:3072 nt lds
  s_add_u32 s47, s47, 16384
  v_mfma_f32_16x16x32_bf16 v[104:107], a[104:107], a[140:143], v[104:107]
  v_mfma_f32_16x16x32_bf16 v[108:111], a[104:107], a[144:147], v[108:111]
  ds_read_b64_tr_b16 a[104:105], v29 offset:16384
  ds_read_b64_tr_b16 a[106:107], v29 offset:18432
  v_mfma_f32_16x16x32_bf16 v[112:115], a[108:111], a[132:135], v[112:115]
  v_mfma_f32_16x16x32_bf16 v[116:119], a[108:111], a[136:139], v[116:119]
  v_mfma_f32_16x16x32_bf16 v[120:123], a[108:111], a[140:143], v[120:123]
  v_mfma_f32_16x16x32_bf16 v[124:127], a[108:111], a[144:147], v[124:127]
  ds_read_b64_tr_b16 a[108:109], v29 offset:16392
  s_waitcnt lgkmcnt(3)
  v_mfma_f32_16x16x32_bf16 v[128:131], a[96:99], a[132:135], v[128:131]
  ds_read_b64_tr_b16 a[110:111], v29 offset:18440
  v_mfma_f32_16x16x32_bf16 v[132:135], a[96:99], a[136:139], v[132:135]
  v_mfma_f32_16x16x32_bf16 v[136:139], a[96:99], a[140:143], v[136:139]
  s_waitcnt vmcnt(13)
  s_waitcnt lgkmcnt(0)
  s_barrier
  v_mfma_f32_16x16x32_bf16 v[140:143], a[96:99], a[144:147], v[140:143]
  ds_read_b128 a[112:115], v16 offset:36864
  ds_read_b128 a[116:119], v16 offset:38912
  v_mfma_f32_16x16x32_bf16 v[144:147], a[100:103], a[132:135], v[144:147]
  ds_read_b128 a[120:123], v16 offset:40960
  ds_read_b128 a[124:127], v16 offset:43008
  v_mfma_f32_16x16x32_bf16 v[148:151], a[100:103], a[136:139], v[148:151]
  ds_read_b128 a[128:131], v10 offset:36864
  ds_read_b64_tr_b16 a[96:97], v18 offset:32768
  v_mfma_f32_16x16x32_bf16 v[152:155], a[100:103], a[140:143], v[152:155]
  ds_read_b64_tr_b16 a[98:99], v18 offset:34816
  v_mfma_f32_16x16x32_bf16 v[156:159], a[100:103], a[144:147], v[156:159]
  ds_read_b64_tr_b16 a[100:101], v18 offset:32776
  v_mfma_f32_16x16x32_bf16 v[160:163], a[104:107], a[132:135], v[160:163]
  ds_read_b64_tr_b16 a[102:103], v18 offset:34824
  v_mfma_f32_16x16x32_bf16 v[164:167], a[104:107], a[136:139], v[164:167]
  v_mfma_f32_16x16x32_bf16 v[168:171], a[104:107], a[140:143], v[168:171]
  v_mfma_f32_16x16x32_bf16 v[172:175], a[104:107], a[144:147], v[172:175]
  ds_read_b64_tr_b16 a[104:105], v19 offset:32768
  ds_read_b64_tr_b16 a[106:107], v19 offset:34816
  v_mfma_f32_16x16x32_bf16 v[176:179], a[108:111], a[132:135], v[176:179]
  v_mfma_f32_16x16x32_bf16 v[180:183], a[108:111], a[136:139], v[180:183]
  v_mfma_f32_16x16x32_bf16 v[184:187], a[108:111], a[140:143], v[184:187]
  v_mfma_f32_16x16x32_bf16 v[188:191], a[108:111], a[144:147], v[188:191]
  ds_read_b64_tr_b16 a[108:109], v19 offset:32776
  ds_read_b64_tr_b16 a[110:111], v19 offset:34824
  s_waitcnt lgkmcnt(4)
  v_mfma_f32_16x16x32_bf16 v[192:195], a[96:99], a[112:115], v[192:195]
  v_mfma_f32_16x16x32_bf16 v[196:199], a[96:99], a[116:119], v[196:199]
  s_add_u32 m0, s43, 65536
  s_nop 0
  buffer_load_dwordx4 v38, s[20:23], s54 offen offset:0 nt lds
  v_mfma_f32_16x16x32_bf16 v[200:203], a[96:99], a[120:123], v[200:203]
  v_mfma_f32_16x16x32_bf16 v[204:207], a[96:99], a[124:127], v[204:207]
  v_mfma_f32_16x16x32_bf16 v[208:211], a[96:99], a[128:131], v[208:211]
  ds_read_b64_tr_b16 a[96:97], v20 offset:32768
  ds_read_b64_tr_b16 a[98:99], v20 offset:34816
  v_mfma_f32_16x16x32_bf16 v[212:215], a[100:103], a[112:115], v[212:215]
  v_mfma_f32_16x16x32_bf16 v[216:219], a[100:103], a[116:119], v[216:219]
  buffer_load_dwordx4 v39, s[20:23], s54 offen offset:1024 nt lds
  v_mfma_f32_16x16x32_bf16 v[220:223], a[100:103], a[120:123], v[220:223]
  v_mfma_f32_16x16x32_bf16 v[224:227], a[100:103], a[124:127], v[224:227]
  v_mfma_f32_16x16x32_bf16 v[228:231], a[100:103], a[128:131], v[228:231]
  ds_read_b64_tr_b16 a[100:101], v20 offset:32776
  s_waitcnt lgkmcnt(3)
  v_mfma_f32_16x16x32_bf16 v[232:235], a[104:107], a[112:115], v[232:235]
  ds_read_b64_tr_b16 a[102:103], v20 offset:34824
  v_mfma_f32_16x16x32_bf16 v[236:239], a[104:107], a[116:119], v[236:239]
  buffer_load_dwordx4 v38, s[20:23], s54 offen offset:2048 nt lds
  v_mfma_f32_16x16x32_bf16 v[240:243], a[104:107], a[120:123], v[240:243]
  v_mfma_f32_16x16x32_bf16 v[244:247], a[104:107], a[124:127], v[244:247]
  v_mfma_f32_16x16x32_bf16 v[248:251], a[104:107], a[128:131], v[248:251]
  ds_read_b64_tr_b16 a[104:105], v21 offset:32768
  ds_read_b64_tr_b16 a[106:107], v21 offset:34816
  v_mfma_f32_16x16x32_bf16 v[252:255], a[108:111], a[112:115], v[252:255]
  v_mfma_f32_16x16x32_bf16 a[0:3], a[108:111], a[116:119], a[0:3]
  buffer_load_dwordx4 v39, s[20:23], s54 offen offset:3072 nt lds
  s_add_u32 s54, s54, 16384
  v_mfma_f32_16x16x32_bf16 a[4:7], a[108:111], a[120:123], a[4:7]
  v_mfma_f32_16x16x32_bf16 a[8:11], a[108:111], a[124:127], a[8:11]
  v_mfma_f32_16x16x32_bf16 a[12:15], a[108:111], a[128:131], a[12:15]
  ds_read_b64_tr_b16 a[108:109], v21 offset:32776
  s_waitcnt lgkmcnt(3)
  v_mfma_f32_16x16x32_bf16 a[16:19], a[96:99], a[112:115], a[16:19]
  ds_read_b64_tr_b16 a[110:111], v21 offset:34824
  v_mfma_f32_16x16x32_bf16 a[20:23], a[96:99], a[116:119], a[20:23]
  s_add_u32 m0, s43, 16384
  s_nop 0
  buffer_load_dwordx4 v34, s[16:19], s47 offen offset:0 nt lds
  v_mfma_f32_16x16x32_bf16 a[24:27], a[96:99], a[120:123], a[24:27]
  v_mfma_f32_16x16x32_bf16 a[28:31], a[96:99], a[124:127], a[28:31]
  v_mfma_f32_16x16x32_bf16 a[32:35], a[96:99], a[128:131], a[32:35]
  ds_read_b64_tr_b16 a[96:97], v26 offset:32768
  ds_read_b64_tr_b16 a[98:99], v26 offset:34816
  v_mfma_f32_16x16x32_bf16 a[36:39], a[100:103], a[112:115], a[36:39]
  v_mfma_f32_16x16x32_bf16 a[40:43], a[100:103], a[116:119], a[40:43]
  buffer_load_dwordx4 v35, s[16:19], s47 offen offset:1024 nt lds
  v_mfma_f32_16x16x32_bf16 a[44:47], a[100:103], a[120:123], a[44:47]
  v_mfma_f32_16x16x32_bf16 a[48:51], a[100:103], a[124:127], a[48:51]
  v_mfma_f32_16x16x32_bf16 a[52:55], a[100:103], a[128:131], a[52:55]
  ds_read_b64_tr_b16 a[100:101], v26 offset:32776
  s_waitcnt lgkmcnt(3)
  v_mfma_f32_16x16x32_bf16 a[56:59], a[104:107], a[112:115], a[56:59]
  ds_read_b64_tr_b16 a[102:103], v26 offset:34824
  v_mfma_f32_16x16x32_bf16 a[60:63], a[104:107], a[116:119], a[60:63]
  buffer_load_dwordx4 v36, s[16:19], s47 offen offset:2048 nt lds
  v_mfma_f32_16x16x32_bf16 a[64:67], a[104:107], a[120:123], a[64:67]
  v_mfma_f32_16x16x32_bf16 a[68:71], a[104:107], a[124:127], a[68:71]
  v_mfma_f32_16x16x32_bf16 a[72:75], a[104:107], a[128:131], a[72:75]
  ds_read_b64_tr_b16 a[104:105], v27 offset:32768
  ds_read_b64_tr_b16 a[106:107], v27 offset:34816
  v_mfma_f32_16x16x32_bf16 a[76:79], a[108:111], a[112:115], a[76:79]
  v_mfma_f32_16x16x32_bf16 a[80:83], a[108:111], a[116:119], a[80:83]
  buffer_load_dwordx4 v37, s[16:19], s47 offen offset:3072 nt lds
  s_add_u32 s47, s47, 16384
  v_mfma_f32_16x16x32_bf16 a[84:87], a[108:111], a[120:123], a[84:87]
  v_mfma_f32_16x16x32_bf16 a[88:91], a[108:111], a[124:127], a[88:91]
  v_mfma_f32_16x16x32_bf16 a[92:95], a[108:111], a[128:131], a[92:95]
  ds_read_b64_tr_b16 a[108:109], v27 offset:32776
  s_waitcnt lgkmcnt(3)
  v_mfma_f32_16x16x32_bf16 v[64:67], a[96:99], a[112:115], v[64:67]
  ds_read_b64_tr_b16 a[110:111], v27 offset:34824
  v_mfma_f32_16x16x32_bf16 v[68:71], a[96:99], a[116:119], v[68:71]
  v_mfma_f32_16x16x32_bf16 v[72:75], a[96:99], a[120:123], v[72:75]
  v_mfma_f32_16x16x32_bf16 v[76:79], a[96:99], a[124:127], v[76:79]
  ds_read_b64_tr_b16 a[96:97], v28 offset:32768
  ds_read_b64_tr_b16 a[98:99], v28 offset:34816
  v_mfma_f32_16x16x32_bf16 v[80:83], a[100:103], a[112:115], v[80:83]
  v_mfma_f32_16x16x32_bf16 v[84:87], a[100:103], a[116:119], v[84:87]
  v_mfma_f32_16x16x32_bf16 v[88:91], a[100:103], a[120:123], v[88:91]
  v_mfma_f32_16x16x32_bf16 v[92:95], a[100:103], a[124:127], v[92:95]
  ds_read_b64_tr_b16 a[100:101], v28 offset:32776
  s_waitcnt lgkmcnt(3)
  v_mfma_f32_16x16x32_bf16 v[96:99], a[104:107], a[112:115], v[96:99]
  ds_read_b64_tr_b16 a[102:103], v28 offset:34824
  v_mfma_f32_16x16x32_bf16 v[100:103], a[104:107], a[116:119], v[100:103]
  v_mfma_f32_16x16x32_bf16 v[104:107], a[104:107], a[120:123], v[104:107]
  v_mfma_f32_16x16x32_bf16 v[108:111], a[104:107], a[124:127], v[108:111]
  ds_read_b64_tr_b16 a[104:105], v29 offset:32768
  ds_read_b64_tr_b16 a[106:107], v29 offset:34816
  v_mfma_f32_16x16x32_bf16 v[112:115], a[108:111], a[112:115], v[112:115]
  v_mfma_f32_16x16x32_bf16 v[116:119], a[108:111], a[116:119], v[116:119]
  v_mfma_f32_16x16x32_bf16 v[120:123], a[108:111], a[120:123], v[120:123]
  v_mfma_f32_16x16x32_bf16 v[124:127], a[108:111], a[124:127], v[124:127]
  ds_read_b64_tr_b16 a[108:109], v29 offset:32776
  s_waitcnt lgkmcnt(3)
  v_mfma_f32_16x16x32_bf16 v[128:131], a[96:99], a[112:115], v[128:131]
  ds_read_b64_tr_b16 a[110:111], v29 offset:34824
  v_mfma_f32_16x16x32_bf16 v[132:135], a[96:99], a[116:119], v[132:135]
  v_mfma_f32_16x16x32_bf16 v[136:139], a[96:99], a[120:123], v[136:139]
  s_waitcnt vmcnt(17)
  s_waitcnt lgkmcnt(0)
  s_barrier
  v_mfma_f32_16x16x32_bf16 v[140:143], a[96:99], a[124:127], v[140:143]
  ds_read_b128 a[132:135], v17 offset:36864
  ds_read_b128 a[136:139], v17 offset:38912
  v_mfma_f32_16x16x32_bf16 v[144:147], a[100:103], a[112:115], v[144:147]
  ds_read_b128 a[140:143], v17 offset:40960
  ds_read_b128 a[144:147], v17 offset:43008
  v_mfma_f32_16x16x32_bf16 v[148:151], a[100:103], a[116:119], v[148:151]
  ds_read_b128 a[148:151], v11 offset:36864
  ds_read_b64_tr_b16 a[96:97], v18 offset:49152
  v_mfma_f32_16x16x32_bf16 v[152:155], a[100:103], a[120:123], v[152:155]
  ds_read_b64_tr_b16 a[98:99], v18 offset:51200
  v_mfma_f32_16x16x32_bf16 v[156:159], a[100:103], a[124:127], v[156:159]
  ds_read_b64_tr_b16 a[100:101], v18 offset:49160
  v_mfma_f32_16x16x32_bf16 v[160:163], a[104:107], a[112:115], v[160:163]
  ds_read_b64_tr_b16 a[102:103], v18 offset:51208
  v_mfma_f32_16x16x32_bf16 v[164:167], a[104:107], a[116:119], v[164:167]
  v_mfma_f32_16x16x32_bf16 v[168:171], a[104:107], a[120:123], v[168:171]
  v_mfma_f32_16x16x32_bf16 v[172:175], a[104:107], a[124:127], v[172:175]
  ds_read_b64_tr_b16 a[104:105], v19 offset:49152
  ds_read_b64_tr_b16 a[106:107], v19 offset:51200
  v_mfma_f32_16x16x32_bf16 v[176:179], a[108:111], a[112:115], v[176:179]
  v_mfma_f32_16x16x32_bf16 v[180:183], a[108:111], a[116:119], v[180:183]
  v_mfma_f32_16x16x32_bf16 v[184:187], a[108:111], a[120:123], v[184:187]
  v_mfma_f32_16x16x32_bf16 v[188:191], a[108:111], a[124:127], v[188:191]
  ds_read_b64_tr_b16 a[108:109], v19 offset:49160
  ds_read_b64_tr_b16 a[110:111], v19 offset:51208
  s_waitcnt lgkmcnt(4)
  v_mfma_f32_16x16x32_bf16 v[192:195], a[96:99], a[132:135], v[192:195]
  v_mfma_f32_16x16x32_bf16 v[196:199], a[96:99], a[136:139], v[196:199]
  s_add_u32 m0, s43, 81920
  s_nop 0
  buffer_load_dwordx4 v38, s[20:23], s54 offen offset:0 nt lds
  v_mfma_f32_16x16x32_bf16 v[200:203], a[96:99], a[140:143], v[200:203]
  v_mfma_f32_16x16x32_bf16 v[204:207], a[96:99], a[144:147], v[204:207]
  v_mfma_f32_16x16x32_bf16 v[208:211], a[96:99], a[148:151], v[208:211]
  ds_read_b64_tr_b16 a[96:97], v20 offset:49152
  ds_read_b64_tr_b16 a[98:99], v20 offset:51200
  v_mfma_f32_16x16x32_bf16 v[212:215], a[100:103], a[132:135], v[212:215]
  v_mfma_f32_16x16x32_bf16 v[216:219], a[100:103], a[136:139], v[216:219]
  buffer_load_dwordx4 v39, s[20:23], s54 offen offset:1024 nt lds
  v_mfma_f32_16x16x32_bf16 v[220:223], a[100:103], a[140:143], v[220:223]
  v_mfma_f32_16x16x32_bf16 v[224:227], a[100:103], a[144:147], v[224:227]
  v_mfma_f32_16x16x32_bf16 v[228:231], a[100:103], a[148:151], v[228:231]
  ds_read_b64_tr_b16 a[100:101], v20 offset:49160
  s_waitcnt lgkmcnt(3)
  v_mfma_f32_16x16x32_bf16 v[232:235], a[104:107], a[132:135], v[232:235]
  ds_read_b64_tr_b16 a[102:103], v20 offset:51208
  v_mfma_f32_16x16x32_bf16 v[236:239], a[104:107], a[136:139], v[236:239]
  buffer_load_dwordx4 v38, s[20:23], s54 offen offset:2048 nt lds
  v_mfma_f32_16x16x32_bf16 v[240:243], a[104:107], a[140:143], v[240:243]
  v_mfma_f32_16x16x32_bf16 v[244:247], a[104:107], a[144:147], v[244:247]
  v_mfma_f32_16x16x32_bf16 v[248:251], a[104:107], a[148:151], v[248:251]
  ds_read_b64_tr_b16 a[104:105], v21 offset:49152
  ds_read_b64_tr_b16 a[106:107], v21 offset:51200
  v_mfma_f32_16x16x32_bf16 v[252:255], a[108:111], a[132:135], v[252:255]
  v_mfma_f32_16x16x32_bf16 a[0:3], a[108:111], a[136:139], a[0:3]
  buffer_load_dwordx4 v39, s[20:23], s54 offen offset:3072 nt lds
  s_add_u32 s54, s54, 16384
  v_mfma_f32_16x16x32_bf16 a[4:7], a[108:111], a[140:143], a[4:7]
  v_mfma_f32_16x16x32_bf16 a[8:11], a[108:111], a[144:147], a[8:11]
  v_mfma_f32_16x16x32_bf16 a[12:15], a[108:111], a[148:151], a[12:15]
  ds_read_b64_tr_b16 a[108:109], v21 offset:49160
  s_waitcnt lgkmcnt(3)
  v_mfma_f32_16x16x32_bf16 a[16:19], a[96:99], a[132:135], a[16:19]
  ds_read_b64_tr_b16 a[110:111], v21 offset:51208
  v_mfma_f32_16x16x32_bf16 a[20:23], a[96:99], a[136:139], a[20:23]
  v_mfma_f32_16x16x32_bf16 a[24:27], a[96:99], a[140:143], a[24:27]
  v_mfma_f32_16x16x32_bf16 a[28:31], a[96:99], a[144:147], a[28:31]
  v_mfma_f32_16x16x32_bf16 a[32:35], a[96:99], a[148:151], a[32:35]
  ds_read_b64_tr_b16 a[96:97], v26 offset:49152
  ds_read_b64_tr_b16 a[98:99], v26 offset:51200
  v_mfma_f32_16x16x32_bf16 a[36:39], a[100:103], a[132:135], a[36:39]
  v_mfma_f32_16x16x32_bf16 a[40:43], a[100:103], a[136:139], a[40:43]
  v_mfma_f32_16x16x32_bf16 a[44:47], a[100:103], a[140:143], a[44:47]
  v_mfma_f32_16x16x32_bf16 a[48:51], a[100:103], a[144:147], a[48:51]
  v_mfma_f32_16x16x32_bf16 a[52:55], a[100:103], a[148:151], a[52:55]
  ds_read_b64_tr_b16 a[100:101], v26 offset:49160
  s_waitcnt lgkmcnt(3)
  v_mfma_f32_16x16x32_bf16 a[56:59], a[104:107], a[132:135], a[56:59]
  ds_read_b64_tr_b16 a[102:103], v26 offset:51208
  v_mfma_f32_16x16x32_bf16 a[60:63], a[104:107], a[136:139], a[60:63]
  v_mfma_f32_16x16x32_bf16 a[64:67], a[104:107], a[140:143], a[64:67]
  v_mfma_f32_16x16x32_bf16 a[68:71], a[104:107], a[144:147], a[68:71]
  v_mfma_f32_16x16x32_bf16 a[72:75], a[104:107], a[148:151], a[72:75]
  ds_read_b64_tr_b16 a[104:105], v27 offset:49152
  ds_read_b64_tr_b16 a[106:107], v27 offset:51200
  v_mfma_f32_16x16x32_bf16 a[76:79], a[108:111], a[132:135], a[76:79]
  v_mfma_f32_16x16x32_bf16 a[80:83], a[108:111], a[136:139], a[80:83]
  v_mfma_f32_16x16x32_bf16 a[84:87], a[108:111], a[140:143], a[84:87]
  v_mfma_f32_16x16x32_bf16 a[88:91], a[108:111], a[144:147], a[88:91]
  v_mfma_f32_16x16x32_bf16 a[92:95], a[108:111], a[148:151], a[92:95]
  ds_read_b64_tr_b16 a[108:109], v27 offset:49160
  s_waitcnt lgkmcnt(3)
  v_mfma_f32_16x16x32_bf16 v[64:67], a[96:99], a[132:135], v[64:67]
  ds_read_b64_tr_b16 a[110:111], v27 offset:51208
  v_mfma_f32_16x16x32_bf16 v[68:71], a[96:99], a[136:139], v[68:71]
  v_mfma_f32_16x16x32_bf16 v[72:75], a[96:99], a[140:143], v[72:75]
  v_mfma_f32_16x16x32_bf16 v[76:79], a[96:99], a[144:147], v[76:79]
  ds_read_b64_tr_b16 a[96:97], v28 offset:49152
  ds_read_b64_tr_b16 a[98:99], v28 offset:51200
  v_mfma_f32_16x16x32_bf16 v[80:83], a[100:103], a[132:135], v[80:83]
  v_mfma_f32_16x16x32_bf16 v[84:87], a[100:103], a[136:139], v[84:87]
  v_mfma_f32_16x16x32_bf16 v[88:91], a[100:103], a[140:143], v[88:91]
  v_mfma_f32_16x16x32_bf16 v[92:95], a[100:103], a[144:147], v[92:95]
  ds_read_b64_tr_b16 a[100:101], v28 offset:49160
  s_waitcnt lgkmcnt(3)
  v_mfma_f32_16x16x32_bf16 v[96:99], a[104:107], a[132:135], v[96:99]
  ds_read_b64_tr_b16 a[102:103], v28 offset:51208
  v_mfma_f32_16x16x32_bf16 v[100:103], a[104:107], a[136:139], v[100:103]
  v_mfma_f32_16x16x32_bf16 v[104:107], a[104:107], a[140:143], v[104:107]
  v_mfma_f32_16x16x32_bf16 v[108:111], a[104:107], a[144:147], v[108:111]
  ds_read_b64_tr_b16 a[104:105], v29 offset:49152
  ds_read_b64_tr_b16 a[106:107], v29 offset:51200
  v_mfma_f32_16x16x32_bf16 v[112:115], a[108:111], a[132:135], v[112:115]
  v_mfma_f32_16x16x32_bf16 v[116:119], a[108:111], a[136:139], v[116:119]
  v_mfma_f32_16x16x32_bf16 v[120:123], a[108:111], a[140:143], v[120:123]
  v_mfma_f32_16x16x32_bf16 v[124:127], a[108:111], a[144:147], v[124:127]
  ds_read_b64_tr_b16 a[108:109], v29 offset:49160
  s_waitcnt lgkmcnt(3)
  v_mfma_f32_16x16x32_bf16 v[128:131], a[96:99], a[132:135], v[128:131]
  ds_read_b64_tr_b16 a[110:111], v29 offset:51208
  v_mfma_f32_16x16x32_bf16 v[132:135], a[96:99], a[136:139], v[132:135]
  v_mfma_f32_16x16x32_bf16 v[136:139], a[96:99], a[140:143], v[136:139]
  s_waitcnt vmcnt(16)
  s_waitcnt lgkmcnt(0)
  s_barrier
  v_mfma_f32_16x16x32_bf16 v[140:143], a[96:99], a[144:147], v[140:143]
  ds_read_b64_tr_b16 a[154:155], v8 offset:0
  ds_read_b64_tr_b16 a[158:159], v8 offset:8
  v_mfma_f32_16x16x32_bf16 v[144:147], a[100:103], a[132:135], v[144:147]
  ds_read_b64_tr_b16 a[162:163], v8 offset:64
  ds_read_b64_tr_b16 a[166:167], v8 offset:72
  v_mfma_f32_16x16x32_bf16 v[148:151], a[100:103], a[136:139], v[148:151]
  ds_read_b64_tr_b16 a[170:171], v9 offset:128
  ds_read_b64_tr_b16 a[174:175], v8 offset:160
  v_mfma_f32_16x16x32_bf16 v[152:155], a[100:103], a[140:143], v[152:155]
  ds_read_b64_tr_b16 a[178:179], v8 offset:168
  ds_read_b64_tr_b16 a[182:183], v8 offset:224
  v_mfma_f32_16x16x32_bf16 v[156:159], a[100:103], a[144:147], v[156:159]
  ds_read_b64_tr_b16 a[186:187], v8 offset:232
  v_mfma_f32_16x16x32_bf16 v[160:163], a[104:107], a[132:135], v[160:163]
  ds_read_b64_tr_b16 a[190:191], v9 offset:288
  v_mfma_f32_16x16x32_bf16 v[164:167], a[104:107], a[136:139], v[164:167]
  v_mfma_f32_16x16x32_bf16 v[168:171], a[104:107], a[140:143], v[168:171]
  v_mfma_f32_16x16x32_bf16 v[172:175], a[104:107], a[144:147], v[172:175]
  v_mfma_f32_16x16x32_bf16 v[176:179], a[108:111], a[132:135], v[176:179]
  v_mfma_f32_16x16x32_bf16 v[180:183], a[108:111], a[136:139], v[180:183]
  v_mfma_f32_16x16x32_bf16 v[184:187], a[108:111], a[140:143], v[184:187]
  v_mfma_f32_16x16x32_bf16 v[188:191], a[108:111], a[144:147], v[188:191]
  s_add_u32 s39, s46, 0
  s_add_u32 s40, s39, 4096
  s_waitcnt lgkmcnt(9)
  buffer_store_dwordx4 a[152:155], v7, s[24:27], s39 offen offset:0
  s_waitcnt lgkmcnt(8)
  buffer_store_dwordx4 a[156:159], v7, s[24:27], s39 offen offset:1024
  s_waitcnt lgkmcnt(7)
  buffer_store_dwordx4 a[160:163], v7, s[24:27], s39 offen offset:2048
  s_waitcnt lgkmcnt(6)
  buffer_store_dwordx4 a[164:167], v7, s[24:27], s39 offen offset:3072
  s_waitcnt lgkmcnt(5)
  buffer_store_dwordx4 a[168:171], v7, s[24:27], s40 offen
  s_add_u32 s39, s46, 655360
  s_add_u32 s40, s39, 4096
  s_waitcnt lgkmcnt(4)
  buffer_store_dwordx4 a[172:175], v7, s[24:27], s39 offen offset:0
  s_waitcnt lgkmcnt(3)
  buffer_store_dwordx4 a[176:179], v7, s[24:27], s39 offen offset:1024
  s_waitcnt lgkmcnt(2)
  buffer_store_dwordx4 a[180:183], v7, s[24:27], s39 offen offset:2048
  s_waitcnt lgkmcnt(1)
  buffer_store_dwordx4 a[184:187], v7, s[24:27], s39 offen offset:3072
  s_waitcnt lgkmcnt(0)
  buffer_store_dwordx4 a[188:191], v7, s[24:27], s40 offen
  s_mov_b32 s28, s86
  s_mov_b32 s29, s87
  s_mov_b32 s30, 256
  v_accvgpr_read_b32 v8, a192
  v_accvgpr_read_b32 v9, a193
  v_accvgpr_read_b32 v10, a194
  v_accvgpr_read_b32 v11, a195
  v_accvgpr_read_b32 v12, a196
  v_accvgpr_read_b32 v13, a197
  v_accvgpr_read_b32 v14, a198
  v_accvgpr_read_b32 v15, a199
  v_accvgpr_read_b32 v16, a200
  v_accvgpr_read_b32 v17, a201
  v_accvgpr_read_b32 v18, a202
  v_accvgpr_read_b32 v19, a203
  v_accvgpr_read_b32 v20, a204
  v_accvgpr_read_b32 v21, a205
  v_accvgpr_read_b32 v22, a206
  v_accvgpr_read_b32 v23, a207
  v_accvgpr_read_b32 v24, a208
  v_accvgpr_read_b32 v25, a209
  v_accvgpr_read_b32 v26, a210
  v_accvgpr_read_b32 v27, a211
  v_accvgpr_read_b32 v28, a212
  v_accvgpr_read_b32 v29, a213
  v_accvgpr_read_b32 v30, a214
  v_accvgpr_read_b32 v31, a215
  s_mov_b32 s98, s51
  s_mov_b32 s99, s51
  s_lshl_b32 s37, s32, 12
  s_add_u32 s37, s37, 49152
  v_add_u32 v32, s37, v7
  s_and_b32 s37, s32, 2
  s_lshl_b32 s37, s37, 12
  s_add_u32 s37, s37, 49152
  v_add_u32 v33, s37, v7
  s_cmp_eq_u32 s33, 1
  s_cbranch_scc1 K1_FX1
  v_accvgpr_read_b32 v44, a12
  v_accvgpr_read_b32 v45, a13
  v_accvgpr_read_b32 v46, a14
  v_accvgpr_read_b32 v47, a15
  v_pk_mul_f32 v[208:209], v[208:209], s[98:99]
  v_pk_mul_f32 v[210:211], v[210:211], s[98:99]
  v_pk_mul_f32 v[228:229], v[228:229], s[98:99]
  v_pk_mul_f32 v[230:231], v[230:231], s[98:99]
  v_pk_mul_f32 v[248:249], v[248:249], s[98:99]
  v_pk_mul_f32 v[250:251], v[250:251], s[98:99]
  v_pk_mul_f32 v[44:45], v[44:45], s[98:99]
  v_pk_mul_f32 v[46:47], v[46:47], s[98:99]
  v_cvt_pk_bf16_f32 v40, v208, v209
  v_cvt_pk_bf16_f32 v41, v210, v211
  v_cvt_pk_bf16_f32 v42, v228, v229
  v_cvt_pk_bf16_f32 v43, v230, v231
  v_cvt_pk_bf16_f32 v48, v248, v249
  v_cvt_pk_bf16_f32 v49, v250, v251
  v_cvt_pk_bf16_f32 v50, v44, v45
  v_cvt_pk_bf16_f32 v51, v46, v47
  ds_write_b128 v32, v[40:43] offset:0
  ds_write_b128 v32, v[48:51] offset:1024
  v_accvgpr_read_b32 v52, a32
  v_accvgpr_read_b32 v53, a33
  v_accvgpr_read_b32 v54, a34
  v_accvgpr_read_b32 v55, a35
  v_accvgpr_read_b32 v56, a52
  v_accvgpr_read_b32 v57, a53
  v_accvgpr_read_b32 v58, a54
  v_accvgpr_read_b32 v59, a55
  v_accvgpr_read_b32 v40, a72
  v_accvgpr_read_b32 v41, a73
  v_accvgpr_read_b32 v42, a74
  v_accvgpr_read_b32 v43, a75
  v_accvgpr_read_b32 v44, a92
  v_accvgpr_read_b32 v45, a93
  v_accvgpr_read_b32 v46, a94
  v_accvgpr_read_b32 v47, a95
  v_pk_mul_f32 v[52:53], v[52:53], s[98:99]
  v_pk_mul_f32 v[54:55], v[54:55], s[98:99]
  v_pk_mul_f32 v[56:57], v[56:57], s[98:99]
  v_pk_mul_f32 v[58:59], v[58:59], s[98:99]
  v_pk_mul_f32 v[40:41], v[40:41], s[98:99]
  v_pk_mul_f32 v[42:43], v[42:43], s[98:99]
  v_pk_mul_f32 v[44:45], v[44:45], s[98:99]
  v_pk_mul_f32 v[46:47], v[46:47], s[98:99]
  v_cvt_pk_bf16_f32 v60, v52, v53
  v_cvt_pk_bf16_f32 v61, v54, v55
  v_cvt_pk_bf16_f32 v62, v56, v57
  v_cvt_pk_bf16_f32 v63, v58, v59
  v_cvt_pk_bf16_f32 v48, v40, v41
  v_cvt_pk_bf16_f32 v49, v42, v43
  v_cvt_pk_bf16_f32 v50, v44, v45
  v_cvt_pk_bf16_f32 v51, v46, v47
  ds_write_b128 v32, v[60:63] offset:2048
  ds_write_b128 v32, v[48:51] offset:3072
  v_pk_mul_f32 v[64:65], v[64:65], s[98:99]
  v_pk_mul_f32 v[66:67], v[66:67], s[98:99]
  v_pk_mul_f32 v[80:81], v[80:81], s[98:99]
  v_pk_mul_f32 v[82:83], v[82:83], s[98:99]
  v_pk_mul_f32 v[68:69], v[68:69], s[98:99]
  v_pk_mul_f32 v[70:71], v[70:71], s[98:99]
  v_pk_mul_f32 v[84:85], v[84:85], s[98:99]
  v_pk_mul_f32 v[86:87], v[86:87], s[98:99]
  v_cvt_pk_bf16_f32 v52, v64, v65
  v_cvt_pk_bf16_f32 v53, v66, v67
  v_cvt_pk_bf16_f32 v54, v80, v81
  v_cvt_pk_bf16_f32 v55, v82, v83
  v_cvt_pk_bf16_f32 v56, v68, v69
  v_cvt_pk_bf16_f32 v57, v70, v71
  v_cvt_pk_bf16_f32 v58, v84, v85
  v_cvt_pk_bf16_f32 v59, v86, v87
  v_accvgpr_write_b32 a160, v52
  v_accvgpr_write_b32 a161, v53
  v_accvgpr_write_b32 a162, v54
  v_accvgpr_write_b32 a163, v55
  v_accvgpr_write_b32 a164, v56
  v_accvgpr_write_b32 a165, v57
  v_accvgpr_write_b32 a166, v58
  v_accvgpr_write_b32 a167, v59
  v_pk_mul_f32 v[72:73], v[72:73], s[98:99]
  v_pk_mul_f32 v[74:75], v[74:75], s[98:99]
  v_pk_mul_f32 v[88:89], v[88:89], s[98:99]
  v_pk_mul_f32 v[90:91], v[90:91], s[98:99]
  v_pk_mul_f32 v[76:77], v[76:77], s[98:99]
  v_pk_mul_f32 v[78:79], v[78:79], s[98:99]
  v_pk_mul_f32 v[92:93], v[92:93], s[98:99]
  v_pk_mul_f32 v[94:95], v[94:95], s[98:99]
  v_cvt_pk_bf16_f32 v60, v72, v73
  v_cvt_pk_bf16_f32 v61, v74, v75
  v_cvt_pk_bf16_f32 v62, v88, v89
  v_cvt_pk_bf16_f32 v63, v90, v91
  v_cvt_pk_bf16_f32 v40, v76, v77
  v_cvt_pk_bf16_f32 v41, v78, v79
  v_cvt_pk_bf16_f32 v42, v92, v93
  v_cvt_pk_bf16_f32 v43, v94, v95
  v_accvgpr_write_b32 a168, v60
  v_accvgpr_write_b32 a169, v61
  v_accvgpr_write_b32 a170, v62
  v_accvgpr_write_b32 a171, v63
  v_accvgpr_write_b32 a172, v40
  v_accvgpr_write_b32 a173, v41
  v_accvgpr_write_b32 a174, v42
  v_accvgpr_write_b32 a175, v43
  v_pk_mul_f32 v[96:97], v[96:97], s[98:99]
  v_pk_mul_f32 v[98:99], v[98:99], s[98:99]
  v_pk_mul_f32 v[112:113], v[112:113], s[98:99]
  v_pk_mul_f32 v[114:115], v[114:115], s[98:99]
  v_pk_mul_f32 v[100:101], v[100:101], s[98:99]
  v_pk_mul_f32 v[102:103], v[102:103], s[98:99]
  v_pk_mul_f32 v[116:117], v[116:117], s[98:99]
  v_pk_mul_f32 v[118:119], v[118:119], s[98:99]
  v_cvt_pk_bf16_f32 v44, v96, v97
  v_cvt_pk_bf16_f32 v45, v98, v99
  v_cvt_pk_bf16_f32 v46, v112, v113
  v_cvt_pk_bf16_f32 v47, v114, v115
  v_cvt_pk_bf16_f32 v48, v100, v101
  v_cvt_pk_bf16_f32 v49, v102, v103
  v_cvt_pk_bf16_f32 v50, v116, v117
  v_cvt_pk_bf16_f32 v51, v118, v119
  v_accvgpr_write_b32 a180, v44
  v_accvgpr_write_b32 a181, v45
  v_accvgpr_write_b32 a182, v46
  v_accvgpr_write_b32 a183, v47
  v_accvgpr_write_b32 a184, v48
  v_accvgpr_write_b32 a185, v49
  v_accvgpr_write_b32 a186, v50
  v_accvgpr_write_b32 a187, v51
  v_pk_mul_f32 v[104:105], v[104:105], s[98:99]
  v_pk_mul_f32 v[106:107], v[106:107], s[98:99]
  v_pk_mul_f32 v[120:121], v[120:121], s[98:99]
  v_pk_mul_f32 v[122:123], v[122:123], s[98:99]
  v_pk_mul_f32 v[108:109], v[108:109], s[98:99]
  v_pk_mul_f32 v[110:111], v[110:111], s[98:99]
  v_pk_mul_f32 v[124:125], v[124:125], s[98:99]
  v_pk_mul_f32 v[126:127], v[126:127], s[98:99]
  v_cvt_pk_bf16_f32 v52, v104, v105
  v_cvt_pk_bf16_f32 v53, v106, v107
  v_cvt_pk_bf16_f32 v54, v120, v121
  v_cvt_pk_bf16_f32 v55, v122, v123
  v_cvt_pk_bf16_f32 v56, v108, v109
  v_cvt_pk_bf16_f32 v57, v110, v111
  v_cvt_pk_bf16_f32 v58, v124, v125
  v_cvt_pk_bf16_f32 v59, v126, v127
  v_accvgpr_write_b32 a188, v52
  v_accvgpr_write_b32 a189, v53
  v_accvgpr_write_b32 a190, v54
  v_accvgpr_write_b32 a191, v55
  v_accvgpr_write_b32 a192, v56
  v_accvgpr_write_b32 a193, v57
  v_accvgpr_write_b32 a194, v58
  v_accvgpr_write_b32 a195, v59
  v_pk_mul_f32 v[128:129], v[128:129], s[98:99]
  v_pk_mul_f32 v[130:131], v[130:131], s[98:99]
  v_pk_mul_f32 v[144:145], v[144:145], s[98:99]
  v_pk_mul_f32 v[146:147], v[146:147], s[98:99]
  v_pk_mul_f32 v[132:133], v[132:133], s[98:99]
  v_pk_mul_f32 v[134:135], v[134:135], s[98:99]
  v_pk_mul_f32 v[148:149], v[148:149], s[98:99]
  v_pk_mul_f32 v[150:151], v[150:151], s[98:99]
  v_cvt_pk_bf16_f32 v60, v128, v129
  v_cvt_pk_bf16_f32 v61, v130, v131
  v_cvt_pk_bf16_f32 v62, v144, v145
  v_cvt_pk_bf16_f32 v63, v146, v147
  v_cvt_pk_bf16_f32 v40, v132, v133
  v_cvt_pk_bf16_f32 v41, v134, v135
  v_cvt_pk_bf16_f32 v42, v148, v149
  v_cvt_pk_bf16_f32 v43, v150, v151
  v_accvgpr_write_b32 a200, v60
  v_accvgpr_write_b32 a201, v61
  v_accvgpr_write_b32 a202, v62
  v_accvgpr_write_b32 a203, v63
  v_accvgpr_write_b32 a204, v40
  v_accvgpr_write_b32 a205, v41
  v_accvgpr_write_b32 a206, v42
  v_accvgpr_write_b32 a207, v43
  v_pk_mul_f32 v[136:137], v[136:137], s[98:99]
  v_pk_mul_f32 v[138:139], v[138:139], s[98:99]
  v_pk_mul_f32 v[152:153], v[152:153], s[98:99]
  v_pk_mul_f32 v[154:155], v[154:155], s[98:99]
  v_pk_mul_f32 v[140:141], v[140:141], s[98:99]
  v_pk_mul_f32 v[142:143], v[142:143], s[98:99]
  v_pk_mul_f32 v[156:157], v[156:157], s[98:99]
  v_pk_mul_f32 v[158:159], v[158:159], s[98:99]
  v_cvt_pk_bf16_f32 v44, v136, v137
  v_cvt_pk_bf16_f32 v45, v138, v139
  v_cvt_pk_bf16_f32 v46, v152, v153
  v_cvt_pk_bf16_f32 v47, v154, v155
  v_cvt_pk_bf16_f32 v48, v140, v141
  v_cvt_pk_bf16_f32 v49, v142, v143
  v_cvt_pk_bf16_f32 v50, v156, v157
  v_cvt_pk_bf16_f32 v51, v158, v159
  v_accvgpr_write_b32 a208, v44
  v_accvgpr_write_b32 a209, v45
  v_accvgpr_write_b32 a210, v46
  v_accvgpr_write_b32 a211, v47
  v_accvgpr_write_b32 a212, v48
  v_accvgpr_write_b32 a213, v49
  v_accvgpr_write_b32 a214, v50
  v_accvgpr_write_b32 a215, v51
  v_pk_mul_f32 v[160:161], v[160:161], s[98:99]
  v_pk_mul_f32 v[162:163], v[162:163], s[98:99]
  v_pk_mul_f32 v[176:177], v[176:177], s[98:99]
  v_pk_mul_f32 v[178:179], v[178:179], s[98:99]
  v_pk_mul_f32 v[164:165], v[164:165], s[98:99]
  v_pk_mul_f32 v[166:167], v[166:167], s[98:99]
  v_pk_mul_f32 v[180:181], v[180:181], s[98:99]
  v_pk_mul_f32 v[182:183], v[182:183], s[98:99]
  v_cvt_pk_bf16_f32 v52, v160, v161
  v_cvt_pk_bf16_f32 v53, v162, v163
  v_cvt_pk_bf16_f32 v54, v176, v177
  v_cvt_pk_bf16_f32 v55, v178, v179
  v_cvt_pk_bf16_f32 v56, v164, v165
  v_cvt_pk_bf16_f32 v57, v166, v167
  v_cvt_pk_bf16_f32 v58, v180, v181
  v_cvt_pk_bf16_f32 v59, v182, v183
  v_accvgpr_write_b32 a220, v52
  v_accvgpr_write_b32 a221, v53
  v_accvgpr_write_b32 a222, v54
  v_accvgpr_write_b32 a223, v55
  v_accvgpr_write_b32 a224, v56
  v_accvgpr_write_b32 a225, v57
  v_accvgpr_write_b32 a226, v58
  v_accvgpr_write_b32 a227, v59
  v_pk_mul_f32 v[168:169], v[168:169], s[98:99]
  v_pk_mul_f32 v[170:171], v[170:171], s[98:99]
  v_pk_mul_f32 v[184:185], v[184:185], s[98:99]
  v_pk_mul_f32 v[186:187], v[186:187], s[98:99]
  v_pk_mul_f32 v[172:173], v[172:173], s[98:99]
  v_pk_mul_f32 v[174:175], v[174:175], s[98:99]
  v_pk_mul_f32 v[188:189], v[188:189], s[98:99]
  v_pk_mul_f32 v[190:191], v[190:191], s[98:99]
  v_cvt_pk_bf16_f32 v60, v168, v169
  v_cvt_pk_bf16_f32 v61, v170, v171
  v_cvt_pk_bf16_f32 v62, v184, v185
  v_cvt_pk_bf16_f32 v63, v186, v187
  v_cvt_pk_bf16_f32 v40, v172, v173
  v_cvt_pk_bf16_f32 v41, v174, v175
  v_cvt_pk_bf16_f32 v42, v188, v189
  v_cvt_pk_bf16_f32 v43, v190, v191
  v_accvgpr_write_b32 a228, v60
  v_accvgpr_write_b32 a229, v61
  v_accvgpr_write_b32 a230, v62
  v_accvgpr_write_b32 a231, v63
  v_accvgpr_write_b32 a232, v40
  v_accvgpr_write_b32 a233, v41
  v_accvgpr_write_b32 a234, v42
  v_accvgpr_write_b32 a235, v43
  v_pk_mul_f32 v[192:193], v[192:193], s[98:99]
  v_pk_mul_f32 v[194:195], v[194:195], s[98:99]
  v_pk_mul_f32 v[212:213], v[212:213], s[98:99]
  v_pk_mul_f32 v[214:215], v[214:215], s[98:99]
  v_pk_mul_f32 v[196:197], v[196:197], s[98:99]
  v_pk_mul_f32 v[198:199], v[198:199], s[98:99]
  v_pk_mul_f32 v[216:217], v[216:217], s[98:99]
  v_pk_mul_f32 v[218:219], v[218:219], s[98:99]
  v_cvt_pk_bf16_f32 v64, v192, v193
  v_cvt_pk_bf16_f32 v65, v194, v195
  v_cvt_pk_bf16_f32 v66, v212, v213
  v_cvt_pk_bf16_f32 v67, v214, v215
  v_cvt_pk_bf16_f32 v68, v196, v197
  v_cvt_pk_bf16_f32 v69, v198, v199
  v_cvt_pk_bf16_f32 v70, v216, v217
  v_cvt_pk_bf16_f32 v71, v218, v219
  v_pk_mul_f32 v[200:201], v[200:201], s[98:99]
  v_pk_mul_f32 v[202:203], v[202:203], s[98:99]
  v_pk_mul_f32 v[220:221], v[220:221], s[98:99]
  v_pk_mul_f32 v[222:223], v[222:223], s[98:99]
  v_pk_mul_f32 v[204:205], v[204:205], s[98:99]
  v_pk_mul_f32 v[206:207], v[206:207], s[98:99]
  v_pk_mul_f32 v[224:225], v[224:225], s[98:99]
  v_pk_mul_f32 v[226:227], v[226:227], s[98:99]
  v_cvt_pk_bf16_f32 v72, v200, v201
  v_cvt_pk_bf16_f32 v73, v202, v203
  v_cvt_pk_bf16_f32 v74, v220, v221
  v_cvt_pk_bf16_f32 v75, v222, v223
  v_cvt_pk_bf16_f32 v76, v204, v205
  v_cvt_pk_bf16_f32 v77, v206, v207
  v_cvt_pk_bf16_f32 v78, v224, v225
  v_cvt_pk_bf16_f32 v79, v226, v227
  v_accvgpr_read_b32 v44, a0
  v_accvgpr_read_b32 v45, a1
  v_accvgpr_read_b32 v46, a2
  v_accvgpr_read_b32 v47, a3
  v_pk_mul_f32 v[232:233], v[232:233], s[98:99]
  v_pk_mul_f32 v[234:235], v[234:235], s[98:99]
  v_pk_mul_f32 v[252:253], v[252:253], s[98:99]
  v_pk_mul_f32 v[254:255], v[254:255], s[98:99]
  v_pk_mul_f32 v[236:237], v[236:237], s[98:99]
  v_pk_mul_f32 v[238:239], v[238:239], s[98:99]
  v_pk_mul_f32 v[44:45], v[44:45], s[98:99]
  v_pk_mul_f32 v[46:47], v[46:47], s[98:99]
  v_cvt_pk_bf16_f32 v84, v232, v233
  v_cvt_pk_bf16_f32 v85, v234, v235
  v_cvt_pk_bf16_f32 v86, v252, v253
  v_cvt_pk_bf16_f32 v87, v254, v255
  v_cvt_pk_bf16_f32 v88, v236, v237
  v_cvt_pk_bf16_f32 v89, v238, v239
  v_cvt_pk_bf16_f32 v90, v44, v45
  v_cvt_pk_bf16_f32 v91, v46, v47
  v_accvgpr_read_b32 v48, a4
  v_accvgpr_read_b32 v49, a5
  v_accvgpr_read_b32 v50, a6
  v_accvgpr_read_b32 v51, a7
  v_accvgpr_read_b32 v52, a8
  v_accvgpr_read_b32 v53, a9
  v_accvgpr_read_b32 v54, a10
  v_accvgpr_read_b32 v55, a11
  v_pk_mul_f32 v[240:241], v[240:241], s[98:99]
  v_pk_mul_f32 v[242:243], v[242:243], s[98:99]
  v_pk_mul_f32 v[48:49], v[48:49], s[98:99]
  v_pk_mul_f32 v[50:51], v[50:51], s[98:99]
  v_pk_mul_f32 v[244:245], v[244:245], s[98:99]
  v_pk_mul_f32 v[246:247], v[246:247], s[98:99]
  v_pk_mul_f32 v[52:53], v[52:53], s[98:99]
  v_pk_mul_f32 v[54:55], v[54:55], s[98:99]
  v_cvt_pk_bf16_f32 v92, v240, v241
  v_cvt_pk_bf16_f32 v93, v242, v243
  v_cvt_pk_bf16_f32 v94, v48, v49
  v_cvt_pk_bf16_f32 v95, v50, v51
  v_cvt_pk_bf16_f32 v96, v244, v245
  v_cvt_pk_bf16_f32 v97, v246, v247
  v_cvt_pk_bf16_f32 v98, v52, v53
  v_cvt_pk_bf16_f32 v99, v54, v55
  v_accvgpr_read_b32 v56, a16
  v_accvgpr_read_b32 v57, a17
  v_accvgpr_read_b32 v58, a18
  v_accvgpr_read_b32 v59, a19
  v_accvgpr_read_b32 v60, a36
  v_accvgpr_read_b32 v61, a37
  v_accvgpr_read_b32 v62, a38
  v_accvgpr_read_b32 v63, a39
  v_accvgpr_read_b32 v40, a20
  v_accvgpr_read_b32 v41, a21
  v_accvgpr_read_b32 v42, a22
  v_accvgpr_read_b32 v43, a23
  v_accvgpr_read_b32 v44, a40
  v_accvgpr_read_b32 v45, a41
  v_accvgpr_read_b32 v46, a42
  v_accvgpr_read_b32 v47, a43
  v_pk_mul_f32 v[56:57], v[56:57], s[98:99]
  v_pk_mul_f32 v[58:59], v[58:59], s[98:99]
  v_pk_mul_f32 v[60:61], v[60:61], s[98:99]
  v_pk_mul_f32 v[62:63], v[62:63], s[98:99]
  v_pk_mul_f32 v[40:41], v[40:41], s[98:99]
  v_pk_mul_f32 v[42:43], v[42:43], s[98:99]
  v_pk_mul_f32 v[44:45], v[44:45], s[98:99]
  v_pk_mul_f32 v[46:47], v[46:47], s[98:99]
  v_cvt_pk_bf16_f32 v104, v56, v57
  v_cvt_pk_bf16_f32 v105, v58, v59
  v_cvt_pk_bf16_f32 v106, v60, v61
  v_cvt_pk_bf16_f32 v107, v62, v63
  v_cvt_pk_bf16_f32 v108, v40, v41
  v_cvt_pk_bf16_f32 v109, v42, v43
  v_cvt_pk_bf16_f32 v110, v44, v45
  v_cvt_pk_bf16_f32 v111, v46, v47
  v_accvgpr_read_b32 v48, a24
  v_accvgpr_read_b32 v49, a25
  v_accvgpr_read_b32 v50, a26
  v_accvgpr_read_b32 v51, a27
  v_accvgpr_read_b32 v52, a44
  v_accvgpr_read_b32 v53, a45
  v_accvgpr_read_b32 v54, a46
  v_accvgpr_read_b32 v55, a47
  v_accvgpr_read_b32 v56, a28
  v_accvgpr_read_b32 v57, a29
  v_accvgpr_read_b32 v58, a30
  v_accvgpr_read_b32 v59, a31
  v_accvgpr_read_b32 v60, a48
  v_accvgpr_read_b32 v61, a49
  v_accvgpr_read_b32 v62, a50
  v_accvgpr_read_b32 v63, a51
  v_pk_mul_f32 v[48:49], v[48:49], s[98:99]
  v_pk_mul_f32 v[50:51], v[50:51], s[98:99]
  v_pk_mul_f32 v[52:53], v[52:53], s[98:99]
  v_pk_mul_f32 v[54:55], v[54:55], s[98:99]
  v_pk_mul_f32 v[56:57], v[56:57], s[98:99]
  v_pk_mul_f32 v[58:59], v[58:59], s[98:99]
  v_pk_mul_f32 v[60:61], v[60:61], s[98:99]
  v_pk_mul_f32 v[62:63], v[62:63], s[98:99]
  v_cvt_pk_bf16_f32 v112, v48, v49
  v_cvt_pk_bf16_f32 v113, v50, v51
  v_cvt_pk_bf16_f32 v114, v52, v53
  v_cvt_pk_bf16_f32 v115, v54, v55
  v_cvt_pk_bf16_f32 v116, v56, v57
  v_cvt_pk_bf16_f32 v117, v58, v59
  v_cvt_pk_bf16_f32 v118, v60, v61
  v_cvt_pk_bf16_f32 v119, v62, v63
  v_accvgpr_read_b32 v40, a56
  v_accvgpr_read_b32 v41, a57
  v_accvgpr_read_b32 v42, a58
  v_accvgpr_read_b32 v43, a59
  v_accvgpr_read_b32 v44, a76
  v_accvgpr_read_b32 v45, a77
  v_accvgpr_read_b32 v46, a78
  v_accvgpr_read_b32 v47, a79
  v_accvgpr_read_b32 v48, a60
  v_accvgpr_read_b32 v49, a61
  v_accvgpr_read_b32 v50, a62
  v_accvgpr_read_b32 v51, a63
  v_accvgpr_read_b32 v52, a80
  v_accvgpr_read_b32 v53, a81
  v_accvgpr_read_b32 v54, a82
  v_accvgpr_read_b32 v55, a83
  v_pk_mul_f32 v[40:41], v[40:41], s[98:99]
  v_pk_mul_f32 v[42:43], v[42:43], s[98:99]
  v_pk_mul_f32 v[44:45], v[44:45], s[98:99]
  v_pk_mul_f32 v[46:47], v[46:47], s[98:99]
  v_pk_mul_f32 v[48:49], v[48:49], s[98:99]
  v_pk_mul_f32 v[50:51], v[50:51], s[98:99]
  v_pk_mul_f32 v[52:53], v[52:53], s[98:99]
  v_pk_mul_f32 v[54:55], v[54:55], s[98:99]
  v_cvt_pk_bf16_f32 v124, v40, v41
  v_cvt_pk_bf16_f32 v125, v42, v43
  v_cvt_pk_bf16_f32 v126, v44, v45
  v_cvt_pk_bf16_f32 v127, v46, v47
  v_cvt_pk_bf16_f32 v128, v48, v49
  v_cvt_pk_bf16_f32 v129, v50, v51
  v_cvt_pk_bf16_f32 v130, v52, v53
  v_cvt_pk_bf16_f32 v131, v54, v55
  v_accvgpr_read_b32 v56, a64
  v_accvgpr_read_b32 v57, a65
  v_accvgpr_read_b32 v58, a66
  v_accvgpr_read_b32 v59, a67
  v_accvgpr_read_b32 v60, a84
  v_accvgpr_read_b32 v61, a85
  v_accvgpr_read_b32 v62, a86
  v_accvgpr_read_b32 v63, a87
  v_accvgpr_read_b32 v40, a68
  v_accvgpr_read_b32 v41, a69
  v_accvgpr_read_b32 v42, a70
  v_accvgpr_read_b32 v43, a71
  v_accvgpr_read_b32 v44, a88
  v_accvgpr_read_b32 v45, a89
  v_accvgpr_read_b32 v46, a90
  v_accvgpr_read_b32 v47, a91
  v_pk_mul_f32 v[56:57], v[56:57], s[98:99]
  v_pk_mul_f32 v[58:59], v[58:59], s[98:99]
  v_pk_mul_f32 v[60:61], v[60:61], s[98:99]
  v_pk_mul_f32 v[62:63], v[62:63], s[98:99]
  v_pk_mul_f32 v[40:41], v[40:41], s[98:99]
  v_pk_mul_f32 v[42:43], v[42:43], s[98:99]
  v_pk_mul_f32 v[44:45], v[44:45], s[98:99]
  v_pk_mul_f32 v[46:47], v[46:47], s[98:99]
  v_cvt_pk_bf16_f32 v132, v56, v57
  v_cvt_pk_bf16_f32 v133, v58, v59
  v_cvt_pk_bf16_f32 v134, v60, v61
  v_cvt_pk_bf16_f32 v135, v62, v63
  v_cvt_pk_bf16_f32 v136, v40, v41
  v_cvt_pk_bf16_f32 v137, v42, v43
  v_cvt_pk_bf16_f32 v138, v44, v45
  v_cvt_pk_bf16_f32 v139, v46, v47
  s_waitcnt lgkmcnt(0)
  s_barrier
  ds_read_b128 v[80:83], v33 offset:0
  ds_read_b128 a[176:179], v33 offset:4096
  ds_read_b128 v[100:103], v33 offset:1024
  ds_read_b128 a[196:199], v33 offset:5120
  ds_read_b128 v[120:123], v33 offset:2048
  ds_read_b128 a[216:219], v33 offset:6144
  ds_read_b128 v[140:143], v33 offset:3072
  ds_read_b128 a[236:239], v33 offset:7168
  s_branch K1_ATT
K1_FX1:
  v_accvgpr_read_b32 v44, a12
  v_accvgpr_read_b32 v45, a13
  v_accvgpr_read_b32 v46, a14
  v_accvgpr_read_b32 v47, a15
  v_pk_mul_f32 v[208:209], v[208:209], s[98:99]
  v_pk_mul_f32 v[210:211], v[210:211], s[98:99]
  v_pk_mul_f32 v[228:229], v[228:229], s[98:99]
  v_pk_mul_f32 v[230:231], v[230:231], s[98:99]
  v_pk_mul_f32 v[248:249], v[248:249], s[98:99]
  v_pk_mul_f32 v[250:251], v[250:251], s[98:99]
  v_pk_mul_f32 v[44:45], v[44:45], s[98:99]
  v_pk_mul_f32 v[46:47], v[46:47], s[98:99]
  v_cvt_pk_bf16_f32 v40, v208, v209
  v_cvt_pk_bf16_f32 v41, v210, v211
  v_cvt_pk_bf16_f32 v42, v228, v229
  v_cvt_pk_bf16_f32 v43, v230, v231
  v_cvt_pk_bf16_f32 v48, v248, v249
  v_cvt_pk_bf16_f32 v49, v250, v251
  v_cvt_pk_bf16_f32 v50, v44, v45
  v_cvt_pk_bf16_f32 v51, v46, v47
  ds_write_b128 v32, v[40:43] offset:0
  ds_write_b128 v32, v[48:51] offset:1024
  v_accvgpr_read_b32 v52, a32
  v_accvgpr_read_b32 v53, a33
  v_accvgpr_read_b32 v54, a34
  v_accvgpr_read_b32 v55, a35
  v_accvgpr_read_b32 v56, a52
  v_accvgpr_read_b32 v57, a53
  v_accvgpr_read_b32 v58, a54
  v_accvgpr_read_b32 v59, a55
  v_accvgpr_read_b32 v40, a72
  v_accvgpr_read_b32 v41, a73
  v_accvgpr_read_b32 v42, a74
  v_accvgpr_read_b32 v43, a75
  v_accvgpr_read_b32 v44, a92
  v_accvgpr_read_b32 v45, a93
  v_accvgpr_read_b32 v46, a94
  v_accvgpr_read_b32 v47, a95
  v_pk_mul_f32 v[52:53], v[52:53], s[98:99]
  v_pk_mul_f32 v[54:55], v[54:55], s[98:99]
  v_pk_mul_f32 v[56:57], v[56:57], s[98:99]
  v_pk_mul_f32 v[58:59], v[58:59], s[98:99]
  v_pk_mul_f32 v[40:41], v[40:41], s[98:99]
  v_pk_mul_f32 v[42:43], v[42:43], s[98:99]
  v_pk_mul_f32 v[44:45], v[44:45], s[98:99]
  v_pk_mul_f32 v[46:47], v[46:47], s[98:99]
  v_cvt_pk_bf16_f32 v60, v52, v53
  v_cvt_pk_bf16_f32 v61, v54, v55
  v_cvt_pk_bf16_f32 v62, v56, v57
  v_cvt_pk_bf16_f32 v63, v58, v59
  v_cvt_pk_bf16_f32 v48, v40, v41
  v_cvt_pk_bf16_f32 v49, v42, v43
  v_cvt_pk_bf16_f32 v50, v44, v45
  v_cvt_pk_bf16_f32 v51, v46, v47
  ds_write_b128 v32, v[60:63] offset:2048
  ds_write_b128 v32, v[48:51] offset:3072
  v_pk_mul_f32 v[192:193], v[192:193], s[98:99]
  v_pk_mul_f32 v[194:195], v[194:195], s[98:99]
  v_pk_mul_f32 v[212:213], v[212:213], s[98:99]
  v_pk_mul_f32 v[214:215], v[214:215], s[98:99]
  v_pk_mul_f32 v[196:197], v[196:197], s[98:99]
  v_pk_mul_f32 v[198:199], v[198:199], s[98:99]
  v_pk_mul_f32 v[216:217], v[216:217], s[98:99]
  v_pk_mul_f32 v[218:219], v[218:219], s[98:99]
  v_cvt_pk_bf16_f32 v52, v192, v193
  v_cvt_pk_bf16_f32 v53, v194, v195
  v_cvt_pk_bf16_f32 v54, v212, v213
  v_cvt_pk_bf16_f32 v55, v214, v215
  v_cvt_pk_bf16_f32 v56, v196, v197
  v_cvt_pk_bf16_f32 v57, v198, v199
  v_cvt_pk_bf16_f32 v58, v216, v217
  v_cvt_pk_bf16_f32 v59, v218, v219
  v_accvgpr_write_b32 a160, v52
  v_accvgpr_write_b32 a161, v53
  v_accvgpr_write_b32 a162, v54
  v_accvgpr_write_b32 a163, v55
  v_accvgpr_write_b32 a164, v56
  v_accvgpr_write_b32 a165, v57
  v_accvgpr_write_b32 a166, v58
  v_accvgpr_write_b32 a167, v59
  v_pk_mul_f32 v[200:201], v[200:201], s[98:99]
  v_pk_mul_f32 v[202:203], v[202:203], s[98:99]
  v_pk_mul_f32 v[220:221], v[220:221], s[98:99]
  v_pk_mul_f32 v[222:223], v[222:223], s[98:99]
  v_pk_mul_f32 v[204:205], v[204:205], s[98:99]
  v_pk_mul_f32 v[206:207], v[206:207], s[98:99]
  v_pk_mul_f32 v[224:225], v[224:225], s[98:99]
  v_pk_mul_f32 v[226:227], v[226:227], s[98:99]
  v_cvt_pk_bf16_f32 v60, v200, v201
  v_cvt_pk_bf16_f32 v61, v202, v203
  v_cvt_pk_bf16_f32 v62, v220, v221
  v_cvt_pk_bf16_f32 v63, v222, v223
  v_cvt_pk_bf16_f32 v40, v204, v205
  v_cvt_pk_bf16_f32 v41, v206, v207
  v_cvt_pk_bf16_f32 v42, v224, v225
  v_cvt_pk_bf16_f32 v43, v226, v227
  v_accvgpr_write_b32 a168, v60
  v_accvgpr_write_b32 a169, v61
  v_accvgpr_write_b32 a170, v62
  v_accvgpr_write_b32 a171, v63
  v_accvgpr_write_b32 a172, v40
  v_accvgpr_write_b32 a173, v41
  v_accvgpr_write_b32 a174, v42
  v_accvgpr_write_b32 a175, v43
  v_accvgpr_read_b32 v48, a0
  v_accvgpr_read_b32 v49, a1
  v_accvgpr_read_b32 v50, a2
  v_accvgpr_read_b32 v51, a3
  v_pk_mul_f32 v[232:233], v[232:233], s[98:99]
  v_pk_mul_f32 v[234:235], v[234:235], s[98:99]
  v_pk_mul_f32 v[252:253], v[252:253], s[98:99]
  v_pk_mul_f32 v[254:255], v[254:255], s[98:99]
  v_pk_mul_f32 v[236:237], v[236:237], s[98:99]
  v_pk_mul_f32 v[238:239], v[238:239], s[98:99]
  v_pk_mul_f32 v[48:49], v[48:49], s[98:99]
  v_pk_mul_f32 v[50:51], v[50:51], s[98:99]
  v_cvt_pk_bf16_f32 v44, v232, v233
  v_cvt_pk_bf16_f32 v45, v234, v235
  v_cvt_pk_bf16_f32 v46, v252, v253
  v_cvt_pk_bf16_f32 v47, v254, v255
  v_cvt_pk_bf16_f32 v52, v236, v237
  v_cvt_pk_bf16_f32 v53, v238, v239
  v_cvt_pk_bf16_f32 v54, v48, v49
  v_cvt_pk_bf16_f32 v55, v50, v51
  v_accvgpr_write_b32 a180, v44
  v_accvgpr_write_b32 a181, v45
  v_accvgpr_write_b32 a182, v46
  v_accvgpr_write_b32 a183, v47
  v_accvgpr_write_b32 a184, v52
  v_accvgpr_write_b32 a185, v53
  v_accvgpr_write_b32 a186, v54
  v_accvgpr_write_b32 a187, v55
  v_accvgpr_read_b32 v56, a4
  v_accvgpr_read_b32 v57, a5
  v_accvgpr_read_b32 v58, a6
  v_accvgpr_read_b32 v59, a7
  v_accvgpr_read_b32 v40, a8
  v_accvgpr_read_b32 v41, a9
  v_accvgpr_read_b32 v42, a10
  v_accvgpr_read_b32 v43, a11
  v_pk_mul_f32 v[240:241], v[240:241], s[98:99]
  v_pk_mul_f32 v[242:243], v[242:243], s[98:99]
  v_pk_mul_f32 v[56:57], v[56:57], s[98:99]
  v_pk_mul_f32 v[58:59], v[58:59], s[98:99]
  v_pk_mul_f32 v[244:245], v[244:245], s[98:99]
  v_pk_mul_f32 v[246:247], v[246:247], s[98:99]
  v_pk_mul_f32 v[40:41], v[40:41], s[98:99]
  v_pk_mul_f32 v[42:43], v[42:43], s[98:99]
  v_cvt_pk_bf16_f32 v60, v240, v241
  v_cvt_pk_bf16_f32 v61, v242, v243
  v_cvt_pk_bf16_f32 v62, v56, v57
  v_cvt_pk_bf16_f32 v63, v58, v59
  v_cvt_pk_bf16_f32 v44, v244, v245
  v_cvt_pk_bf16_f32 v45, v246, v247
  v_cvt_pk_bf16_f32 v46, v40, v41
  v_cvt_pk_bf16_f32 v47, v42, v43
  v_accvgpr_write_b32 a188, v60
  v_accvgpr_write_b32 a189, v61
  v_accvgpr_write_b32 a190, v62
  v_accvgpr_write_b32 a191, v63
  v_accvgpr_write_b32 a192, v44
  v_accvgpr_write_b32 a193, v45
  v_accvgpr_write_b32 a194, v46
  v_accvgpr_write_b32 a195, v47
  v_accvgpr_read_b32 v48, a16
  v_accvgpr_read_b32 v49, a17
  v_accvgpr_read_b32 v50, a18
  v_accvgpr_read_b32 v51, a19
  v_accvgpr_read_b32 v52, a36
  v_accvgpr_read_b32 v53, a37
  v_accvgpr_read_b32 v54, a38
  v_accvgpr_read_b32 v55, a39
  v_accvgpr_read_b32 v60, a20
  v_accvgpr_read_b32 v61, a21
  v_accvgpr_read_b32 v62, a22
  v_accvgpr_read_b32 v63, a23
  v_accvgpr_read_b32 v40, a40
  v_accvgpr_read_b32 v41, a41
  v_accvgpr_read_b32 v42, a42
  v_accvgpr_read_b32 v43, a43
  v_pk_mul_f32 v[48:49], v[48:49], s[98:99]
  v_pk_mul_f32 v[50:51], v[50:51], s[98:99]
  v_pk_mul_f32 v[52:53], v[52:53], s[98:99]
  v_pk_mul_f32 v[54:55], v[54:55], s[98:99]
  v_pk_mul_f32 v[60:61], v[60:61], s[98:99]
  v_pk_mul_f32 v[62:63], v[62:63], s[98:99]
  v_pk_mul_f32 v[40:41], v[40:41], s[98:99]
  v_pk_mul_f32 v[42:43], v[42:43], s[98:99]
  v_cvt_pk_bf16_f32 v56, v48, v49
  v_cvt_pk_bf16_f32 v57, v50, v51
  v_cvt_pk_bf16_f32 v58, v52, v53
  v_cvt_pk_bf16_f32 v59, v54, v55
  v_cvt_pk_bf16_f32 v44, v60, v61
  v_cvt_pk_bf16_f32 v45, v62, v63
  v_cvt_pk_bf16_f32 v46, v40, v41
  v_cvt_pk_bf16_f32 v47, v42, v43
  v_accvgpr_write_b32 a200, v56
  v_accvgpr_write_b32 a201, v57
  v_accvgpr_write_b32 a202, v58
  v_accvgpr_write_b32 a203, v59
  v_accvgpr_write_b32 a204, v44
  v_accvgpr_write_b32 a205, v45
  v_accvgpr_write_b32 a206, v46
  v_accvgpr_write_b32 a207, v47
  v_accvgpr_read_b32 v48, a24
  v_accvgpr_read_b32 v49, a25
  v_accvgpr_read_b32 v50, a26
  v_accvgpr_read_b32 v51, a27
  v_accvgpr_read_b32 v52, a44
  v_accvgpr_read_b32 v53, a45
  v_accvgpr_read_b32 v54, a46
  v_accvgpr_read_b32 v55, a47
  v_accvgpr_read_b32 v60, a28
  v_accvgpr_read_b32 v61, a29
  v_accvgpr_read_b32 v62, a30
  v_accvgpr_read_b32 v63, a31
  v_accvgpr_read_b32 v40, a48
  v_accvgpr_read_b32 v41, a49
  v_accvgpr_read_b32 v42, a50
  v_accvgpr_read_b32 v43, a51
  v_pk_mul_f32 v[48:49], v[48:49], s[98:99]
  v_pk_mul_f32 v[50:51], v[50:51], s[98:99]
  v_pk_mul_f32 v[52:53], v[52:53], s[98:99]
  v_pk_mul_f32 v[54:55], v[54:55], s[98:99]
  v_pk_mul_f32 v[60:61], v[60:61], s[98:99]
  v_pk_mul_f32 v[62:63], v[62:63], s[98:99]
  v_pk_mul_f32 v[40:41], v[40:41], s[98:99]
  v_pk_mul_f32 v[42:43], v[42:43], s[98:99]
  v_cvt_pk_bf16_f32 v56, v48, v49
  v_cvt_pk_bf16_f32 v57, v50, v51
  v_cvt_pk_bf16_f32 v58, v52, v53
  v_cvt_pk_bf16_f32 v59, v54, v55
  v_cvt_pk_bf16_f32 v44, v60, v61
  v_cvt_pk_bf16_f32 v45, v62, v63
  v_cvt_pk_bf16_f32 v46, v40, v41
  v_cvt_pk_bf16_f32 v47, v42, v43
  v_accvgpr_write_b32 a208, v56
  v_accvgpr_write_b32 a209, v57
  v_accvgpr_write_b32 a210, v58
  v_accvgpr_write_b32 a211, v59
  v_accvgpr_write_b32 a212, v44
  v_accvgpr_write_b32 a213, v45
  v_accvgpr_write_b32 a214, v46
  v_accvgpr_write_b32 a215, v47
  v_accvgpr_read_b32 v48, a56
  v_accvgpr_read_b32 v49, a57
  v_accvgpr_read_b32 v50, a58
  v_accvgpr_read_b32 v51, a59
  v_accvgpr_read_b32 v52, a76
  v_accvgpr_read_b32 v53, a77
  v_accvgpr_read_b32 v54, a78
  v_accvgpr_read_b32 v55, a79
  v_accvgpr_read_b32 v60, a60
  v_accvgpr_read_b32 v61, a61
  v_accvgpr_read_b32 v62, a62
  v_accvgpr_read_b32 v63, a63
  v_accvgpr_read_b32 v40, a80
  v_accvgpr_read_b32 v41, a81
  v_accvgpr_read_b32 v42, a82
  v_accvgpr_read_b32 v43, a83
  v_pk_mul_f32 v[48:49], v[48:49], s[98:99]
  v_pk_mul_f32 v[50:51], v[50:51], s[98:99]
  v_pk_mul_f32 v[52:53], v[52:53], s[98:99]
  v_pk_mul_f32 v[54:55], v[54:55], s[98:99]
  v_pk_mul_f32 v[60:61], v[60:61], s[98:99]
  v_pk_mul_f32 v[62:63], v[62:63], s[98:99]
  v_pk_mul_f32 v[40:41], v[40:41], s[98:99]
  v_pk_mul_f32 v[42:43], v[42:43], s[98:99]
  v_cvt_pk_bf16_f32 v56, v48, v49
  v_cvt_pk_bf16_f32 v57, v50, v51
  v_cvt_pk_bf16_f32 v58, v52, v53
  v_cvt_pk_bf16_f32 v59, v54, v55
  v_cvt_pk_bf16_f32 v44, v60, v61
  v_cvt_pk_bf16_f32 v45, v62, v63
  v_cvt_pk_bf16_f32 v46, v40, v41
  v_cvt_pk_bf16_f32 v47, v42, v43
  v_accvgpr_write_b32 a220, v56
  v_accvgpr_write_b32 a221, v57
  v_accvgpr_write_b32 a222, v58
  v_accvgpr_write_b32 a223, v59
  v_accvgpr_write_b32 a224, v44
  v_accvgpr_write_b32 a225, v45
  v_accvgpr_write_b32 a226, v46
  v_accvgpr_write_b32 a227, v47
  v_accvgpr_read_b32 v48, a64
  v_accvgpr_read_b32 v49, a65
  v_accvgpr_read_b32 v50, a66
  v_accvgpr_read_b32 v51, a67
  v_accvgpr_read_b32 v52, a84
  v_accvgpr_read_b32 v53, a85
  v_accvgpr_read_b32 v54, a86
  v_accvgpr_read_b32 v55, a87
  v_accvgpr_read_b32 v60, a68
  v_accvgpr_read_b32 v61, a69
  v_accvgpr_read_b32 v62, a70
  v_accvgpr_read_b32 v63, a71
  v_accvgpr_read_b32 v40, a88
  v_accvgpr_read_b32 v41, a89
  v_accvgpr_read_b32 v42, a90
  v_accvgpr_read_b32 v43, a91
  v_pk_mul_f32 v[48:49], v[48:49], s[98:99]
  v_pk_mul_f32 v[50:51], v[50:51], s[98:99]
  v_pk_mul_f32 v[52:53], v[52:53], s[98:99]
  v_pk_mul_f32 v[54:55], v[54:55], s[98:99]
  v_pk_mul_f32 v[60:61], v[60:61], s[98:99]
  v_pk_mul_f32 v[62:63], v[62:63], s[98:99]
  v_pk_mul_f32 v[40:41], v[40:41], s[98:99]
  v_pk_mul_f32 v[42:43], v[42:43], s[98:99]
  v_cvt_pk_bf16_f32 v56, v48, v49
  v_cvt_pk_bf16_f32 v57, v50, v51
  v_cvt_pk_bf16_f32 v58, v52, v53
  v_cvt_pk_bf16_f32 v59, v54, v55
  v_cvt_pk_bf16_f32 v44, v60, v61
  v_cvt_pk_bf16_f32 v45, v62, v63
  v_cvt_pk_bf16_f32 v46, v40, v41
  v_cvt_pk_bf16_f32 v47, v42, v43
  v_accvgpr_write_b32 a228, v56
  v_accvgpr_write_b32 a229, v57
  v_accvgpr_write_b32 a230, v58
  v_accvgpr_write_b32 a231, v59
  v_accvgpr_write_b32 a232, v44
  v_accvgpr_write_b32 a233, v45
  v_accvgpr_write_b32 a234, v46
  v_accvgpr_write_b32 a235, v47
  v_pk_mul_f32 v[64:65], v[64:65], s[98:99]
  v_pk_mul_f32 v[66:67], v[66:67], s[98:99]
  v_pk_mul_f32 v[80:81], v[80:81], s[98:99]
  v_pk_mul_f32 v[82:83], v[82:83], s[98:99]
  v_pk_mul_f32 v[68:69], v[68:69], s[98:99]
  v_pk_mul_f32 v[70:71], v[70:71], s[98:99]
  v_pk_mul_f32 v[84:85], v[84:85], s[98:99]
  v_pk_mul_f32 v[86:87], v[86:87], s[98:99]
  v_cvt_pk_bf16_f32 v64, v64, v65
  v_cvt_pk_bf16_f32 v65, v66, v67
  v_cvt_pk_bf16_f32 v66, v80, v81
  v_cvt_pk_bf16_f32 v67, v82, v83
  v_cvt_pk_bf16_f32 v68, v68, v69
  v_cvt_pk_bf16_f32 v69, v70, v71
  v_cvt_pk_bf16_f32 v70, v84, v85
  v_cvt_pk_bf16_f32 v71, v86, v87
  v_pk_mul_f32 v[72:73], v[72:73], s[98:99]
  v_pk_mul_f32 v[74:75], v[74:75], s[98:99]
  v_pk_mul_f32 v[88:89], v[88:89], s[98:99]
  v_pk_mul_f32 v[90:91], v[90:91], s[98:99]
  v_pk_mul_f32 v[76:77], v[76:77], s[98:99]
  v_pk_mul_f32 v[78:79], v[78:79], s[98:99]
  v_pk_mul_f32 v[92:93], v[92:93], s[98:99]
  v_pk_mul_f32 v[94:95], v[94:95], s[98:99]
  v_cvt_pk_bf16_f32 v72, v72, v73
  v_cvt_pk_bf16_f32 v73, v74, v75
  v_cvt_pk_bf16_f32 v74, v88, v89
  v_cvt_pk_bf16_f32 v75, v90, v91
  v_cvt_pk_bf16_f32 v76, v76, v77
  v_cvt_pk_bf16_f32 v77, v78, v79
  v_cvt_pk_bf16_f32 v78, v92, v93
  v_cvt_pk_bf16_f32 v79, v94, v95
  v_pk_mul_f32 v[96:97], v[96:97], s[98:99]
  v_pk_mul_f32 v[98:99], v[98:99], s[98:99]
  v_pk_mul_f32 v[112:113], v[112:113], s[98:99]
  v_pk_mul_f32 v[114:115], v[114:115], s[98:99]
  v_pk_mul_f32 v[100:101], v[100:101], s[98:99]
  v_pk_mul_f32 v[102:103], v[102:103], s[98:99]
  v_pk_mul_f32 v[116:117], v[116:117], s[98:99]
  v_pk_mul_f32 v[118:119], v[118:119], s[98:99]
  v_cvt_pk_bf16_f32 v84, v96, v97
  v_cvt_pk_bf16_f32 v85, v98, v99
  v_cvt_pk_bf16_f32 v86, v112, v113
  v_cvt_pk_bf16_f32 v87, v114, v115
  v_cvt_pk_bf16_f32 v88, v100, v101
  v_cvt_pk_bf16_f32 v89, v102, v103
  v_cvt_pk_bf16_f32 v90, v116, v117
  v_cvt_pk_bf16_f32 v91, v118, v119
  v_pk_mul_f32 v[104:105], v[104:105], s[98:99]
  v_pk_mul_f32 v[106:107], v[106:107], s[98:99]
  v_pk_mul_f32 v[120:121], v[120:121], s[98:99]
  v_pk_mul_f32 v[122:123], v[122:123], s[98:99]
  v_pk_mul_f32 v[108:109], v[108:109], s[98:99]
  v_pk_mul_f32 v[110:111], v[110:111], s[98:99]
  v_pk_mul_f32 v[124:125], v[124:125], s[98:99]
  v_pk_mul_f32 v[126:127], v[126:127], s[98:99]
  v_cvt_pk_bf16_f32 v92, v104, v105
  v_cvt_pk_bf16_f32 v93, v106, v107
  v_cvt_pk_bf16_f32 v94, v120, v121
  v_cvt_pk_bf16_f32 v95, v122, v123
  v_cvt_pk_bf16_f32 v96, v108, v109
  v_cvt_pk_bf16_f32 v97, v110, v111
  v_cvt_pk_bf16_f32 v98, v124, v125
  v_cvt_pk_bf16_f32 v99, v126, v127
  v_pk_mul_f32 v[128:129], v[128:129], s[98:99]
  v_pk_mul_f32 v[130:131], v[130:131], s[98:99]
  v_pk_mul_f32 v[144:145], v[144:145], s[98:99]
  v_pk_mul_f32 v[146:147], v[146:147], s[98:99]
  v_pk_mul_f32 v[132:133], v[132:133], s[98:99]
  v_pk_mul_f32 v[134:135], v[134:135], s[98:99]
  v_pk_mul_f32 v[148:149], v[148:149], s[98:99]
  v_pk_mul_f32 v[150:151], v[150:151], s[98:99]
  v_cvt_pk_bf16_f32 v104, v128, v129
  v_cvt_pk_bf16_f32 v105, v130, v131
  v_cvt_pk_bf16_f32 v106, v144, v145
  v_cvt_pk_bf16_f32 v107, v146, v147
  v_cvt_pk_bf16_f32 v108, v132, v133
  v_cvt_pk_bf16_f32 v109, v134, v135
  v_cvt_pk_bf16_f32 v110, v148, v149
  v_cvt_pk_bf16_f32 v111, v150, v151
  v_pk_mul_f32 v[136:137], v[136:137], s[98:99]
  v_pk_mul_f32 v[138:139], v[138:139], s[98:99]
  v_pk_mul_f32 v[152:153], v[152:153], s[98:99]
  v_pk_mul_f32 v[154:155], v[154:155], s[98:99]
  v_pk_mul_f32 v[140:141], v[140:141], s[98:99]
  v_pk_mul_f32 v[142:143], v[142:143], s[98:99]
  v_pk_mul_f32 v[156:157], v[156:157], s[98:99]
  v_pk_mul_f32 v[158:159], v[158:159], s[98:99]
  v_cvt_pk_bf16_f32 v112, v136, v137
  v_cvt_pk_bf16_f32 v113, v138, v139
  v_cvt_pk_bf16_f32 v114, v152, v153
  v_cvt_pk_bf16_f32 v115, v154, v155
  v_cvt_pk_bf16_f32 v116, v140, v141
  v_cvt_pk_bf16_f32 v117, v142, v143
  v_cvt_pk_bf16_f32 v118, v156, v157
  v_cvt_pk_bf16_f32 v119, v158, v159
  v_pk_mul_f32 v[160:161], v[160:161], s[98:99]
  v_pk_mul_f32 v[162:163], v[162:163], s[98:99]
  v_pk_mul_f32 v[176:177], v[176:177], s[98:99]
  v_pk_mul_f32 v[178:179], v[178:179], s[98:99]
  v_pk_mul_f32 v[164:165], v[164:165], s[98:99]
  v_pk_mul_f32 v[166:167], v[166:167], s[98:99]
  v_pk_mul_f32 v[180:181], v[180:181], s[98:99]
  v_pk_mul_f32 v[182:183], v[182:183], s[98:99]
  v_cvt_pk_bf16_f32 v124, v160, v161
  v_cvt_pk_bf16_f32 v125, v162, v163
  v_cvt_pk_bf16_f32 v126, v176, v177
  v_cvt_pk_bf16_f32 v127, v178, v179
  v_cvt_pk_bf16_f32 v128, v164, v165
  v_cvt_pk_bf16_f32 v129, v166, v167
  v_cvt_pk_bf16_f32 v130, v180, v181
  v_cvt_pk_bf16_f32 v131, v182, v183
  v_pk_mul_f32 v[168:169], v[168:169], s[98:99]
  v_pk_mul_f32 v[170:171], v[170:171], s[98:99]
  v_pk_mul_f32 v[184:185], v[184:185], s[98:99]
  v_pk_mul_f32 v[186:187], v[186:187], s[98:99]
  v_pk_mul_f32 v[172:173], v[172:173], s[98:99]
  v_pk_mul_f32 v[174:175], v[174:175], s[98:99]
  v_pk_mul_f32 v[188:189], v[188:189], s[98:99]
  v_pk_mul_f32 v[190:191], v[190:191], s[98:99]
  v_cvt_pk_bf16_f32 v132, v168, v169
  v_cvt_pk_bf16_f32 v133, v170, v171
  v_cvt_pk_bf16_f32 v134, v184, v185
  v_cvt_pk_bf16_f32 v135, v186, v187
  v_cvt_pk_bf16_f32 v136, v172, v173
  v_cvt_pk_bf16_f32 v137, v174, v175
  v_cvt_pk_bf16_f32 v138, v188, v189
  v_cvt_pk_bf16_f32 v139, v190, v191
  s_waitcnt lgkmcnt(0)
  s_barrier
  ds_read_b128 v[80:83], v33 offset:0
  ds_read_b128 a[176:179], v33 offset:4096
  ds_read_b128 v[100:103], v33 offset:1024
  ds_read_b128 a[196:199], v33 offset:5120
  ds_read_b128 v[120:123], v33 offset:2048
  ds_read_b128 a[216:219], v33 offset:6144
  ds_read_b128 v[140:143], v33 offset:3072
  ds_read_b128 a[236:239], v33 offset:7168
K1_ATT:
  v_mov_b32 v56, 0x3f803f80
  v_mov_b32 v57, 0x3f803f80
  v_mov_b32 v58, 0x3f803f80
  v_mov_b32 v59, 0x3f803f80
  s_mov_b32 s48, 0
  s_mov_b32 s49, 0
  s_waitcnt vmcnt(18)
  s_waitcnt lgkmcnt(0)
  s_barrier
  s_add_u32 m0, s43, 98304
  s_nop 0
  buffer_load_dwordx4 v38, s[20:23], s54 offen offset:0 nt lds
  buffer_load_dwordx4 v39, s[20:23], s54 offen offset:1024 nt lds
K1_A:
  ds_read_b128 a[240:243], v8 offset:0
  ds_read_b128 a[244:247], v9 offset:0
  ds_read_b128 a[248:251], v10 offset:0
  ds_read_b128 a[252:255], v11 offset:0
  s_waitcnt lgkmcnt(3)
  v_mfma_f32_16x16x32_bf16 v[144:147], a[240:243], v[64:67], 0
  buffer_load_dwordx4 v38, s[20:23], s54 offen offset:2048 nt lds
  v_mfma_f32_16x16x32_bf16 v[152:155], a[240:243], v[68:71], 0
  v_mfma_f32_16x16x32_bf16 v[160:163], a[240:243], v[72:75], 0
  v_mfma_f32_16x16x32_bf16 v[168:171], a[240:243], v[76:79], 0
  v_mfma_f32_16x16x32_bf16 v[176:179], a[240:243], v[80:83], 0
  ds_read_b128 a[240:243], v8 offset:4096
  s_waitcnt lgkmcnt(3)
  v_mfma_f32_16x16x32_bf16 v[144:147], a[244:247], v[84:87], v[144:147]
  v_mfma_f32_16x16x32_bf16 v[152:155], a[244:247], v[88:91], v[152:155]
  v_mfma_f32_16x16x32_bf16 v[160:163], a[244:247], v[92:95], v[160:163]
  v_mfma_f32_16x16x32_bf16 v[168:171], a[244:247], v[96:99], v[168:171]
  v_mfma_f32_16x16x32_bf16 v[176:179], a[244:247], v[100:103], v[176:179]
  s_waitcnt lgkmcnt(2)
  v_mfma_f32_16x16x32_bf16 v[144:147], a[248:251], v[104:107], v[144:147]
  ds_read_b128 a[244:247], v9 offset:4096
  v_mfma_f32_16x16x32_bf16 v[152:155], a[248:251], v[108:111], v[152:155]
  v_mfma_f32_16x16x32_bf16 v[160:163], a[248:251], v[112:115], v[160:163]
  v_mfma_f32_16x16x32_bf16 v[168:171], a[248:251], v[116:119], v[168:171]
  v_mfma_f32_16x16x32_bf16 v[176:179], a[248:251], v[120:123], v[176:179]
  ds_read_b128 a[248:251], v10 offset:4096
  s_waitcnt lgkmcnt(3)
  v_mfma_f32_16x16x32_bf16 v[144:147], a[252:255], v[124:127], v[144:147]
  buffer_load_dwordx4 v39, s[20:23], s54 offen offset:3072 nt lds
  s_add_u32 s54, s54, 16384
  v_mfma_f32_16x16x32_bf16 v[152:155], a[252:255], v[128:131], v[152:155]
  v_mfma_f32_16x16x32_bf16 v[160:163], a[252:255], v[132:135], v[160:163]
  v_mfma_f32_16x16x32_bf16 v[168:171], a[252:255], v[136:139], v[168:171]
  v_mfma_f32_16x16x32_bf16 v[176:179], a[252:255], v[140:143], v[176:179]
  ds_read_b128 a[252:255], v11 offset:4096
  s_waitcnt lgkmcnt(3)
  v_mfma_f32_16x16x32_bf16 v[148:151], a[240:243], v[64:67], 0
  v_mfma_f32_16x16x32_bf16 v[156:159], a[240:243], v[68:71], 0
  v_mfma_f32_16x16x32_bf16 v[164:167], a[240:243], v[72:75], 0
  v_mfma_f32_16x16x32_bf16 v[172:175], a[240:243], v[76:79], 0
  s_add_u32 m0, s43, 32768
  s_nop 0
  buffer_load_dwordx4 v34, s[16:19], s47 offen offset:0 nt lds
  v_mfma_f32_16x16x32_bf16 v[180:183], a[240:243], v[80:83], 0
  s_waitcnt lgkmcnt(2)
  v_mfma_f32_16x16x32_bf16 v[148:151], a[244:247], v[84:87], v[148:151]
  v_mfma_f32_16x16x32_bf16 v[156:159], a[244:247], v[88:91], v[156:159]
  v_mfma_f32_16x16x32_bf16 v[164:167], a[244:247], v[92:95], v[164:167]
  v_mfma_f32_16x16x32_bf16 v[172:175], a[244:247], v[96:99], v[172:175]
  v_mfma_f32_16x16x32_bf16 v[180:183], a[244:247], v[100:103], v[180:183]
  s_waitcnt lgkmcnt(1)
  v_mfma_f32_16x16x32_bf16 v[148:151], a[248:251], v[104:107], v[148:151]
  v_mfma_f32_16x16x32_bf16 v[156:159], a[248:251], v[108:111], v[156:159]
  buffer_load_dwordx4 v35, s[16:19], s47 offen offset:1024 nt lds
  v_mfma_f32_16x16x32_bf16 v[164:167], a[248:251], v[112:115], v[164:167]
  v_mfma_f32_16x16x32_bf16 v[172:175], a[248:251], v[116:119], v[172:175]
  v_mfma_f32_16x16x32_bf16 v[180:183], a[248:251], v[120:123], v[180:183]
  s_waitcnt lgkmcnt(0)
  v_mfma_f32_16x16x32_bf16 v[148:151], a[252:255], v[124:127], v[148:151]
  v_mfma_f32_16x16x32_bf16 v[156:159], a[252:255], v[128:131], v[156:159]
  v_mfma_f32_16x16x32_bf16 v[164:167], a[252:255], v[132:135], v[164:167]
  ds_read_b128 a[240:243], v12 offset:0
  v_mfma_f32_16x16x32_bf16 v[172:175], a[252:255], v[136:139], v[172:175]
  v_mfma_f32_16x16x32_bf16 v[180:183], a[252:255], v[140:143], v[180:183]
  buffer_load_dwordx4 v36, s[16:19], s47 offen offset:2048 nt lds
  s_cmp_eq_u32 s49, 1
  s_cbranch_scc1 K1_AGIVEN
  v_max3_f32 v216, v144, v145, v146
  v_max3_f32 v220, v152, v153, v154
  v_max3_f32 v224, v160, v161, v162
  v_max3_f32 v228, v168, v169, v170
  v_max3_f32 v232, v176, v177, v178
  v_max3_f32 v217, v147, v148, v149
  v_max3_f32 v221, v155, v156, v157
  v_max3_f32 v225, v163, v164, v165
  v_max3_f32 v229, v171, v172, v173
  v_max3_f32 v233, v179, v180, v181
  v_max3_f32 v216, v216, v150, v151
  v_max3_f32 v220, v220, v158, v159
  v_max3_f32 v224, v224, v166, v167
  v_max3_f32 v228, v228, v174, v175
  v_max3_f32 v232, v232, v182, v183
  v_max_f32 v216, v216, v217
  v_max_f32 v220, v220, v221
  v_max_f32 v224, v224, v225
  v_max_f32 v228, v228, v229
  v_max_f32 v232, v232, v233
  v_mov_b32 v217, v216
  v_mov_b32 v221, v220
  v_mov_b32 v225, v224
  v_mov_b32 v229, v228
  v_mov_b32 v233, v232
  v_permlane32_swap_b32 v216, v217
  v_permlane32_swap_b32 v220, v221
  v_permlane32_swap_b32 v224, v225
  v_permlane32_swap_b32 v228, v229
  v_permlane32_swap_b32 v232, v233
  v_max_f32 v216, v216, v217
  v_max_f32 v220, v220, v221
  v_max_f32 v224, v224, v225
  v_max_f32 v228, v228, v229
  v_max_f32 v232, v232, v233
  v_mov_b32 v217, v216
  v_mov_b32 v221, v220
  v_mov_b32 v225, v224
  v_mov_b32 v229, v228
  v_mov_b32 v233, v232
  v_permlane16_swap_b32 v216, v217
  v_permlane16_swap_b32 v220, v221
  v_permlane16_swap_b32 v224, v225
  v_permlane16_swap_b32 v228, v229
  v_permlane16_swap_b32 v232, v233
  v_max_f32 v216, v216, v217
  v_max_f32 v220, v220, v221
  v_max_f32 v224, v224, v225
  v_max_f32 v228, v228, v229
  v_max_f32 v232, v232, v233
  v_sub_f32 v216, 0, v216
  v_sub_f32 v220, 0, v220
  v_sub_f32 v224, 0, v224
  v_sub_f32 v228, 0, v228
  v_sub_f32 v232, 0, v232
  v_mov_b32 v217, v216
  v_mov_b32 v221, v220
  v_mov_b32 v225, v224
  v_mov_b32 v229, v228
  v_mov_b32 v233, v232
  v_mov_b32 v218, v216
  v_mov_b32 v222, v220
  v_mov_b32 v226, v224
  v_mov_b32 v230, v228
  v_mov_b32 v234, v232
  v_mov_b32 v219, v216
  v_mov_b32 v223, v220
  v_mov_b32 v227, v224
  v_mov_b32 v231, v228
  v_mov_b32 v235, v232
K1_AGIVEN:
  v_add_f32 v144, v216, v144
  v_add_f32 v152, v220, v152
  v_add_f32 v160, v224, v160
  v_add_f32 v168, v228, v168
  v_add_f32 v176, v232, v176
  v_add_f32 v145, v216, v145
  v_add_f32 v153, v220, v153
  v_add_f32 v161, v224, v161
  v_add_f32 v169, v228, v169
  v_add_f32 v177, v232, v177
  v_add_f32 v146, v216, v146
  v_add_f32 v154, v220, v154
  v_add_f32 v162, v224, v162
  v_add_f32 v170, v228, v170
  v_add_f32 v178, v232, v178
  v_add_f32 v147, v216, v147
  v_add_f32 v155, v220, v155
  v_add_f32 v163, v224, v163
  v_add_f32 v171, v228, v171
  v_add_f32 v179, v232, v179
  v_add_f32 v148, v216, v148
  v_add_f32 v156, v220, v156
  v_add_f32 v164, v224, v164
  v_add_f32 v172, v228, v172
  v_add_f32 v180, v232, v180
  v_add_f32 v149, v216, v149
  v_add_f32 v157, v220, v157
  v_add_f32 v165, v224, v165
  v_add_f32 v173, v228, v173
  v_add_f32 v181, v232, v181
  v_add_f32 v150, v216, v150
  v_add_f32 v158, v220, v158
  v_add_f32 v166, v224, v166
  v_add_f32 v174, v228, v174
  v_add_f32 v182, v232, v182
  v_add_f32 v151, v216, v151
  v_add_f32 v159, v220, v159
  v_add_f32 v167, v224, v167
  v_add_f32 v175, v228, v175
  v_add_f32 v183, v232, v183
  v_exp_f32 v144, v144
  v_exp_f32 v145, v145
  s_nop 0
  v_cvt_pk_bf16_f32 v144, v144, v145
  v_exp_f32 v146, v146
  v_exp_f32 v147, v147
  s_nop 0
  v_cvt_pk_bf16_f32 v145, v146, v147
  v_exp_f32 v152, v152
  v_exp_f32 v153, v153
  s_nop 0
  v_cvt_pk_bf16_f32 v152, v152, v153
  v_exp_f32 v154, v154
  v_exp_f32 v155, v155
  s_nop 0
  v_cvt_pk_bf16_f32 v153, v154, v155
  v_exp_f32 v160, v160
  ds_read_b128 a[244:247], v13 offset:0
  v_exp_f32 v161, v161
  s_nop 0
  v_cvt_pk_bf16_f32 v160, v160, v161
  v_exp_f32 v162, v162
  ds_read_b128 a[248:251], v14 offset:0
  v_exp_f32 v163, v163
  s_nop 0
  v_cvt_pk_bf16_f32 v161, v162, v163
  v_exp_f32 v168, v168
  ds_read_b128 a[252:255], v15 offset:0
  v_exp_f32 v169, v169
  s_nop 0
  v_cvt_pk_bf16_f32 v168, v168, v169
  v_exp_f32 v170, v170
  buffer_load_dwordx4 v37, s[16:19], s47 offen offset:3072 nt lds
  s_add_u32 s47, s47, 16384
  v_exp_f32 v171, v171
  s_nop 0
  v_cvt_pk_bf16_f32 v169, v170, v171
  v_exp_f32 v176, v176
  v_exp_f32 v177, v177
  s_nop 0
  v_cvt_pk_bf16_f32 v176, v176, v177
  v_exp_f32 v178, v178
  v_exp_f32 v179, v179
  s_nop 0
  v_cvt_pk_bf16_f32 v177, v178, v179
  v_exp_f32 v148, v148
  v_exp_f32 v149, v149
  s_nop 0
  v_cvt_pk_bf16_f32 v146, v148, v149
  v_exp_f32 v150, v150
  v_exp_f32 v151, v151
  s_nop 0
  v_cvt_pk_bf16_f32 v147, v150, v151
  v_exp_f32 v156, v156
  ds_read_b64_tr_b16 v[40:41], v16 offset:0
  ds_read_b64_tr_b16 v[42:43], v16 offset:4096
  v_exp_f32 v157, v157
  s_nop 0
  v_cvt_pk_bf16_f32 v154, v156, v157
  s_waitcnt lgkmcnt(5)
  v_mfma_f32_16x16x32_bf16 v[184:187], a[240:243], v[64:67], v[216:219]
  v_exp_f32 v158, v158
  v_mfma_f32_16x16x32_bf16 v[192:195], a[240:243], v[68:71], v[220:223]
  v_mfma_f32_16x16x32_bf16 v[200:203], a[240:243], v[72:75], v[224:227]
  v_exp_f32 v159, v159
  v_mfma_f32_16x16x32_bf16 v[208:211], a[240:243], v[76:79], v[228:231]
  ds_read_b128 a[240:243], v12 offset:4096
  v_cvt_pk_bf16_f32 v155, v158, v159
  s_waitcnt lgkmcnt(5)
  v_mfma_f32_16x16x32_bf16 v[184:187], a[244:247], v[84:87], v[184:187]
  v_exp_f32 v164, v164
  v_mfma_f32_16x16x32_bf16 v[192:195], a[244:247], v[88:91], v[192:195]
  ds_read_b64_tr_b16 v[44:45], v17 offset:0
  ds_read_b64_tr_b16 v[46:47], v17 offset:4096
  v_mfma_f32_16x16x32_bf16 v[200:203], a[244:247], v[92:95], v[200:203]
  v_exp_f32 v165, v165
  v_mfma_f32_16x16x32_bf16 v[208:211], a[244:247], v[96:99], v[208:211]
  ds_read_b128 a[244:247], v13 offset:4096
  v_cvt_pk_bf16_f32 v162, v164, v165
  s_waitcnt lgkmcnt(7)
  v_mfma_f32_16x16x32_bf16 v[184:187], a[248:251], v[104:107], v[184:187]
  v_exp_f32 v166, v166
  v_mfma_f32_16x16x32_bf16 v[192:195], a[248:251], v[108:111], v[192:195]
  ds_read_b64_tr_b16 v[48:49], v18 offset:0
  ds_read_b64_tr_b16 v[50:51], v18 offset:4096
  v_mfma_f32_16x16x32_bf16 v[200:203], a[248:251], v[112:115], v[200:203]
  v_exp_f32 v167, v167
  v_mfma_f32_16x16x32_bf16 v[208:211], a[248:251], v[116:119], v[208:211]
  ds_read_b128 a[248:251], v14 offset:4096
  v_cvt_pk_bf16_f32 v163, v166, v167
  s_waitcnt lgkmcnt(9)
  v_mfma_f32_16x16x32_bf16 v[184:187], a[252:255], v[124:127], v[184:187]
  v_exp_f32 v172, v172
  v_mfma_f32_16x16x32_bf16 v[192:195], a[252:255], v[128:131], v[192:195]
  ds_read_b64_tr_b16 v[52:53], v19 offset:0
  ds_read_b64_tr_b16 v[54:55], v19 offset:4096
  v_mfma_f32_16x16x32_bf16 v[200:203], a[252:255], v[132:135], v[200:203]
  v_exp_f32 v173, v173
  v_mfma_f32_16x16x32_bf16 v[208:211], a[252:255], v[136:139], v[208:211]
  ds_read_b128 a[252:255], v15 offset:4096
  v_cvt_pk_bf16_f32 v170, v172, v173
  s_waitcnt lgkmcnt(9)
  v_mfma_f32_16x16x32_bf16 v[188:191], a[240:243], v[64:67], v[216:219]
  v_exp_f32 v174, v174
  v_mfma_f32_16x16x32_bf16 v[196:199], a[240:243], v[68:71], v[220:223]
  v_mfma_f32_16x16x32_bf16 v[204:207], a[240:243], v[72:75], v[224:227]
  v_exp_f32 v175, v175
  v_mfma_f32_16x16x32_bf16 v[212:215], a[240:243], v[76:79], v[228:231]
  v_cvt_pk_bf16_f32 v171, v174, v175
  s_waitcnt lgkmcnt(6)
  v_mfma_f32_16x16x32_bf16 v[188:191], a[244:247], v[84:87], v[188:191]
  v_exp_f32 v180, v180
  v_mfma_f32_16x16x32_bf16 v[196:199], a[244:247], v[88:91], v[196:199]
  v_mfma_f32_16x16x32_bf16 v[204:207], a[244:247], v[92:95], v[204:207]
  v_exp_f32 v181, v181
  v_mfma_f32_16x16x32_bf16 v[212:215], a[244:247], v[96:99], v[212:215]
  v_cvt_pk_bf16_f32 v178, v180, v181
  s_waitcnt lgkmcnt(3)
  v_mfma_f32_16x16x32_bf16 v[188:191], a[248:251], v[104:107], v[188:191]
  v_exp_f32 v182, v182
  v_mfma_f32_16x16x32_bf16 v[196:199], a[248:251], v[108:111], v[196:199]
  v_mfma_f32_16x16x32_bf16 v[204:207], a[248:251], v[112:115], v[204:207]
  v_exp_f32 v183, v183
  v_mfma_f32_16x16x32_bf16 v[212:215], a[248:251], v[116:119], v[212:215]
  v_cvt_pk_bf16_f32 v179, v182, v183
  s_waitcnt lgkmcnt(0)
  v_mfma_f32_16x16x32_bf16 v[188:191], a[252:255], v[124:127], v[188:191]
  v_exp_f32 v184, v184
  v_mfma_f32_16x16x32_bf16 v[196:199], a[252:255], v[128:131], v[196:199]
  v_mfma_f32_16x16x32_bf16 v[204:207], a[252:255], v[132:135], v[204:207]
  v_exp_f32 v185, v185
  v_mfma_f32_16x16x32_bf16 v[212:215], a[252:255], v[136:139], v[212:215]
  v_cvt_pk_bf16_f32 v184, v184, v185
  v_mfma_f32_16x16x32_bf16 v[236:239], v[56:59], v[144:147], 0
  v_exp_f32 v186, v186
  v_mfma_f32_16x16x32_bf16 v[240:243], v[56:59], v[152:155], 0
  v_mfma_f32_16x16x32_bf16 v[244:247], v[56:59], v[160:163], 0
  v_exp_f32 v187, v187
  v_mfma_f32_16x16x32_bf16 v[248:251], v[56:59], v[168:171], 0
  v_cvt_pk_bf16_f32 v185, v186, v187
  v_mfma_f32_16x16x32_bf16 v[252:255], v[56:59], v[176:179], 0
  v_exp_f32 v192, v192
  v_mfma_f32_16x16x32_bf16 a[0:3], v[40:43], v[144:147], 0
  v_mfma_f32_16x16x32_bf16 a[32:35], v[40:43], v[152:155], 0
  v_exp_f32 v193, v193
  v_mfma_f32_16x16x32_bf16 a[64:67], v[40:43], v[160:163], 0
  v_cvt_pk_bf16_f32 v192, v192, v193
  v_mfma_f32_16x16x32_bf16 a[96:99], v[40:43], v[168:171], 0
  v_exp_f32 v194, v194
  v_mfma_f32_16x16x32_bf16 a[128:131], v[40:43], v[176:179], 0
  ds_read_b64_tr_b16 v[40:41], v20 offset:0
  ds_read_b64_tr_b16 v[42:43], v20 offset:4096
  v_mfma_f32_16x16x32_bf16 a[4:7], v[44:47], v[144:147], 0
  v_exp_f32 v195, v195
  v_mfma_f32_16x16x32_bf16 a[36:39], v[44:47], v[152:155], 0
  v_cvt_pk_bf16_f32 v193, v194, v195
  v_mfma_f32_16x16x32_bf16 a[68:71], v[44:47], v[160:163], 0
  v_exp_f32 v200, v200
  v_mfma_f32_16x16x32_bf16 a[100:103], v[44:47], v[168:171], 0
  v_mfma_f32_16x16x32_bf16 a[132:135], v[44:47], v[176:179], 0
  v_exp_f32 v201, v201
  v_mfma_f32_16x16x32_bf16 a[8:11], v[48:51], v[144:147], 0
  ds_read_b64_tr_b16 v[44:45], v21 offset:0
  v_cvt_pk_bf16_f32 v200, v200, v201
  v_mfma_f32_16x16x32_bf16 a[40:43], v[48:51], v[152:155], 0
  v_exp_f32 v202, v202
  v_mfma_f32_16x16x32_bf16 a[72:75], v[48:51], v[160:163], 0
  ds_read_b64_tr_b16 v[46:47], v21 offset:4096
  v_mfma_f32_16x16x32_bf16 a[104:107], v[48:51], v[168:171], 0
  v_exp_f32 v203, v203
  v_mfma_f32_16x16x32_bf16 a[136:139], v[48:51], v[176:179], 0
  ds_read_b64_tr_b16 v[48:49], v22 offset:0
  v_cvt_pk_bf16_f32 v201, v202, v203
  v_mfma_f32_16x16x32_bf16 a[12:15], v[52:55], v[144:147], 0
  s_waitcnt vmcnt(8)
  s_barrier
  v_exp_f32 v208, v208
  v_mfma_f32_16x16x32_bf16 a[44:47], v[52:55], v[152:155], 0
  ds_read_b64_tr_b16 v[50:51], v22 offset:4096
  ds_read_b128 a[240:243], v8 offset:16384
  v_mfma_f32_16x16x32_bf16 a[76:79], v[52:55], v[160:163], 0
  v_exp_f32 v209, v209
  v_mfma_f32_16x16x32_bf16 a[108:111], v[52:55], v[168:171], 0
  ds_read_b128 a[244:247], v9 offset:16384
  v_cvt_pk_bf16_f32 v208, v208, v209
  v_mfma_f32_16x16x32_bf16 a[140:143], v[52:55], v[176:179], 0
  v_exp_f32 v210, v210
  s_waitcnt lgkmcnt(6)
  v_mfma_f32_16x16x32_bf16 a[16:19], v[40:43], v[144:147], 0
  ds_read_b64_tr_b16 v[52:53], v23 offset:0
  ds_read_b64_tr_b16 v[54:55], v23 offset:4096
  v_mfma_f32_16x16x32_bf16 a[48:51], v[40:43], v[152:155], 0
  v_exp_f32 v211, v211
  v_mfma_f32_16x16x32_bf16 a[80:83], v[40:43], v[160:163], 0
  ds_read_b128 a[248:251], v10 offset:16384
  v_cvt_pk_bf16_f32 v209, v210, v211
  v_mfma_f32_16x16x32_bf16 a[112:115], v[40:43], v[168:171], 0
  v_exp_f32 v188, v188
  v_mfma_f32_16x16x32_bf16 a[144:147], v[40:43], v[176:179], 0
  ds_read_b128 a[252:255], v11 offset:16384
  s_add_u32 m0, s43, 114688
  s_nop 0
  buffer_load_dwordx4 v38, s[20:23], s54 offen offset:0 nt lds
  s_waitcnt lgkmcnt(8)
  v_mfma_f32_16x16x32_bf16 a[20:23], v[44:47], v[144:147], 0
  v_exp_f32 v189, v189
  v_mfma_f32_16x16x32_bf16 a[52:55], v[44:47], v[152:155], 0
  v_cvt_pk_bf16_f32 v186, v188, v189
  v_mfma_f32_16x16x32_bf16 a[84:87], v[44:47], v[160:163], 0
  v_exp_f32 v190, v190
  v_mfma_f32_16x16x32_bf16 a[116:119], v[44:47], v[168:171], 0
  v_mfma_f32_16x16x32_bf16 a[148:151], v[44:47], v[176:179], 0
  v_exp_f32 v191, v191
  s_waitcnt lgkmcnt(6)
  v_mfma_f32_16x16x32_bf16 a[24:27], v[48:51], v[144:147], 0
  v_cvt_pk_bf16_f32 v187, v190, v191
  v_mfma_f32_16x16x32_bf16 a[56:59], v[48:51], v[152:155], 0
  v_exp_f32 v196, v196
  v_mfma_f32_16x16x32_bf16 a[88:91], v[48:51], v[160:163], 0
  buffer_load_dwordx4 v39, s[20:23], s54 offen offset:1024 nt lds
  v_mfma_f32_16x16x32_bf16 a[120:123], v[48:51], v[168:171], 0
  v_exp_f32 v197, v197
  v_mfma_f32_16x16x32_bf16 a[152:155], v[48:51], v[176:179], 0
  v_cvt_pk_bf16_f32 v194, v196, v197
  s_waitcnt lgkmcnt(2)
  v_mfma_f32_16x16x32_bf16 a[28:31], v[52:55], v[144:147], 0
  v_exp_f32 v198, v198
  v_mfma_f32_16x16x32_bf16 a[60:63], v[52:55], v[152:155], 0
  v_mfma_f32_16x16x32_bf16 a[92:95], v[52:55], v[160:163], 0
  v_exp_f32 v199, v199
  v_mfma_f32_16x16x32_bf16 a[124:127], v[52:55], v[168:171], 0
  v_cvt_pk_bf16_f32 v195, v198, v199
  v_mfma_f32_16x16x32_bf16 a[156:159], v[52:55], v[176:179], 0
  v_exp_f32 v204, v204
  v_mfma_f32_16x16x32_bf16 v[144:147], a[240:243], v[64:67], v[216:219]
  buffer_load_dwordx4 v38, s[20:23], s54 offen offset:2048 nt lds
  v_mfma_f32_16x16x32_bf16 v[152:155], a[240:243], v[68:71], v[220:223]
  v_exp_f32 v205, v205
  v_mfma_f32_16x16x32_bf16 v[160:163], a[240:243], v[72:75], v[224:227]
  v_cvt_pk_bf16_f32 v202, v204, v205
  v_mfma_f32_16x16x32_bf16 v[168:171], a[240:243], v[76:79], v[228:231]
  v_exp_f32 v206, v206
  v_mfma_f32_16x16x32_bf16 v[176:179], a[240:243], v[80:83], v[232:235]
  ds_read_b128 a[240:243], v8 offset:20480
  ds_read_b64_tr_b16 v[40:41], v24 offset:0
  v_mfma_f32_16x16x32_bf16 v[144:147], a[244:247], v[84:87], v[144:147]
  v_exp_f32 v207, v207
  v_mfma_f32_16x16x32_bf16 v[152:155], a[244:247], v[88:91], v[152:155]
  ds_read_b64_tr_b16 v[42:43], v24 offset:4096
  v_cvt_pk_bf16_f32 v203, v206, v207
  v_mfma_f32_16x16x32_bf16 v[160:163], a[244:247], v[92:95], v[160:163]
  v_exp_f32 v212, v212
  v_mfma_f32_16x16x32_bf16 v[168:171], a[244:247], v[96:99], v[168:171]
  ds_read_b64_tr_b16 v[44:45], v25 offset:0
  ds_read_b64_tr_b16 v[46:47], v25 offset:4096
  v_mfma_f32_16x16x32_bf16 v[176:179], a[244:247], v[100:103], v[176:179]
  v_exp_f32 v213, v213
  s_waitcnt lgkmcnt(6)
  v_mfma_f32_16x16x32_bf16 v[144:147], a[248:251], v[104:107], v[144:147]
  ds_read_b128 a[244:247], v9 offset:20480
  v_cvt_pk_bf16_f32 v210, v212, v213
  v_mfma_f32_16x16x32_bf16 v[152:155], a[248:251], v[108:111], v[152:155]
  v_exp_f32 v214, v214
  v_mfma_f32_16x16x32_bf16 v[160:163], a[248:251], v[112:115], v[160:163]
  ds_read_b64_tr_b16 v[48:49], v26 offset:0
  ds_read_b64_tr_b16 v[50:51], v26 offset:4096
  v_mfma_f32_16x16x32_bf16 v[168:171], a[248:251], v[116:119], v[168:171]
  v_exp_f32 v215, v215
  v_mfma_f32_16x16x32_bf16 v[176:179], a[248:251], v[120:123], v[176:179]
  ds_read_b128 a[248:251], v10 offset:20480
  v_cvt_pk_bf16_f32 v211, v214, v215
  s_waitcnt lgkmcnt(9)
  v_mfma_f32_16x16x32_bf16 v[144:147], a[252:255], v[124:127], v[144:147]
  buffer_load_dwordx4 v39, s[20:23], s54 offen offset:3072 nt lds
  s_add_u32 s54, s54, 16384
  v_mfma_f32_16x16x32_bf16 v[152:155], a[252:255], v[128:131], v[152:155]
  ds_read_b64_tr_b16 v[52:53], v27 offset:0
  ds_read_b64_tr_b16 v[54:55], v27 offset:4096
  v_mfma_f32_16x16x32_bf16 v[160:163], a[252:255], v[132:135], v[160:163]
  v_mfma_f32_16x16x32_bf16 v[168:171], a[252:255], v[136:139], v[168:171]
  v_mfma_f32_16x16x32_bf16 v[176:179], a[252:255], v[140:143], v[176:179]
  ds_read_b128 a[252:255], v11 offset:20480
  s_waitcnt lgkmcnt(11)
  v_mfma_f32_16x16x32_bf16 v[148:151], a[240:243], v[64:67], v[216:219]
  v_mfma_f32_16x16x32_bf16 v[156:159], a[240:243], v[68:71], v[220:223]
  v_mfma_f32_16x16x32_bf16 v[164:167], a[240:243], v[72:75], v[224:227]
  v_mfma_f32_16x16x32_bf16 v[172:175], a[240:243], v[76:79], v[228:231]
  s_add_u32 m0, s43, 49152
  s_nop 0
  buffer_load_dwordx4 v34, s[16:19], s47 offen offset:0 nt lds
  v_mfma_f32_16x16x32_bf16 v[180:183], a[240:243], v[80:83], v[232:235]
  v_exp_f32 v144, v144
  s_waitcnt lgkmcnt(6)
  v_mfma_f32_16x16x32_bf16 v[148:151], a[244:247], v[84:87], v[148:151]
  v_mfma_f32_16x16x32_bf16 v[156:159], a[244:247], v[88:91], v[156:159]
  v_exp_f32 v145, v145
  v_mfma_f32_16x16x32_bf16 v[164:167], a[244:247], v[92:95], v[164:167]
  v_cvt_pk_bf16_f32 v144, v144, v145
  v_mfma_f32_16x16x32_bf16 v[172:175], a[244:247], v[96:99], v[172:175]
  v_exp_f32 v146, v146
  v_mfma_f32_16x16x32_bf16 v[180:183], a[244:247], v[100:103], v[180:183]
  s_waitcnt lgkmcnt(3)
  v_mfma_f32_16x16x32_bf16 v[148:151], a[248:251], v[104:107], v[148:151]
  v_exp_f32 v147, v147
  v_mfma_f32_16x16x32_bf16 v[156:159], a[248:251], v[108:111], v[156:159]
  buffer_load_dwordx4 v35, s[16:19], s47 offen offset:1024 nt lds
  v_cvt_pk_bf16_f32 v145, v146, v147
  v_mfma_f32_16x16x32_bf16 v[164:167], a[248:251], v[112:115], v[164:167]
  v_exp_f32 v152, v152
  v_mfma_f32_16x16x32_bf16 v[172:175], a[248:251], v[116:119], v[172:175]
  v_mfma_f32_16x16x32_bf16 v[180:183], a[248:251], v[120:123], v[180:183]
  v_exp_f32 v153, v153
  s_waitcnt lgkmcnt(0)
  v_mfma_f32_16x16x32_bf16 v[148:151], a[252:255], v[124:127], v[148:151]
  v_cvt_pk_bf16_f32 v152, v152, v153
  v_mfma_f32_16x16x32_bf16 v[156:159], a[252:255], v[128:131], v[156:159]
  v_exp_f32 v154, v154
  v_mfma_f32_16x16x32_bf16 v[164:167], a[252:255], v[132:135], v[164:167]
  ds_read_b128 a[240:243], v12 offset:16384
  v_mfma_f32_16x16x32_bf16 v[172:175], a[252:255], v[136:139], v[172:175]
  v_exp_f32 v155, v155
  v_mfma_f32_16x16x32_bf16 v[180:183], a[252:255], v[140:143], v[180:183]
  buffer_load_dwordx4 v36, s[16:19], s47 offen offset:2048 nt lds
  v_cvt_pk_bf16_f32 v153, v154, v155
  v_mfma_f32_16x16x32_bf16 v[236:239], v[56:59], v[184:187], v[236:239]
  v_exp_f32 v160, v160
  v_mfma_f32_16x16x32_bf16 v[240:243], v[56:59], v[192:195], v[240:243]
  ds_read_b128 a[244:247], v13 offset:16384
  v_mfma_f32_16x16x32_bf16 v[244:247], v[56:59], v[200:203], v[244:247]
  v_exp_f32 v161, v161
  v_mfma_f32_16x16x32_bf16 v[248:251], v[56:59], v[208:211], v[248:251]
  v_cvt_pk_bf16_f32 v160, v160, v161
  v_mfma_f32_16x16x32_bf16 a[0:3], v[40:43], v[184:187], a[0:3]
  v_exp_f32 v162, v162
  v_mfma_f32_16x16x32_bf16 a[32:35], v[40:43], v[192:195], a[32:35]
  ds_read_b128 a[248:251], v14 offset:16384
  v_mfma_f32_16x16x32_bf16 a[64:67], v[40:43], v[200:203], a[64:67]
  v_exp_f32 v163, v163
  v_mfma_f32_16x16x32_bf16 a[96:99], v[40:43], v[208:211], a[96:99]
  ds_read_b64_tr_b16 v[40:41], v28 offset:0
  v_cvt_pk_bf16_f32 v161, v162, v163
  v_mfma_f32_16x16x32_bf16 a[4:7], v[44:47], v[184:187], a[4:7]
  v_exp_f32 v168, v168
  v_mfma_f32_16x16x32_bf16 a[36:39], v[44:47], v[192:195], a[36:39]
  ds_read_b64_tr_b16 v[42:43], v28 offset:4096
  ds_read_b128 a[252:255], v15 offset:16384
  v_mfma_f32_16x16x32_bf16 a[68:71], v[44:47], v[200:203], a[68:71]
  v_exp_f32 v169, v169
  v_mfma_f32_16x16x32_bf16 a[100:103], v[44:47], v[208:211], a[100:103]
  ds_read_b64_tr_b16 v[44:45], v29 offset:0
  v_cvt_pk_bf16_f32 v168, v168, v169
  v_mfma_f32_16x16x32_bf16 a[8:11], v[48:51], v[184:187], a[8:11]
  v_exp_f32 v170, v170
  v_mfma_f32_16x16x32_bf16 a[40:43], v[48:51], v[192:195], a[40:43]
  ds_read_b64_tr_b16 v[46:47], v29 offset:4096
  buffer_load_dwordx4 v37, s[16:19], s47 offen offset:3072 nt lds
  s_add_u32 s47, s47, 16384
  v_mfma_f32_16x16x32_bf16 a[72:75], v[48:51], v[200:203], a[72:75]
  v_exp_f32 v171, v171
  v_mfma_f32_16x16x32_bf16 a[104:107], v[48:51], v[208:211], a[104:107]
  ds_read_b64_tr_b16 v[48:49], v30 offset:0
  v_cvt_pk_bf16_f32 v169, v170, v171
  v_mfma_f32_16x16x32_bf16 a[12:15], v[52:55], v[184:187], a[12:15]
  v_exp_f32 v176, v176
  v_mfma_f32_16x16x32_bf16 a[44:47], v[52:55], v[192:195], a[44:47]
  ds_read_b64_tr_b16 v[50:51], v30 offset:4096
  v_mfma_f32_16x16x32_bf16 a[76:79], v[52:55], v[200:203], a[76:79]
  v_exp_f32 v177, v177
  v_mfma_f32_16x16x32_bf16 a[108:111], v[52:55], v[208:211], a[108:111]
  ds_read_b64_tr_b16 v[52:53], v31 offset:0
  v_cvt_pk_bf16_f32 v176, v176, v177
  s_waitcnt lgkmcnt(6)
  v_mfma_f32_16x16x32_bf16 a[16:19], v[40:43], v[184:187], a[16:19]
  v_exp_f32 v178, v178
  v_mfma_f32_16x16x32_bf16 a[48:51], v[40:43], v[192:195], a[48:51]
  ds_read_b64_tr_b16 v[54:55], v31 offset:4096
  v_mfma_f32_16x16x32_bf16 a[80:83], v[40:43], v[200:203], a[80:83]
  v_exp_f32 v179, v179
  v_mfma_f32_16x16x32_bf16 a[112:115], v[40:43], v[208:211], a[112:115]
  v_cvt_pk_bf16_f32 v177, v178, v179
  s_waitcnt lgkmcnt(4)
  v_mfma_f32_16x16x32_bf16 a[20:23], v[44:47], v[184:187], a[20:23]
  v_exp_f32 v148, v148
  v_mfma_f32_16x16x32_bf16 a[52:55], v[44:47], v[192:195], a[52:55]
  v_mfma_f32_16x16x32_bf16 a[84:87], v[44:47], v[200:203], a[84:87]
  v_exp_f32 v149, v149
  v_mfma_f32_16x16x32_bf16 a[116:119], v[44:47], v[208:211], a[116:119]
  v_cvt_pk_bf16_f32 v146, v148, v149
  s_waitcnt lgkmcnt(2)
  v_mfma_f32_16x16x32_bf16 a[24:27], v[48:51], v[184:187], a[24:27]
  v_exp_f32 v150, v150
  v_mfma_f32_16x16x32_bf16 a[56:59], v[48:51], v[192:195], a[56:59]
  v_mfma_f32_16x16x32_bf16 a[88:91], v[48:51], v[200:203], a[88:91]
  v_exp_f32 v151, v151
  v_mfma_f32_16x16x32_bf16 a[120:123], v[48:51], v[208:211], a[120:123]
  v_cvt_pk_bf16_f32 v147, v150, v151
  s_waitcnt lgkmcnt(0)
  v_mfma_f32_16x16x32_bf16 a[28:31], v[52:55], v[184:187], a[28:31]
  v_exp_f32 v156, v156
  v_mfma_f32_16x16x32_bf16 a[60:63], v[52:55], v[192:195], a[60:63]
  ds_read_b64_tr_b16 v[40:41], v16 offset:16384
  ds_read_b64_tr_b16 v[42:43], v16 offset:20480
  v_mfma_f32_16x16x32_bf16 a[92:95], v[52:55], v[200:203], a[92:95]
  v_exp_f32 v157, v157
  v_mfma_f32_16x16x32_bf16 a[124:127], v[52:55], v[208:211], a[124:127]
  v_cvt_pk_bf16_f32 v154, v156, v157
  v_mfma_f32_16x16x32_bf16 v[184:187], a[240:243], v[64:67], v[216:219]
  v_exp_f32 v158, v158
  v_mfma_f32_16x16x32_bf16 v[192:195], a[240:243], v[68:71], v[220:223]
  v_mfma_f32_16x16x32_bf16 v[200:203], a[240:243], v[72:75], v[224:227]
  v_exp_f32 v159, v159
  v_mfma_f32_16x16x32_bf16 v[208:211], a[240:243], v[76:79], v[228:231]
  ds_read_b128 a[240:243], v12 offset:20480
  v_cvt_pk_bf16_f32 v155, v158, v159
  v_mfma_f32_16x16x32_bf16 v[184:187], a[244:247], v[84:87], v[184:187]
  v_exp_f32 v164, v164
  v_mfma_f32_16x16x32_bf16 v[192:195], a[244:247], v[88:91], v[192:195]
  ds_read_b64_tr_b16 v[44:45], v17 offset:16384
  ds_read_b64_tr_b16 v[46:47], v17 offset:20480
  v_mfma_f32_16x16x32_bf16 v[200:203], a[244:247], v[92:95], v[200:203]
  v_exp_f32 v165, v165
  v_mfma_f32_16x16x32_bf16 v[208:211], a[244:247], v[96:99], v[208:211]
  ds_read_b128 a[244:247], v13 offset:20480
  v_cvt_pk_bf16_f32 v162, v164, v165
  v_mfma_f32_16x16x32_bf16 v[184:187], a[248:251], v[104:107], v[184:187]
  v_exp_f32 v166, v166
  v_mfma_f32_16x16x32_bf16 v[192:195], a[248:251], v[108:111], v[192:195]
  ds_read_b64_tr_b16 v[48:49], v18 offset:16384
  ds_read_b64_tr_b16 v[50:51], v18 offset:20480
  v_mfma_f32_16x16x32_bf16 v[200:203], a[248:251], v[112:115], v[200:203]
  v_exp_f32 v167, v167
  v_mfma_f32_16x16x32_bf16 v[208:211], a[248:251], v[116:119], v[208:211]
  ds_read_b128 a[248:251], v14 offset:20480
  v_cvt_pk_bf16_f32 v163, v166, v167
  v_mfma_f32_16x16x32_bf16 v[184:187], a[252:255], v[124:127], v[184:187]
  v_exp_f32 v172, v172
  v_mfma_f32_16x16x32_bf16 v[192:195], a[252:255], v[128:131], v[192:195]
  ds_read_b64_tr_b16 v[52:53], v19 offset:16384
  ds_read_b64_tr_b16 v[54:55], v19 offset:20480
  v_mfma_f32_16x16x32_bf16 v[200:203], a[252:255], v[132:135], v[200:203]
  v_exp_f32 v173, v173
  v_mfma_f32_16x16x32_bf16 v[208:211], a[252:255], v[136:139], v[208:211]
  ds_read_b128 a[252:255], v15 offset:20480
  v_cvt_pk_bf16_f32 v170, v172, v173
  s_waitcnt lgkmcnt(9)
  v_mfma_f32_16x16x32_bf16 v[188:191], a[240:243], v[64:67], v[216:219]
  v_exp_f32 v174, v174
  v_mfma_f32_16x16x32_bf16 v[196:199], a[240:243], v[68:71], v[220:223]
  v_mfma_f32_16x16x32_bf16 v[204:207], a[240:243], v[72:75], v[224:227]
  v_exp_f32 v175, v175
  v_mfma_f32_16x16x32_bf16 v[212:215], a[240:243], v[76:79], v[228:231]
  v_cvt_pk_bf16_f32 v171, v174, v175
  s_waitcnt lgkmcnt(6)
  v_mfma_f32_16x16x32_bf16 v[188:191], a[244:247], v[84:87], v[188:191]
  v_exp_f32 v180, v180
  v_mfma_f32_16x16x32_bf16 v[196:199], a[244:247], v[88:91], v[196:199]
  v_mfma_f32_16x16x32_bf16 v[204:207], a[244:247], v[92:95], v[204:207]
  v_exp_f32 v181, v181
  v_mfma_f32_16x16x32_bf16 v[212:215], a[244:247], v[96:99], v[212:215]
  v_cvt_pk_bf16_f32 v178, v180, v181
  s_waitcnt lgkmcnt(3)
  v_mfma_f32_16x16x32_bf16 v[188:191], a[248:251], v[104:107], v[188:191]
  v_exp_f32 v182, v182
  v_mfma_f32_16x16x32_bf16 v[196:199], a[248:251], v[108:111], v[196:199]
  v_mfma_f32_16x16x32_bf16 v[204:207], a[248:251], v[112:115], v[204:207]
  v_exp_f32 v183, v183
  v_mfma_f32_16x16x32_bf16 v[212:215], a[248:251], v[116:119], v[212:215]
  v_cvt_pk_bf16_f32 v179, v182, v183
  s_waitcnt lgkmcnt(0)
  v_mfma_f32_16x16x32_bf16 v[188:191], a[252:255], v[124:127], v[188:191]
  v_exp_f32 v184, v184
  v_mfma_f32_16x16x32_bf16 v[196:199], a[252:255], v[128:131], v[196:199]
  v_mfma_f32_16x16x32_bf16 v[204:207], a[252:255], v[132:135], v[204:207]
  v_exp_f32 v185, v185
  v_mfma_f32_16x16x32_bf16 v[212:215], a[252:255], v[136:139], v[212:215]
  v_cvt_pk_bf16_f32 v184, v184, v185
  v_mfma_f32_16x16x32_bf16 v[236:239], v[56:59], v[144:147], v[236:239]
  v_exp_f32 v186, v186
  v_mfma_f32_16x16x32_bf16 v[240:243], v[56:59], v[152:155], v[240:243]
  v_mfma_f32_16x16x32_bf16 v[244:247], v[56:59], v[160:163], v[244:247]
  v_exp_f32 v187, v187
  v_mfma_f32_16x16x32_bf16 v[248:251], v[56:59], v[168:171], v[248:251]
  v_cvt_pk_bf16_f32 v185, v186, v187
  v_mfma_f32_16x16x32_bf16 v[252:255], v[56:59], v[176:179], v[252:255]
  v_exp_f32 v192, v192
  v_mfma_f32_16x16x32_bf16 a[0:3], v[40:43], v[144:147], a[0:3]
  v_mfma_f32_16x16x32_bf16 a[32:35], v[40:43], v[152:155], a[32:35]
  v_exp_f32 v193, v193
  v_mfma_f32_16x16x32_bf16 a[64:67], v[40:43], v[160:163], a[64:67]
  v_cvt_pk_bf16_f32 v192, v192, v193
  v_mfma_f32_16x16x32_bf16 a[96:99], v[40:43], v[168:171], a[96:99]
  v_exp_f32 v194, v194
  v_mfma_f32_16x16x32_bf16 a[128:131], v[40:43], v[176:179], a[128:131]
  ds_read_b64_tr_b16 v[40:41], v20 offset:16384
  ds_read_b64_tr_b16 v[42:43], v20 offset:20480
  v_mfma_f32_16x16x32_bf16 a[4:7], v[44:47], v[144:147], a[4:7]
  v_exp_f32 v195, v195
  v_mfma_f32_16x16x32_bf16 a[36:39], v[44:47], v[152:155], a[36:39]
  v_cvt_pk_bf16_f32 v193, v194, v195
  v_mfma_f32_16x16x32_bf16 a[68:71], v[44:47], v[160:163], a[68:71]
  v_exp_f32 v200, v200
  v_mfma_f32_16x16x32_bf16 a[100:103], v[44:47], v[168:171], a[100:103]
  v_mfma_f32_16x16x32_bf16 a[132:135], v[44:47], v[176:179], a[132:135]
  v_exp_f32 v201, v201
  v_mfma_f32_16x16x32_bf16 a[8:11], v[48:51], v[144:147], a[8:11]
  ds_read_b64_tr_b16 v[44:45], v21 offset:16384
  v_cvt_pk_bf16_f32 v200, v200, v201
  v_mfma_f32_16x16x32_bf16 a[40:43], v[48:51], v[152:155], a[40:43]
  v_exp_f32 v202, v202
  v_mfma_f32_16x16x32_bf16 a[72:75], v[48:51], v[160:163], a[72:75]
  ds_read_b64_tr_b16 v[46:47], v21 offset:20480
  v_mfma_f32_16x16x32_bf16 a[104:107], v[48:51], v[168:171], a[104:107]
  v_exp_f32 v203, v203
  v_mfma_f32_16x16x32_bf16 a[136:139], v[48:51], v[176:179], a[136:139]
  ds_read_b64_tr_b16 v[48:49], v22 offset:16384
  v_cvt_pk_bf16_f32 v201, v202, v203
  s_mov_b32 s44, 4
K1_L1:
  v_mfma_f32_16x16x32_bf16 a[12:15], v[52:55], v[144:147], a[12:15]
  s_waitcnt vmcnt(8)
  s_barrier
  v_exp_f32 v208, v208
  v_mfma_f32_16x16x32_bf16 a[44:47], v[52:55], v[152:155], a[44:47]
  ds_read_b64_tr_b16 v[50:51], v22 offset:20480
  ds_read_b128 a[240:243], v8 offset:32768
  v_mfma_f32_16x16x32_bf16 a[76:79], v[52:55], v[160:163], a[76:79]
  v_exp_f32 v209, v209
  v_mfma_f32_16x16x32_bf16 a[108:111], v[52:55], v[168:171], a[108:111]
  ds_read_b128 a[244:247], v9 offset:32768
  v_cvt_pk_bf16_f32 v208, v208, v209
  v_mfma_f32_16x16x32_bf16 a[140:143], v[52:55], v[176:179], a[140:143]
  v_exp_f32 v210, v210
  s_waitcnt lgkmcnt(6)
  v_mfma_f32_16x16x32_bf16 a[16:19], v[40:43], v[144:147], a[16:19]
  ds_read_b64_tr_b16 v[52:53], v23 offset:16384
  ds_read_b64_tr_b16 v[54:55], v23 offset:20480
  v_mfma_f32_16x16x32_bf16 a[48:51], v[40:43], v[152:155], a[48:51]
  v_exp_f32 v211, v211
  v_mfma_f32_16x16x32_bf16 a[80:83], v[40:43], v[160:163], a[80:83]
  ds_read_b128 a[248:251], v10 offset:32768
  v_cvt_pk_bf16_f32 v209, v210, v211
  v_mfma_f32_16x16x32_bf16 a[112:115], v[40:43], v[168:171], a[112:115]
  v_exp_f32 v188, v188
  v_mfma_f32_16x16x32_bf16 a[144:147], v[40:43], v[176:179], a[144:147]
  ds_read_b128 a[252:255], v11 offset:32768
  s_add_u32 m0, s43, 65536
  s_nop 0
  buffer_load_dwordx4 v38, s[20:23], s54 offen offset:0 nt lds
  s_waitcnt lgkmcnt(8)
  v_mfma_f32_16x16x32_bf16 a[20:23], v[44:47], v[144:147], a[20:23]
  v_exp_f32 v189, v189
  v_mfma_f32_16x16x32_bf16 a[52:55], v[44:47], v[152:155], a[52:55]
  v_cvt_pk_bf16_f32 v186, v188, v189
  v_mfma_f32_16x16x32_bf16 a[84:87], v[44:47], v[160:163], a[84:87]
  v_exp_f32 v190, v190
  v_mfma_f32_16x16x32_bf16 a[116:119], v[44:47], v[168:171], a[116:119]
  v_mfma_f32_16x16x32_bf16 a[148:151], v[44:47], v[176:179], a[148:151]
  v_exp_f32 v191, v191
  s_waitcnt lgkmcnt(6)
  v_mfma_f32_16x16x32_bf16 a[24:27], v[48:51], v[144:147], a[24:27]
  v_cvt_pk_bf16_f32 v187, v190, v191
  v_mfma_f32_16x16x32_bf16 a[56:59], v[48:51], v[152:155], a[56:59]
  v_exp_f32 v196, v196
  v_mfma_f32_16x16x32_bf16 a[88:91], v[48:51], v[160:163], a[88:91]
  buffer_load_dwordx4 v39, s[20:23], s54 offen offset:1024 nt lds
  v_mfma_f32_16x16x32_bf16 a[120:123], v[48:51], v[168:171], a[120:123]
  v_exp_f32 v197, v197
  v_mfma_f32_16x16x32_bf16 a[152:155], v[48:51], v[176:179], a[152:155]
  v_cvt_pk_bf16_f32 v194, v196, v197
  s_waitcnt lgkmcnt(2)
  v_mfma_f32_16x16x32_bf16 a[28:31], v[52:55], v[144:147], a[28:31]
  v_exp_f32 v198, v198
  v_mfma_f32_16x16x32_bf16 a[60:63], v[52:55], v[152:155], a[60:63]
  v_mfma_f32_16x16x32_bf16 a[92:95], v[52:55], v[160:163], a[92:95]
  v_exp_f32 v199, v199
  v_mfma_f32_16x16x32_bf16 a[124:127], v[52:55], v[168:171], a[124:127]
  v_cvt_pk_bf16_f32 v195, v198, v199
  v_mfma_f32_16x16x32_bf16 a[156:159], v[52:55], v[176:179], a[156:159]
  v_exp_f32 v204, v204
  v_mfma_f32_16x16x32_bf16 v[144:147], a[240:243], v[64:67], v[216:219]
  buffer_load_dwordx4 v38, s[20:23], s54 offen offset:2048 nt lds
  v_mfma_f32_16x16x32_bf16 v[152:155], a[240:243], v[68:71], v[220:223]
  v_exp_f32 v205, v205
  v_mfma_f32_16x16x32_bf16 v[160:163], a[240:243], v[72:75], v[224:227]
  v_cvt_pk_bf16_f32 v202, v204, v205
  v_mfma_f32_16x16x32_bf16 v[168:171], a[240:243], v[76:79], v[228:231]
  v_exp_f32 v206, v206
  v_mfma_f32_16x16x32_bf16 v[176:179], a[240:243], v[80:83], v[232:235]
  ds_read_b128 a[240:243], v8 offset:36864
  ds_read_b64_tr_b16 v[40:41], v24 offset:16384
  v_mfma_f32_16x16x32_bf16 v[144:147], a[244:247], v[84:87], v[144:147]
  v_exp_f32 v207, v207
  v_mfma_f32_16x16x32_bf16 v[152:155], a[244:247], v[88:91], v[152:155]
  ds_read_b64_tr_b16 v[42:43], v24 offset:20480
  v_cvt_pk_bf16_f32 v203, v206, v207
  v_mfma_f32_16x16x32_bf16 v[160:163], a[244:247], v[92:95], v[160:163]
  v_exp_f32 v212, v212
  v_mfma_f32_16x16x32_bf16 v[168:171], a[244:247], v[96:99], v[168:171]
  ds_read_b64_tr_b16 v[44:45], v25 offset:16384
  ds_read_b64_tr_b16 v[46:47], v25 offset:20480
  v_mfma_f32_16x16x32_bf16 v[176:179], a[244:247], v[100:103], v[176:179]
  v_exp_f32 v213, v213
  s_waitcnt lgkmcnt(6)
  v_mfma_f32_16x16x32_bf16 v[144:147], a[248:251], v[104:107], v[144:147]
  ds_read_b128 a[244:247], v9 offset:36864
  v_cvt_pk_bf16_f32 v210, v212, v213
  v_mfma_f32_16x16x32_bf16 v[152:155], a[248:251], v[108:111], v[152:155]
  v_exp_f32 v214, v214
  v_mfma_f32_16x16x32_bf16 v[160:163], a[248:251], v[112:115], v[160:163]
  ds_read_b64_tr_b16 v[48:49], v26 offset:16384
  ds_read_b64_tr_b16 v[50:51], v26 offset:20480
  v_mfma_f32_16x16x32_bf16 v[168:171], a[248:251], v[116:119], v[168:171]
  v_exp_f32 v215, v215
  v_mfma_f32_16x16x32_bf16 v[176:179], a[248:251], v[120:123], v[176:179]
  ds_read_b128 a[248:251], v10 offset:36864
  v_cvt_pk_bf16_f32 v211, v214, v215
  s_waitcnt lgkmcnt(9)
  v_mfma_f32_16x16x32_bf16 v[144:147], a[252:255], v[124:127], v[144:147]
  buffer_load_dwordx4 v39, s[20:23], s54 offen offset:3072 nt lds
  s_add_u32 s54, s54, 16384
  v_mfma_f32_16x16x32_bf16 v[152:155], a[252:255], v[128:131], v[152:155]
  ds_read_b64_tr_b16 v[52:53], v27 offset:16384
  ds_read_b64_tr_b16 v[54:55], v27 offset:20480
  v_mfma_f32_16x16x32_bf16 v[160:163], a[252:255], v[132:135], v[160:163]
  v_mfma_f32_16x16x32_bf16 v[168:171], a[252:255], v[136:139], v[168:171]
  v_mfma_f32_16x16x32_bf16 v[176:179], a[252:255], v[140:143], v[176:179]
  ds_read_b128 a[252:255], v11 offset:36864
  s_waitcnt lgkmcnt(11)
  v_mfma_f32_16x16x32_bf16 v[148:151], a[240:243], v[64:67], v[216:219]
  v_mfma_f32_16x16x32_bf16 v[156:159], a[240:243], v[68:71], v[220:223]
  v_mfma_f32_16x16x32_bf16 v[164:167], a[240:243], v[72:75], v[224:227]
  v_mfma_f32_16x16x32_bf16 v[172:175], a[240:243], v[76:79], v[228:231]
  s_add_u32 m0, s43, 0
  s_nop 0
  buffer_load_dwordx4 v34, s[16:19], s47 offen offset:0 nt lds
  v_mfma_f32_16x16x32_bf16 v[180:183], a[240:243], v[80:83], v[232:235]
  v_exp_f32 v144, v144
  s_waitcnt lgkmcnt(6)
  v_mfma_f32_16x16x32_bf16 v[148:151], a[244:247], v[84:87], v[148:151]
  v_mfma_f32_16x16x32_bf16 v[156:159], a[244:247], v[88:91], v[156:159]
  v_exp_f32 v145, v145
  v_mfma_f32_16x16x32_bf16 v[164:167], a[244:247], v[92:95], v[164:167]
  v_cvt_pk_bf16_f32 v144, v144, v145
  v_mfma_f32_16x16x32_bf16 v[172:175], a[244:247], v[96:99], v[172:175]
  v_exp_f32 v146, v146
  v_mfma_f32_16x16x32_bf16 v[180:183], a[244:247], v[100:103], v[180:183]
  s_waitcnt lgkmcnt(3)
  v_mfma_f32_16x16x32_bf16 v[148:151], a[248:251], v[104:107], v[148:151]
  v_exp_f32 v147, v147
  v_mfma_f32_16x16x32_bf16 v[156:159], a[248:251], v[108:111], v[156:159]
  buffer_load_dwordx4 v35, s[16:19], s47 offen offset:1024 nt lds
  v_cvt_pk_bf16_f32 v145, v146, v147
  v_mfma_f32_16x16x32_bf16 v[164:167], a[248:251], v[112:115], v[164:167]
  v_exp_f32 v152, v152
  v_mfma_f32_16x16x32_bf16 v[172:175], a[248:251], v[116:119], v[172:175]
  v_mfma_f32_16x16x32_bf16 v[180:183], a[248:251], v[120:123], v[180:183]
  v_exp_f32 v153, v153
  s_waitcnt lgkmcnt(0)
  v_mfma_f32_16x16x32_bf16 v[148:151], a[252:255], v[124:127], v[148:151]
  v_cvt_pk_bf16_f32 v152, v152, v153
  v_mfma_f32_16x16x32_bf16 v[156:159], a[252:255], v[128:131], v[156:159]
  v_exp_f32 v154, v154
  v_mfma_f32_16x16x32_bf16 v[164:167], a[252:255], v[132:135], v[164:167]
  ds_read_b128 a[240:243], v12 offset:32768
  v_mfma_f32_16x16x32_bf16 v[172:175], a[252:255], v[136:139], v[172:175]
  v_exp_f32 v155, v155
  v_mfma_f32_16x16x32_bf16 v[180:183], a[252:255], v[140:143], v[180:183]
  buffer_load_dwordx4 v36, s[16:19], s47 offen offset:2048 nt lds
  v_cvt_pk_bf16_f32 v153, v154, v155
  v_mfma_f32_16x16x32_bf16 v[236:239], v[56:59], v[184:187], v[236:239]
  v_exp_f32 v160, v160
  v_mfma_f32_16x16x32_bf16 v[240:243], v[56:59], v[192:195], v[240:243]
  ds_read_b128 a[244:247], v13 offset:32768
  v_mfma_f32_16x16x32_bf16 v[244:247], v[56:59], v[200:203], v[244:247]
  v_exp_f32 v161, v161
  v_mfma_f32_16x16x32_bf16 v[248:251], v[56:59], v[208:211], v[248:251]
  v_cvt_pk_bf16_f32 v160, v160, v161
  v_mfma_f32_16x16x32_bf16 a[0:3], v[40:43], v[184:187], a[0:3]
  v_exp_f32 v162, v162
  v_mfma_f32_16x16x32_bf16 a[32:35], v[40:43], v[192:195], a[32:35]
  ds_read_b128 a[248:251], v14 offset:32768
  v_mfma_f32_16x16x32_bf16 a[64:67], v[40:43], v[200:203], a[64:67]
  v_exp_f32 v163, v163
  v_mfma_f32_16x16x32_bf16 a[96:99], v[40:43], v[208:211], a[96:99]
  ds_read_b64_tr_b16 v[40:41], v28 offset:16384
  v_cvt_pk_bf16_f32 v161, v162, v163
  v_mfma_f32_16x16x32_bf16 a[4:7], v[44:47], v[184:187], a[4:7]
  v_exp_f32 v168, v168
  v_mfma_f32_16x16x32_bf16 a[36:39], v[44:47], v[192:195], a[36:39]
  ds_read_b64_tr_b16 v[42:43], v28 offset:20480
  ds_read_b128 a[252:255], v15 offset:32768
  v_mfma_f32_16x16x32_bf16 a[68:71], v[44:47], v[200:203], a[68:71]
  v_exp_f32 v169, v169
  v_mfma_f32_16x16x32_bf16 a[100:103], v[44:47], v[208:211], a[100:103]
  ds_read_b64_tr_b16 v[44:45], v29 offset:16384
  v_cvt_pk_bf16_f32 v168, v168, v169
  v_mfma_f32_16x16x32_bf16 a[8:11], v[48:51], v[184:187], a[8:11]
  v_exp_f32 v170, v170
  v_mfma_f32_16x16x32_bf16 a[40:43], v[48:51], v[192:195], a[40:43]
  ds_read_b64_tr_b16 v[46:47], v29 offset:20480
  buffer_load_dwordx4 v37, s[16:19], s47 offen offset:3072 nt lds
  s_add_u32 s47, s47, 16384
  v_mfma_f32_16x16x32_bf16 a[72:75], v[48:51], v[200:203], a[72:75]
  v_exp_f32 v171, v171
  v_mfma_f32_16x16x32_bf16 a[104:107], v[48:51], v[208:211], a[104:107]
  ds_read_b64_tr_b16 v[48:49], v30 offset:16384
  v_cvt_pk_bf16_f32 v169, v170, v171
  v_mfma_f32_16x16x32_bf16 a[12:15], v[52:55], v[184:187], a[12:15]
  v_exp_f32 v176, v176
  v_mfma_f32_16x16x32_bf16 a[44:47], v[52:55], v[192:195], a[44:47]
  ds_read_b64_tr_b16 v[50:51], v30 offset:20480
  v_mfma_f32_16x16x32_bf16 a[76:79], v[52:55], v[200:203], a[76:79]
  v_exp_f32 v177, v177
  v_mfma_f32_16x16x32_bf16 a[108:111], v[52:55], v[208:211], a[108:111]
  ds_read_b64_tr_b16 v[52:53], v31 offset:16384
  v_cvt_pk_bf16_f32 v176, v176, v177
  s_waitcnt lgkmcnt(6)
  v_mfma_f32_16x16x32_bf16 a[16:19], v[40:43], v[184:187], a[16:19]
  v_exp_f32 v178, v178
  v_mfma_f32_16x16x32_bf16 a[48:51], v[40:43], v[192:195], a[48:51]
  ds_read_b64_tr_b16 v[54:55], v31 offset:20480
  v_mfma_f32_16x16x32_bf16 a[80:83], v[40:43], v[200:203], a[80:83]
  v_exp_f32 v179, v179
  v_mfma_f32_16x16x32_bf16 a[112:115], v[40:43], v[208:211], a[112:115]
  v_cvt_pk_bf16_f32 v177, v178, v179
  s_waitcnt lgkmcnt(4)
  v_mfma_f32_16x16x32_bf16 a[20:23], v[44:47], v[184:187], a[20:23]
  v_exp_f32 v148, v148
  v_mfma_f32_16x16x32_bf16 a[52:55], v[44:47], v[192:195], a[52:55]
  v_mfma_f32_16x16x32_bf16 a[84:87], v[44:47], v[200:203], a[84:87]
  v_exp_f32 v149, v149
  v_mfma_f32_16x16x32_bf16 a[116:119], v[44:47], v[208:211], a[116:119]
  v_cvt_pk_bf16_f32 v146, v148, v149
  s_waitcnt lgkmcnt(2)
  v_mfma_f32_16x16x32_bf16 a[24:27], v[48:51], v[184:187], a[24:27]
  v_exp_f32 v150, v150
  v_mfma_f32_16x16x32_bf16 a[56:59], v[48:51], v[192:195], a[56:59]
  v_mfma_f32_16x16x32_bf16 a[88:91], v[48:51], v[200:203], a[88:91]
  v_exp_f32 v151, v151
  v_mfma_f32_16x16x32_bf16 a[120:123], v[48:51], v[208:211], a[120:123]
  v_cvt_pk_bf16_f32 v147, v150, v151
  s_waitcnt lgkmcnt(0)
  v_mfma_f32_16x16x32_bf16 a[28:31], v[52:55], v[184:187], a[28:31]
  v_exp_f32 v156, v156
  v_mfma_f32_16x16x32_bf16 a[60:63], v[52:55], v[192:195], a[60:63]
  ds_read_b64_tr_b16 v[40:41], v16 offset:32768
  ds_read_b64_tr_b16 v[42:43], v16 offset:36864
  v_mfma_f32_16x16x32_bf16 a[92:95], v[52:55], v[200:203], a[92:95]
  v_exp_f32 v157, v157
  v_mfma_f32_16x16x32_bf16 a[124:127], v[52:55], v[208:211], a[124:127]
  v_cvt_pk_bf16_f32 v154, v156, v157
  v_mfma_f32_16x16x32_bf16 v[184:187], a[240:243], v[64:67], v[216:219]
  v_exp_f32 v158, v158
  v_mfma_f32_16x16x32_bf16 v[192:195], a[240:243], v[68:71], v[220:223]
  v_mfma_f32_16x16x32_bf16 v[200:203], a[240:243], v[72:75], v[224:227]
  v_exp_f32 v159, v159
  v_mfma_f32_16x16x32_bf16 v[208:211], a[240:243], v[76:79], v[228:231]
  ds_read_b128 a[240:243], v12 offset:36864
  v_cvt_pk_bf16_f32 v155, v158, v159
  v_mfma_f32_16x16x32_bf16 v[184:187], a[244:247], v[84:87], v[184:187]
  v_exp_f32 v164, v164
  v_mfma_f32_16x16x32_bf16 v[192:195], a[244:247], v[88:91], v[192:195]
  ds_read_b64_tr_b16 v[44:45], v17 offset:32768
  ds_read_b64_tr_b16 v[46:47], v17 offset:36864
  v_mfma_f32_16x16x32_bf16 v[200:203], a[244:247], v[92:95], v[200:203]
  v_exp_f32 v165, v165
  v_mfma_f32_16x16x32_bf16 v[208:211], a[244:247], v[96:99], v[208:211]
  ds_read_b128 a[244:247], v13 offset:36864
  v_cvt_pk_bf16_f32 v162, v164, v165
  v_mfma_f32_16x16x32_bf16 v[184:187], a[248:251], v[104:107], v[184:187]
  v_exp_f32 v166, v166
  v_mfma_f32_16x16x32_bf16 v[192:195], a[248:251], v[108:111], v[192:195]
  ds_read_b64_tr_b16 v[48:49], v18 offset:32768
  ds_read_b64_tr_b16 v[50:51], v18 offset:36864
  v_mfma_f32_16x16x32_bf16 v[200:203], a[248:251], v[112:115], v[200:203]
  v_exp_f32 v167, v167
  v_mfma_f32_16x16x32_bf16 v[208:211], a[248:251], v[116:119], v[208:211]
  ds_read_b128 a[248:251], v14 offset:36864
  v_cvt_pk_bf16_f32 v163, v166, v167
  v_mfma_f32_16x16x32_bf16 v[184:187], a[252:255], v[124:127], v[184:187]
  v_exp_f32 v172, v172
  v_mfma_f32_16x16x32_bf16 v[192:195], a[252:255], v[128:131], v[192:195]
  ds_read_b64_tr_b16 v[52:53], v19 offset:32768
  ds_read_b64_tr_b16 v[54:55], v19 offset:36864
  v_mfma_f32_16x16x32_bf16 v[200:203], a[252:255], v[132:135], v[200:203]
  v_exp_f32 v173, v173
  v_mfma_f32_16x16x32_bf16 v[208:211], a[252:255], v[136:139], v[208:211]
  ds_read_b128 a[252:255], v15 offset:36864
  v_cvt_pk_bf16_f32 v170, v172, v173
  s_waitcnt lgkmcnt(9)
  v_mfma_f32_16x16x32_bf16 v[188:191], a[240:243], v[64:67], v[216:219]
  v_exp_f32 v174, v174
  v_mfma_f32_16x16x32_bf16 v[196:199], a[240:243], v[68:71], v[220:223]
  v_mfma_f32_16x16x32_bf16 v[204:207], a[240:243], v[72:75], v[224:227]
  v_exp_f32 v175, v175
  v_mfma_f32_16x16x32_bf16 v[212:215], a[240:243], v[76:79], v[228:231]
  v_cvt_pk_bf16_f32 v171, v174, v175
  s_waitcnt lgkmcnt(6)
  v_mfma_f32_16x16x32_bf16 v[188:191], a[244:247], v[84:87], v[188:191]
  v_exp_f32 v180, v180
  v_mfma_f32_16x16x32_bf16 v[196:199], a[244:247], v[88:91], v[196:199]
  v_mfma_f32_16x16x32_bf16 v[204:207], a[244:247], v[92:95], v[204:207]
  v_exp_f32 v181, v181
  v_mfma_f32_16x16x32_bf16 v[212:215], a[244:247], v[96:99], v[212:215]
  v_cvt_pk_bf16_f32 v178, v180, v181
  s_waitcnt lgkmcnt(3)
  v_mfma_f32_16x16x32_bf16 v[188:191], a[248:251], v[104:107], v[188:191]
  v_exp_f32 v182, v182
  v_mfma_f32_16x16x32_bf16 v[196:199], a[248:251], v[108:111], v[196:199]
  v_mfma_f32_16x16x32_bf16 v[204:207], a[248:251], v[112:115], v[204:207]
  v_exp_f32 v183, v183
  v_mfma_f32_16x16x32_bf16 v[212:215], a[248:251], v[116:119], v[212:215]
  v_cvt_pk_bf16_f32 v179, v182, v183
  s_waitcnt lgkmcnt(0)
  v_mfma_f32_16x16x32_bf16 v[188:191], a[252:255], v[124:127], v[188:191]
  v_exp_f32 v184, v184
  v_mfma_f32_16x16x32_bf16 v[196:199], a[252:255], v[128:131], v[196:199]
  v_mfma_f32_16x16x32_bf16 v[204:207], a[252:255], v[132:135], v[204:207]
  v_exp_f32 v185, v185
  v_mfma_f32_16x16x32_bf16 v[212:215], a[252:255], v[136:139], v[212:215]
  v_cvt_pk_bf16_f32 v184, v184, v185
  v_mfma_f32_16x16x32_bf16 v[236:239], v[56:59], v[144:147], v[236:239]
  v_exp_f32 v186, v186
  v_mfma_f32_16x16x32_bf16 v[240:243], v[56:59], v[152:155], v[240:243]
  v_mfma_f32_16x16x32_bf16 v[244:247], v[56:59], v[160:163], v[244:247]
  v_exp_f32 v187, v187
  v_mfma_f32_16x16x32_bf16 v[248:251], v[56:59], v[168:171], v[248:251]
  v_cvt_pk_bf16_f32 v185, v186, v187
  v_mfma_f32_16x16x32_bf16 v[252:255], v[56:59], v[176:179], v[252:255]
  v_exp_f32 v192, v192
  v_mfma_f32_16x16x32_bf16 a[0:3], v[40:43], v[144:147], a[0:3]
  v_mfma_f32_16x16x32_bf16 a[32:35], v[40:43], v[152:155], a[32:35]
  v_exp_f32 v193, v193
  v_mfma_f32_16x16x32_bf16 a[64:67], v[40:43], v[160:163], a[64:67]
  v_cvt_pk_bf16_f32 v192, v192, v193
  v_mfma_f32_16x16x32_bf16 a[96:99], v[40:43], v[168:171], a[96:99]
  v_exp_f32 v194, v194
  v_mfma_f32_16x16x32_bf16 a[128:131], v[40:43], v[176:179], a[128:131]
  ds_read_b64_tr_b16 v[40:41], v20 offset:32768
  ds_read_b64_tr_b16 v[42:43], v20 offset:36864
  v_mfma_f32_16x16x32_bf16 a[4:7], v[44:47], v[144:147], a[4:7]
  v_exp_f32 v195, v195
  v_mfma_f32_16x16x32_bf16 a[36:39], v[44:47], v[152:155], a[36:39]
  v_cvt_pk_bf16_f32 v193, v194, v195
  v_mfma_f32_16x16x32_bf16 a[68:71], v[44:47], v[160:163], a[68:71]
  v_exp_f32 v200, v200
  v_mfma_f32_16x16x32_bf16 a[100:103], v[44:47], v[168:171], a[100:103]
  v_mfma_f32_16x16x32_bf16 a[132:135], v[44:47], v[176:179], a[132:135]
  v_exp_f32 v201, v201
  v_mfma_f32_16x16x32_bf16 a[8:11], v[48:51], v[144:147], a[8:11]
  ds_read_b64_tr_b16 v[44:45], v21 offset:32768
  v_cvt_pk_bf16_f32 v200, v200, v201
  v_mfma_f32_16x16x32_bf16 a[40:43], v[48:51], v[152:155], a[40:43]
  v_exp_f32 v202, v202
  v_mfma_f32_16x16x32_bf16 a[72:75], v[48:51], v[160:163], a[72:75]
  ds_read_b64_tr_b16 v[46:47], v21 offset:36864
  v_mfma_f32_16x16x32_bf16 a[104:107], v[48:51], v[168:171], a[104:107]
  v_exp_f32 v203, v203
  v_mfma_f32_16x16x32_bf16 a[136:139], v[48:51], v[176:179], a[136:139]
  ds_read_b64_tr_b16 v[48:49], v22 offset:32768
  v_cvt_pk_bf16_f32 v201, v202, v203
  v_mfma_f32_16x16x32_bf16 a[12:15], v[52:55], v[144:147], a[12:15]
  s_waitcnt vmcnt(8)
  s_barrier
  v_exp_f32 v208, v208
  v_mfma_f32_16x16x32_bf16 a[44:47], v[52:55], v[152:155], a[44:47]
  ds_read_b64_tr_b16 v[50:51], v22 offset:36864
  ds_read_b128 a[240:243], v8 offset:49152
  v_mfma_f32_16x16x32_bf16 a[76:79], v[52:55], v[160:163], a[76:79]
  v_exp_f32 v209, v209
  v_mfma_f32_16x16x32_bf16 a[108:111], v[52:55], v[168:171], a[108:111]
  ds_read_b128 a[244:247], v9 offset:49152
  v_cvt_pk_bf16_f32 v208, v208, v209
  v_mfma_f32_16x16x32_bf16 a[140:143], v[52:55], v[176:179], a[140:143]
  v_exp_f32 v210, v210
  s_waitcnt lgkmcnt(6)
  v_mfma_f32_16x16x32_bf16 a[16:19], v[40:43], v[144:147], a[16:19]
  ds_read_b64_tr_b16 v[52:53], v23 offset:32768
  ds_read_b64_tr_b16 v[54:55], v23 offset:36864
  v_mfma_f32_16x16x32_bf16 a[48:51], v[40:43], v[152:155], a[48:51]
  v_exp_f32 v211, v211
  v_mfma_f32_16x16x32_bf16 a[80:83], v[40:43], v[160:163], a[80:83]
  ds_read_b128 a[248:251], v10 offset:49152
  v_cvt_pk_bf16_f32 v209, v210, v211
  v_mfma_f32_16x16x32_bf16 a[112:115], v[40:43], v[168:171], a[112:115]
  v_exp_f32 v188, v188
  v_mfma_f32_16x16x32_bf16 a[144:147], v[40:43], v[176:179], a[144:147]
  ds_read_b128 a[252:255], v11 offset:49152
  s_add_u32 m0, s43, 81920
  s_nop 0
  buffer_load_dwordx4 v38, s[20:23], s54 offen offset:0 nt lds
  s_waitcnt lgkmcnt(8)
  v_mfma_f32_16x16x32_bf16 a[20:23], v[44:47], v[144:147], a[20:23]
  v_exp_f32 v189, v189
  v_mfma_f32_16x16x32_bf16 a[52:55], v[44:47], v[152:155], a[52:55]
  v_cvt_pk_bf16_f32 v186, v188, v189
  v_mfma_f32_16x16x32_bf16 a[84:87], v[44:47], v[160:163], a[84:87]
  v_exp_f32 v190, v190
  v_mfma_f32_16x16x32_bf16 a[116:119], v[44:47], v[168:171], a[116:119]
  v_mfma_f32_16x16x32_bf16 a[148:151], v[44:47], v[176:179], a[148:151]
  v_exp_f32 v191, v191
  s_waitcnt lgkmcnt(6)
  v_mfma_f32_16x16x32_bf16 a[24:27], v[48:51], v[144:147], a[24:27]
  v_cvt_pk_bf16_f32 v187, v190, v191
  v_mfma_f32_16x16x32_bf16 a[56:59], v[48:51], v[152:155], a[56:59]
  v_exp_f32 v196, v196
  v_mfma_f32_16x16x32_bf16 a[88:91], v[48:51], v[160:163], a[88:91]
  buffer_load_dwordx4 v39, s[20:23], s54 offen offset:1024 nt lds
  v_mfma_f32_16x16x32_bf16 a[120:123], v[48:51], v[168:171], a[120:123]
  v_exp_f32 v197, v197
  v_mfma_f32_16x16x32_bf16 a[152:155], v[48:51], v[176:179], a[152:155]
  v_cvt_pk_bf16_f32 v194, v196, v197
  s_waitcnt lgkmcnt(2)
  v_mfma_f32_16x16x32_bf16 a[28:31], v[52:55], v[144:147], a[28:31]
  v_exp_f32 v198, v198
  v_mfma_f32_16x16x32_bf16 a[60:63], v[52:55], v[152:155], a[60:63]
  v_mfma_f32_16x16x32_bf16 a[92:95], v[52:55], v[160:163], a[92:95]
  v_exp_f32 v199, v199
  v_mfma_f32_16x16x32_bf16 a[124:127], v[52:55], v[168:171], a[124:127]
  v_cvt_pk_bf16_f32 v195, v198, v199
  v_mfma_f32_16x16x32_bf16 a[156:159], v[52:55], v[176:179], a[156:159]
  v_exp_f32 v204, v204
  v_mfma_f32_16x16x32_bf16 v[144:147], a[240:243], v[64:67], v[216:219]
  buffer_load_dwordx4 v38, s[20:23], s54 offen offset:2048 nt lds
  v_mfma_f32_16x16x32_bf16 v[152:155], a[240:243], v[68:71], v[220:223]
  v_exp_f32 v205, v205
  v_mfma_f32_16x16x32_bf16 v[160:163], a[240:243], v[72:75], v[224:227]
  v_cvt_pk_bf16_f32 v202, v204, v205
  v_mfma_f32_16x16x32_bf16 v[168:171], a[240:243], v[76:79], v[228:231]
  v_exp_f32 v206, v206
  v_mfma_f32_16x16x32_bf16 v[176:179], a[240:243], v[80:83], v[232:235]
  ds_read_b128 a[240:243], v8 offset:53248
  ds_read_b64_tr_b16 v[40:41], v24 offset:32768
  v_mfma_f32_16x16x32_bf16 v[144:147], a[244:247], v[84:87], v[144:147]
  v_exp_f32 v207, v207
  v_mfma_f32_16x16x32_bf16 v[152:155], a[244:247], v[88:91], v[152:155]
  ds_read_b64_tr_b16 v[42:43], v24 offset:36864
  v_cvt_pk_bf16_f32 v203, v206, v207
  v_mfma_f32_16x16x32_bf16 v[160:163], a[244:247], v[92:95], v[160:163]
  v_exp_f32 v212, v212
  v_mfma_f32_16x16x32_bf16 v[168:171], a[244:247], v[96:99], v[168:171]
  ds_read_b64_tr_b16 v[44:45], v25 offset:32768
  ds_read_b64_tr_b16 v[46:47], v25 offset:36864
  v_mfma_f32_16x16x32_bf16 v[176:179], a[244:247], v[100:103], v[176:179]
  v_exp_f32 v213, v213
  s_waitcnt lgkmcnt(6)
  v_mfma_f32_16x16x32_bf16 v[144:147], a[248:251], v[104:107], v[144:147]
  ds_read_b128 a[244:247], v9 offset:53248
  v_cvt_pk_bf16_f32 v210, v212, v213
  v_mfma_f32_16x16x32_bf16 v[152:155], a[248:251], v[108:111], v[152:155]
  v_exp_f32 v214, v214
  v_mfma_f32_16x16x32_bf16 v[160:163], a[248:251], v[112:115], v[160:163]
  ds_read_b64_tr_b16 v[48:49], v26 offset:32768
  ds_read_b64_tr_b16 v[50:51], v26 offset:36864
  v_mfma_f32_16x16x32_bf16 v[168:171], a[248:251], v[116:119], v[168:171]
  v_exp_f32 v215, v215
  v_mfma_f32_16x16x32_bf16 v[176:179], a[248:251], v[120:123], v[176:179]
  ds_read_b128 a[248:251], v10 offset:53248
  v_cvt_pk_bf16_f32 v211, v214, v215
  s_waitcnt lgkmcnt(9)
  v_mfma_f32_16x16x32_bf16 v[144:147], a[252:255], v[124:127], v[144:147]
  buffer_load_dwordx4 v39, s[20:23], s54 offen offset:3072 nt lds
  s_add_u32 s54, s54, 16384
  v_mfma_f32_16x16x32_bf16 v[152:155], a[252:255], v[128:131], v[152:155]
  ds_read_b64_tr_b16 v[52:53], v27 offset:32768
  ds_read_b64_tr_b16 v[54:55], v27 offset:36864
  v_mfma_f32_16x16x32_bf16 v[160:163], a[252:255], v[132:135], v[160:163]
  v_mfma_f32_16x16x32_bf16 v[168:171], a[252:255], v[136:139], v[168:171]
  v_mfma_f32_16x16x32_bf16 v[176:179], a[252:255], v[140:143], v[176:179]
  ds_read_b128 a[252:255], v11 offset:53248
  s_waitcnt lgkmcnt(11)
  v_mfma_f32_16x16x32_bf16 v[148:151], a[240:243], v[64:67], v[216:219]
  v_mfma_f32_16x16x32_bf16 v[156:159], a[240:243], v[68:71], v[220:223]
  v_mfma_f32_16x16x32_bf16 v[164:167], a[240:243], v[72:75], v[224:227]
  v_mfma_f32_16x16x32_bf16 v[172:175], a[240:243], v[76:79], v[228:231]
  s_add_u32 m0, s43, 16384
  s_nop 0
  buffer_load_dwordx4 v34, s[16:19], s47 offen offset:0 nt lds
  v_mfma_f32_16x16x32_bf16 v[180:183], a[240:243], v[80:83], v[232:235]
  v_exp_f32 v144, v144
  s_waitcnt lgkmcnt(6)
  v_mfma_f32_16x16x32_bf16 v[148:151], a[244:247], v[84:87], v[148:151]
  v_mfma_f32_16x16x32_bf16 v[156:159], a[244:247], v[88:91], v[156:159]
  v_exp_f32 v145, v145
  v_mfma_f32_16x16x32_bf16 v[164:167], a[244:247], v[92:95], v[164:167]
  v_cvt_pk_bf16_f32 v144, v144, v145
  v_mfma_f32_16x16x32_bf16 v[172:175], a[244:247], v[96:99], v[172:175]
  v_exp_f32 v146, v146
  v_mfma_f32_16x16x32_bf16 v[180:183], a[244:247], v[100:103], v[180:183]
  s_waitcnt lgkmcnt(3)
  v_mfma_f32_16x16x32_bf16 v[148:151], a[248:251], v[104:107], v[148:151]
  v_exp_f32 v147, v147
  v_mfma_f32_16x16x32_bf16 v[156:159], a[248:251], v[108:111], v[156:159]
  buffer_load_dwordx4 v35, s[16:19], s47 offen offset:1024 nt lds
  v_cvt_pk_bf16_f32 v145, v146, v147
  v_mfma_f32_16x16x32_bf16 v[164:167], a[248:251], v[112:115], v[164:167]
  v_exp_f32 v152, v152
  v_mfma_f32_16x16x32_bf16 v[172:175], a[248:251], v[116:119], v[172:175]
  v_mfma_f32_16x16x32_bf16 v[180:183], a[248:251], v[120:123], v[180:183]
  v_exp_f32 v153, v153
  s_waitcnt lgkmcnt(0)
  v_mfma_f32_16x16x32_bf16 v[148:151], a[252:255], v[124:127], v[148:151]
  v_cvt_pk_bf16_f32 v152, v152, v153
  v_mfma_f32_16x16x32_bf16 v[156:159], a[252:255], v[128:131], v[156:159]
  v_exp_f32 v154, v154
  v_mfma_f32_16x16x32_bf16 v[164:167], a[252:255], v[132:135], v[164:167]
  ds_read_b128 a[240:243], v12 offset:49152
  v_mfma_f32_16x16x32_bf16 v[172:175], a[252:255], v[136:139], v[172:175]
  v_exp_f32 v155, v155
  v_mfma_f32_16x16x32_bf16 v[180:183], a[252:255], v[140:143], v[180:183]
  buffer_load_dwordx4 v36, s[16:19], s47 offen offset:2048 nt lds
  v_cvt_pk_bf16_f32 v153, v154, v155
  v_mfma_f32_16x16x32_bf16 v[236:239], v[56:59], v[184:187], v[236:239]
  v_exp_f32 v160, v160
  v_mfma_f32_16x16x32_bf16 v[240:243], v[56:59], v[192:195], v[240:243]
  ds_read_b128 a[244:247], v13 offset:49152
  v_mfma_f32_16x16x32_bf16 v[244:247], v[56:59], v[200:203], v[244:247]
  v_exp_f32 v161, v161
  v_mfma_f32_16x16x32_bf16 v[248:251], v[56:59], v[208:211], v[248:251]
  v_cvt_pk_bf16_f32 v160, v160, v161
  v_mfma_f32_16x16x32_bf16 a[0:3], v[40:43], v[184:187], a[0:3]
  v_exp_f32 v162, v162
  v_mfma_f32_16x16x32_bf16 a[32:35], v[40:43], v[192:195], a[32:35]
  ds_read_b128 a[248:251], v14 offset:49152
  v_mfma_f32_16x16x32_bf16 a[64:67], v[40:43], v[200:203], a[64:67]
  v_exp_f32 v163, v163
  v_mfma_f32_16x16x32_bf16 a[96:99], v[40:43], v[208:211], a[96:99]
  ds_read_b64_tr_b16 v[40:41], v28 offset:32768
  v_cvt_pk_bf16_f32 v161, v162, v163
  v_mfma_f32_16x16x32_bf16 a[4:7], v[44:47], v[184:187], a[4:7]
  v_exp_f32 v168, v168
  v_mfma_f32_16x16x32_bf16 a[36:39], v[44:47], v[192:195], a[36:39]
  ds_read_b64_tr_b16 v[42:43], v28 offset:36864
  ds_read_b128 a[252:255], v15 offset:49152
  v_mfma_f32_16x16x32_bf16 a[68:71], v[44:47], v[200:203], a[68:71]
  v_exp_f32 v169, v169
  v_mfma_f32_16x16x32_bf16 a[100:103], v[44:47], v[208:211], a[100:103]
  ds_read_b64_tr_b16 v[44:45], v29 offset:32768
  v_cvt_pk_bf16_f32 v168, v168, v169
  v_mfma_f32_16x16x32_bf16 a[8:11], v[48:51], v[184:187], a[8:11]
  v_exp_f32 v170, v170
  v_mfma_f32_16x16x32_bf16 a[40:43], v[48:51], v[192:195], a[40:43]
  ds_read_b64_tr_b16 v[46:47], v29 offset:36864
  buffer_load_dwordx4 v37, s[16:19], s47 offen offset:3072 nt lds
  s_add_u32 s47, s47, 16384
  v_mfma_f32_16x16x32_bf16 a[72:75], v[48:51], v[200:203], a[72:75]
  v_exp_f32 v171, v171
  v_mfma_f32_16x16x32_bf16 a[104:107], v[48:51], v[208:211], a[104:107]
  ds_read_b64_tr_b16 v[48:49], v30 offset:32768
  v_cvt_pk_bf16_f32 v169, v170, v171
  v_mfma_f32_16x16x32_bf16 a[12:15], v[52:55], v[184:187], a[12:15]
  v_exp_f32 v176, v176
  v_mfma_f32_16x16x32_bf16 a[44:47], v[52:55], v[192:195], a[44:47]
  ds_read_b64_tr_b16 v[50:51], v30 offset:36864
  v_mfma_f32_16x16x32_bf16 a[76:79], v[52:55], v[200:203], a[76:79]
  v_exp_f32 v177, v177
  v_mfma_f32_16x16x32_bf16 a[108:111], v[52:55], v[208:211], a[108:111]
  ds_read_b64_tr_b16 v[52:53], v31 offset:32768
  v_cvt_pk_bf16_f32 v176, v176, v177
  s_waitcnt lgkmcnt(6)
  v_mfma_f32_16x16x32_bf16 a[16:19], v[40:43], v[184:187], a[16:19]
  v_exp_f32 v178, v178
  v_mfma_f32_16x16x32_bf16 a[48:51], v[40:43], v[192:195], a[48:51]
  ds_read_b64_tr_b16 v[54:55], v31 offset:36864
  v_mfma_f32_16x16x32_bf16 a[80:83], v[40:43], v[200:203], a[80:83]
  v_exp_f32 v179, v179
  v_mfma_f32_16x16x32_bf16 a[112:115], v[40:43], v[208:211], a[112:115]
  v_cvt_pk_bf16_f32 v177, v178, v179
  s_waitcnt lgkmcnt(4)
  v_mfma_f32_16x16x32_bf16 a[20:23], v[44:47], v[184:187], a[20:23]
  v_exp_f32 v148, v148
  v_mfma_f32_16x16x32_bf16 a[52:55], v[44:47], v[192:195], a[52:55]
  v_mfma_f32_16x16x32_bf16 a[84:87], v[44:47], v[200:203], a[84:87]
  v_exp_f32 v149, v149
  v_mfma_f32_16x16x32_bf16 a[116:119], v[44:47], v[208:211], a[116:119]
  v_cvt_pk_bf16_f32 v146, v148, v149
  s_waitcnt lgkmcnt(2)
  v_mfma_f32_16x16x32_bf16 a[24:27], v[48:51], v[184:187], a[24:27]
  v_exp_f32 v150, v150
  v_mfma_f32_16x16x32_bf16 a[56:59], v[48:51], v[192:195], a[56:59]
  v_mfma_f32_16x16x32_bf16 a[88:91], v[48:51], v[200:203], a[88:91]
  v_exp_f32 v151, v151
  v_mfma_f32_16x16x32_bf16 a[120:123], v[48:51], v[208:211], a[120:123]
  v_cvt_pk_bf16_f32 v147, v150, v151
  s_waitcnt lgkmcnt(0)
  v_mfma_f32_16x16x32_bf16 a[28:31], v[52:55], v[184:187], a[28:31]
  v_exp_f32 v156, v156
  v_mfma_f32_16x16x32_bf16 a[60:63], v[52:55], v[192:195], a[60:63]
  ds_read_b64_tr_b16 v[40:41], v16 offset:49152
  ds_read_b64_tr_b16 v[42:43], v16 offset:53248
  v_mfma_f32_16x16x32_bf16 a[92:95], v[52:55], v[200:203], a[92:95]
  v_exp_f32 v157, v157
  v_mfma_f32_16x16x32_bf16 a[124:127], v[52:55], v[208:211], a[124:127]
  v_cvt_pk_bf16_f32 v154, v156, v157
  v_mfma_f32_16x16x32_bf16 v[184:187], a[240:243], v[64:67], v[216:219]
  v_exp_f32 v158, v158
  v_mfma_f32_16x16x32_bf16 v[192:195], a[240:243], v[68:71], v[220:223]
  v_mfma_f32_16x16x32_bf16 v[200:203], a[240:243], v[72:75], v[224:227]
  v_exp_f32 v159, v159
  v_mfma_f32_16x16x32_bf16 v[208:211], a[240:243], v[76:79], v[228:231]
  ds_read_b128 a[240:243], v12 offset:53248
  v_cvt_pk_bf16_f32 v155, v158, v159
  v_mfma_f32_16x16x32_bf16 v[184:187], a[244:247], v[84:87], v[184:187]
  v_exp_f32 v164, v164
  v_mfma_f32_16x16x32_bf16 v[192:195], a[244:247], v[88:91], v[192:195]
  ds_read_b64_tr_b16 v[44:45], v17 offset:49152
  ds_read_b64_tr_b16 v[46:47], v17 offset:53248
  v_mfma_f32_16x16x32_bf16 v[200:203], a[244:247], v[92:95], v[200:203]
  v_exp_f32 v165, v165
  v_mfma_f32_16x16x32_bf16 v[208:211], a[244:247], v[96:99], v[208:211]
  ds_read_b128 a[244:247], v13 offset:53248
  v_cvt_pk_bf16_f32 v162, v164, v165
  v_mfma_f32_16x16x32_bf16 v[184:187], a[248:251], v[104:107], v[184:187]
  v_exp_f32 v166, v166
  v_mfma_f32_16x16x32_bf16 v[192:195], a[248:251], v[108:111], v[192:195]
  ds_read_b64_tr_b16 v[48:49], v18 offset:49152
  ds_read_b64_tr_b16 v[50:51], v18 offset:53248
  v_mfma_f32_16x16x32_bf16 v[200:203], a[248:251], v[112:115], v[200:203]
  v_exp_f32 v167, v167
  v_mfma_f32_16x16x32_bf16 v[208:211], a[248:251], v[116:119], v[208:211]
  ds_read_b128 a[248:251], v14 offset:53248
  v_cvt_pk_bf16_f32 v163, v166, v167
  v_mfma_f32_16x16x32_bf16 v[184:187], a[252:255], v[124:127], v[184:187]
  v_exp_f32 v172, v172
  v_mfma_f32_16x16x32_bf16 v[192:195], a[252:255], v[128:131], v[192:195]
  ds_read_b64_tr_b16 v[52:53], v19 offset:49152
  ds_read_b64_tr_b16 v[54:55], v19 offset:53248
  v_mfma_f32_16x16x32_bf16 v[200:203], a[252:255], v[132:135], v[200:203]
  v_exp_f32 v173, v173
  v_mfma_f32_16x16x32_bf16 v[208:211], a[252:255], v[136:139], v[208:211]
  ds_read_b128 a[252:255], v15 offset:53248
  v_cvt_pk_bf16_f32 v170, v172, v173
  s_waitcnt lgkmcnt(9)
  v_mfma_f32_16x16x32_bf16 v[188:191], a[240:243], v[64:67], v[216:219]
  v_exp_f32 v174, v174
  v_mfma_f32_16x16x32_bf16 v[196:199], a[240:243], v[68:71], v[220:223]
  v_mfma_f32_16x16x32_bf16 v[204:207], a[240:243], v[72:75], v[224:227]
  v_exp_f32 v175, v175
  v_mfma_f32_16x16x32_bf16 v[212:215], a[240:243], v[76:79], v[228:231]
  v_cvt_pk_bf16_f32 v171, v174, v175
  s_waitcnt lgkmcnt(6)
  v_mfma_f32_16x16x32_bf16 v[188:191], a[244:247], v[84:87], v[188:191]
  v_exp_f32 v180, v180
  v_mfma_f32_16x16x32_bf16 v[196:199], a[244:247], v[88:91], v[196:199]
  v_mfma_f32_16x16x32_bf16 v[204:207], a[244:247], v[92:95], v[204:207]
  v_exp_f32 v181, v181
  v_mfma_f32_16x16x32_bf16 v[212:215], a[244:247], v[96:99], v[212:215]
  v_cvt_pk_bf16_f32 v178, v180, v181
  s_waitcnt lgkmcnt(3)
  v_mfma_f32_16x16x32_bf16 v[188:191], a[248:251], v[104:107], v[188:191]
  v_exp_f32 v182, v182
  v_mfma_f32_16x16x32_bf16 v[196:199], a[248:251], v[108:111], v[196:199]
  v_mfma_f32_16x16x32_bf16 v[204:207], a[248:251], v[112:115], v[204:207]
  v_exp_f32 v183, v183
  v_mfma_f32_16x16x32_bf16 v[212:215], a[248:251], v[116:119], v[212:215]
  v_cvt_pk_bf16_f32 v179, v182, v183
  s_waitcnt lgkmcnt(0)
  v_mfma_f32_16x16x32_bf16 v[188:191], a[252:255], v[124:127], v[188:191]
  v_exp_f32 v184, v184
  v_mfma_f32_16x16x32_bf16 v[196:199], a[252:255], v[128:131], v[196:199]
  v_mfma_f32_16x16x32_bf16 v[204:207], a[252:255], v[132:135], v[204:207]
  v_exp_f32 v185, v185
  v_mfma_f32_16x16x32_bf16 v[212:215], a[252:255], v[136:139], v[212:215]
  v_cvt_pk_bf16_f32 v184, v184, v185
  v_mfma_f32_16x16x32_bf16 v[236:239], v[56:59], v[144:147], v[236:239]
  v_exp_f32 v186, v186
  v_mfma_f32_16x16x32_bf16 v[240:243], v[56:59], v[152:155], v[240:243]
  v_mfma_f32_16x16x32_bf16 v[244:247], v[56:59], v[160:163], v[244:247]
  v_exp_f32 v187, v187
  v_mfma_f32_16x16x32_bf16 v[248:251], v[56:59], v[168:171], v[248:251]
  v_cvt_pk_bf16_f32 v185, v186, v187
  v_mfma_f32_16x16x32_bf16 v[252:255], v[56:59], v[176:179], v[252:255]
  v_exp_f32 v192, v192
  v_mfma_f32_16x16x32_bf16 a[0:3], v[40:43], v[144:147], a[0:3]
  v_mfma_f32_16x16x32_bf16 a[32:35], v[40:43], v[152:155], a[32:35]
  v_exp_f32 v193, v193
  v_mfma_f32_16x16x32_bf16 a[64:67], v[40:43], v[160:163], a[64:67]
  v_cvt_pk_bf16_f32 v192, v192, v193
  v_mfma_f32_16x16x32_bf16 a[96:99], v[40:43], v[168:171], a[96:99]
  v_exp_f32 v194, v194
  v_mfma_f32_16x16x32_bf16 a[128:131], v[40:43], v[176:179], a[128:131]
  ds_read_b64_tr_b16 v[40:41], v20 offset:49152
  ds_read_b64_tr_b16 v[42:43], v20 offset:53248
  v_mfma_f32_16x16x32_bf16 a[4:7], v[44:47], v[144:147], a[4:7]
  v_exp_f32 v195, v195
  v_mfma_f32_16x16x32_bf16 a[36:39], v[44:47], v[152:155], a[36:39]
  v_cvt_pk_bf16_f32 v193, v194, v195
  v_mfma_f32_16x16x32_bf16 a[68:71], v[44:47], v[160:163], a[68:71]
  v_exp_f32 v200, v200
  v_mfma_f32_16x16x32_bf16 a[100:103], v[44:47], v[168:171], a[100:103]
  v_mfma_f32_16x16x32_bf16 a[132:135], v[44:47], v[176:179], a[132:135]
  v_exp_f32 v201, v201
  v_mfma_f32_16x16x32_bf16 a[8:11], v[48:51], v[144:147], a[8:11]
  ds_read_b64_tr_b16 v[44:45], v21 offset:49152
  v_cvt_pk_bf16_f32 v200, v200, v201
  v_mfma_f32_16x16x32_bf16 a[40:43], v[48:51], v[152:155], a[40:43]
  v_exp_f32 v202, v202
  v_mfma_f32_16x16x32_bf16 a[72:75], v[48:51], v[160:163], a[72:75]
  ds_read_b64_tr_b16 v[46:47], v21 offset:53248
  v_mfma_f32_16x16x32_bf16 a[104:107], v[48:51], v[168:171], a[104:107]
  v_exp_f32 v203, v203
  v_mfma_f32_16x16x32_bf16 a[136:139], v[48:51], v[176:179], a[136:139]
  ds_read_b64_tr_b16 v[48:49], v22 offset:49152
  v_cvt_pk_bf16_f32 v201, v202, v203
  s_sub_u32 s44, s44, 1
  s_cmp_eq_u32 s44, 0
  s_cbranch_scc1 K1_T
  v_mfma_f32_16x16x32_bf16 a[12:15], v[52:55], v[144:147], a[12:15]
  s_waitcnt vmcnt(8)
  s_barrier
  v_exp_f32 v208, v208
  v_mfma_f32_16x16x32_bf16 a[44:47], v[52:55], v[152:155], a[44:47]
  ds_read_b64_tr_b16 v[50:51], v22 offset:53248
  ds_read_b128 a[240:243], v8 offset:0
  v_mfma_f32_16x16x32_bf16 a[76:79], v[52:55], v[160:163], a[76:79]
  v_exp_f32 v209, v209
  v_mfma_f32_16x16x32_bf16 a[108:111], v[52:55], v[168:171], a[108:111]
  ds_read_b128 a[244:247], v9 offset:0
  v_cvt_pk_bf16_f32 v208, v208, v209
  v_mfma_f32_16x16x32_bf16 a[140:143], v[52:55], v[176:179], a[140:143]
  v_exp_f32 v210, v210
  s_waitcnt lgkmcnt(6)
  v_mfma_f32_16x16x32_bf16 a[16:19], v[40:43], v[144:147], a[16:19]
  ds_read_b64_tr_b16 v[52:53], v23 offset:49152
  ds_read_b64_tr_b16 v[54:55], v23 offset:53248
  v_mfma_f32_16x16x32_bf16 a[48:51], v[40:43], v[152:155], a[48:51]
  v_exp_f32 v211, v211
  v_mfma_f32_16x16x32_bf16 a[80:83], v[40:43], v[160:163], a[80:83]
  ds_read_b128 a[248:251], v10 offset:0
  v_cvt_pk_bf16_f32 v209, v210, v211
  v_mfma_f32_16x16x32_bf16 a[112:115], v[40:43], v[168:171], a[112:115]
  v_exp_f32 v188, v188
  v_mfma_f32_16x16x32_bf16 a[144:147], v[40:43], v[176:179], a[144:147]
  ds_read_b128 a[252:255], v11 offset:0
  s_add_u32 m0, s43, 98304
  s_nop 0
  buffer_load_dwordx4 v38, s[20:23], s54 offen offset:0 nt lds
  s_waitcnt lgkmcnt(8)
  v_mfma_f32_16x16x32_bf16 a[20:23], v[44:47], v[144:147], a[20:23]
  v_exp_f32 v189, v189
  v_mfma_f32_16x16x32_bf16 a[52:55], v[44:47], v[152:155], a[52:55]
  v_cvt_pk_bf16_f32 v186, v188, v189
  v_mfma_f32_16x16x32_bf16 a[84:87], v[44:47], v[160:163], a[84:87]
  v_exp_f32 v190, v190
  v_mfma_f32_16x16x32_bf16 a[116:119], v[44:47], v[168:171], a[116:119]
  v_mfma_f32_16x16x32_bf16 a[148:151], v[44:47], v[176:179], a[148:151]
  v_exp_f32 v191, v191
  s_waitcnt lgkmcnt(6)
  v_mfma_f32_16x16x32_bf16 a[24:27], v[48:51], v[144:147], a[24:27]
  v_cvt_pk_bf16_f32 v187, v190, v191
  v_mfma_f32_16x16x32_bf16 a[56:59], v[48:51], v[152:155], a[56:59]
  v_exp_f32 v196, v196
  v_mfma_f32_16x16x32_bf16 a[88:91], v[48:51], v[160:163], a[88:91]
  buffer_load_dwordx4 v39, s[20:23], s54 offen offset:1024 nt lds
  v_mfma_f32_16x16x32_bf16 a[120:123], v[48:51], v[168:171], a[120:123]
  v_exp_f32 v197, v197
  v_mfma_f32_16x16x32_bf16 a[152:155], v[48:51], v[176:179], a[152:155]
  v_cvt_pk_bf16_f32 v194, v196, v197
  s_waitcnt lgkmcnt(2)
  v_mfma_f32_16x16x32_bf16 a[28:31], v[52:55], v[144:147], a[28:31]
  v_exp_f32 v198, v198
  v_mfma_f32_16x16x32_bf16 a[60:63], v[52:55], v[152:155], a[60:63]
  v_mfma_f32_16x16x32_bf16 a[92:95], v[52:55], v[160:163], a[92:95]
  v_exp_f32 v199, v199
  v_mfma_f32_16x16x32_bf16 a[124:127], v[52:55], v[168:171], a[124:127]
  v_cvt_pk_bf16_f32 v195, v198, v199
  v_mfma_f32_16x16x32_bf16 a[156:159], v[52:55], v[176:179], a[156:159]
  v_exp_f32 v204, v204
  v_mfma_f32_16x16x32_bf16 v[144:147], a[240:243], v[64:67], v[216:219]
  buffer_load_dwordx4 v38, s[20:23], s54 offen offset:2048 nt lds
  v_mfma_f32_16x16x32_bf16 v[152:155], a[240:243], v[68:71], v[220:223]
  v_exp_f32 v205, v205
  v_mfma_f32_16x16x32_bf16 v[160:163], a[240:243], v[72:75], v[224:227]
  v_cvt_pk_bf16_f32 v202, v204, v205
  v_mfma_f32_16x16x32_bf16 v[168:171], a[240:243], v[76:79], v[228:231]
  v_exp_f32 v206, v206
  v_mfma_f32_16x16x32_bf16 v[176:179], a[240:243], v[80:83], v[232:235]
  ds_read_b128 a[240:243], v8 offset:4096
  ds_read_b64_tr_b16 v[40:41], v24 offset:49152
  v_mfma_f32_16x16x32_bf16 v[144:147], a[244:247], v[84:87], v[144:147]
  v_exp_f32 v207, v207
  v_mfma_f32_16x16x32_bf16 v[152:155], a[244:247], v[88:91], v[152:155]
  ds_read_b64_tr_b16 v[42:43], v24 offset:53248
  v_cvt_pk_bf16_f32 v203, v206, v207
  v_mfma_f32_16x16x32_bf16 v[160:163], a[244:247], v[92:95], v[160:163]
  v_exp_f32 v212, v212
  v_mfma_f32_16x16x32_bf16 v[168:171], a[244:247], v[96:99], v[168:171]
  ds_read_b64_tr_b16 v[44:45], v25 offset:49152
  ds_read_b64_tr_b16 v[46:47], v25 offset:53248
  v_mfma_f32_16x16x32_bf16 v[176:179], a[244:247], v[100:103], v[176:179]
  v_exp_f32 v213, v213
  s_waitcnt lgkmcnt(6)
  v_mfma_f32_16x16x32_bf16 v[144:147], a[248:251], v[104:107], v[144:147]
  ds_read_b128 a[244:247], v9 offset:4096
  v_cvt_pk_bf16_f32 v210, v212, v213
  v_mfma_f32_16x16x32_bf16 v[152:155], a[248:251], v[108:111], v[152:155]
  v_exp_f32 v214, v214
  v_mfma_f32_16x16x32_bf16 v[160:163], a[248:251], v[112:115], v[160:163]
  ds_read_b64_tr_b16 v[48:49], v26 offset:49152
  ds_read_b64_tr_b16 v[50:51], v26 offset:53248
  v_mfma_f32_16x16x32_bf16 v[168:171], a[248:251], v[116:119], v[168:171]
  v_exp_f32 v215, v215
  v_mfma_f32_16x16x32_bf16 v[176:179], a[248:251], v[120:123], v[176:179]
  ds_read_b128 a[248:251], v10 offset:4096
  v_cvt_pk_bf16_f32 v211, v214, v215
  s_waitcnt lgkmcnt(9)
  v_mfma_f32_16x16x32_bf16 v[144:147], a[252:255], v[124:127], v[144:147]
  buffer_load_dwordx4 v39, s[20:23], s54 offen offset:3072 nt lds
  s_add_u32 s54, s54, 16384
  v_mfma_f32_16x16x32_bf16 v[152:155], a[252:255], v[128:131], v[152:155]
  ds_read_b64_tr_b16 v[52:53], v27 offset:49152
  ds_read_b64_tr_b16 v[54:55], v27 offset:53248
  v_mfma_f32_16x16x32_bf16 v[160:163], a[252:255], v[132:135], v[160:163]
  v_mfma_f32_16x16x32_bf16 v[168:171], a[252:255], v[136:139], v[168:171]
  v_mfma_f32_16x16x32_bf16 v[176:179], a[252:255], v[140:143], v[176:179]
  ds_read_b128 a[252:255], v11 offset:4096
  s_waitcnt lgkmcnt(11)
  v_mfma_f32_16x16x32_bf16 v[148:151], a[240:243], v[64:67], v[216:219]
  v_mfma_f32_16x16x32_bf16 v[156:159], a[240:243], v[68:71], v[220:223]
  v_mfma_f32_16x16x32_bf16 v[164:167], a[240:243], v[72:75], v[224:227]
  v_mfma_f32_16x16x32_bf16 v[172:175], a[240:243], v[76:79], v[228:231]
  s_add_u32 m0, s43, 32768
  s_nop 0
  buffer_load_dwordx4 v34, s[16:19], s47 offen offset:0 nt lds
  v_mfma_f32_16x16x32_bf16 v[180:183], a[240:243], v[80:83], v[232:235]
  v_exp_f32 v144, v144
  s_waitcnt lgkmcnt(6)
  v_mfma_f32_16x16x32_bf16 v[148:151], a[244:247], v[84:87], v[148:151]
  v_mfma_f32_16x16x32_bf16 v[156:159], a[244:247], v[88:91], v[156:159]
  v_exp_f32 v145, v145
  v_mfma_f32_16x16x32_bf16 v[164:167], a[244:247], v[92:95], v[164:167]
  v_cvt_pk_bf16_f32 v144, v144, v145
  v_mfma_f32_16x16x32_bf16 v[172:175], a[244:247], v[96:99], v[172:175]
  v_exp_f32 v146, v146
  v_mfma_f32_16x16x32_bf16 v[180:183], a[244:247], v[100:103], v[180:183]
  s_waitcnt lgkmcnt(3)
  v_mfma_f32_16x16x32_bf16 v[148:151], a[248:251], v[104:107], v[148:151]
  v_exp_f32 v147, v147
  v_mfma_f32_16x16x32_bf16 v[156:159], a[248:251], v[108:111], v[156:159]
  buffer_load_dwordx4 v35, s[16:19], s47 offen offset:1024 nt lds
  v_cvt_pk_bf16_f32 v145, v146, v147
  v_mfma_f32_16x16x32_bf16 v[164:167], a[248:251], v[112:115], v[164:167]
  v_exp_f32 v152, v152
  v_mfma_f32_16x16x32_bf16 v[172:175], a[248:251], v[116:119], v[172:175]
  v_mfma_f32_16x16x32_bf16 v[180:183], a[248:251], v[120:123], v[180:183]
  v_exp_f32 v153, v153
  s_waitcnt lgkmcnt(0)
  v_mfma_f32_16x16x32_bf16 v[148:151], a[252:255], v[124:127], v[148:151]
  v_cvt_pk_bf16_f32 v152, v152, v153
  v_mfma_f32_16x16x32_bf16 v[156:159], a[252:255], v[128:131], v[156:159]
  v_exp_f32 v154, v154
  v_mfma_f32_16x16x32_bf16 v[164:167], a[252:255], v[132:135], v[164:167]
  ds_read_b128 a[240:243], v12 offset:0
  v_mfma_f32_16x16x32_bf16 v[172:175], a[252:255], v[136:139], v[172:175]
  v_exp_f32 v155, v155
  v_mfma_f32_16x16x32_bf16 v[180:183], a[252:255], v[140:143], v[180:183]
  buffer_load_dwordx4 v36, s[16:19], s47 offen offset:2048 nt lds
  v_cvt_pk_bf16_f32 v153, v154, v155
  v_mfma_f32_16x16x32_bf16 v[236:239], v[56:59], v[184:187], v[236:239]
  v_exp_f32 v160, v160
  v_mfma_f32_16x16x32_bf16 v[240:243], v[56:59], v[192:195], v[240:243]
  ds_read_b128 a[244:247], v13 offset:0
  v_mfma_f32_16x16x32_bf16 v[244:247], v[56:59], v[200:203], v[244:247]
  v_exp_f32 v161, v161
  v_mfma_f32_16x16x32_bf16 v[248:251], v[56:59], v[208:211], v[248:251]
  v_cvt_pk_bf16_f32 v160, v160, v161
  v_mfma_f32_16x16x32_bf16 a[0:3], v[40:43], v[184:187], a[0:3]
  v_exp_f32 v162, v162
  v_mfma_f32_16x16x32_bf16 a[32:35], v[40:43], v[192:195], a[32:35]
  ds_read_b128 a[248:251], v14 offset:0
  v_mfma_f32_16x16x32_bf16 a[64:67], v[40:43], v[200:203], a[64:67]
  v_exp_f32 v163, v163
  v_mfma_f32_16x16x32_bf16 a[96:99], v[40:43], v[208:211], a[96:99]
  ds_read_b64_tr_b16 v[40:41], v28 offset:49152
  v_cvt_pk_bf16_f32 v161, v162, v163
  v_mfma_f32_16x16x32_bf16 a[4:7], v[44:47], v[184:187], a[4:7]
  v_exp_f32 v168, v168
  v_mfma_f32_16x16x32_bf16 a[36:39], v[44:47], v[192:195], a[36:39]
  ds_read_b64_tr_b16 v[42:43], v28 offset:53248
  ds_read_b128 a[252:255], v15 offset:0
  v_mfma_f32_16x16x32_bf16 a[68:71], v[44:47], v[200:203], a[68:71]
  v_exp_f32 v169, v169
  v_mfma_f32_16x16x32_bf16 a[100:103], v[44:47], v[208:211], a[100:103]
  ds_read_b64_tr_b16 v[44:45], v29 offset:49152
  v_cvt_pk_bf16_f32 v168, v168, v169
  v_mfma_f32_16x16x32_bf16 a[8:11], v[48:51], v[184:187], a[8:11]
  v_exp_f32 v170, v170
  v_mfma_f32_16x16x32_bf16 a[40:43], v[48:51], v[192:195], a[40:43]
  ds_read_b64_tr_b16 v[46:47], v29 offset:53248
  buffer_load_dwordx4 v37, s[16:19], s47 offen offset:3072 nt lds
  s_add_u32 s47, s47, 16384
  v_mfma_f32_16x16x32_bf16 a[72:75], v[48:51], v[200:203], a[72:75]
  v_exp_f32 v171, v171
  v_mfma_f32_16x16x32_bf16 a[104:107], v[48:51], v[208:211], a[104:107]
  ds_read_b64_tr_b16 v[48:49], v30 offset:49152
  v_cvt_pk_bf16_f32 v169, v170, v171
  v_mfma_f32_16x16x32_bf16 a[12:15], v[52:55], v[184:187], a[12:15]
  v_exp_f32 v176, v176
  v_mfma_f32_16x16x32_bf16 a[44:47], v[52:55], v[192:195], a[44:47]
  ds_read_b64_tr_b16 v[50:51], v30 offset:53248
  v_mfma_f32_16x16x32_bf16 a[76:79], v[52:55], v[200:203], a[76:79]
  v_exp_f32 v177, v177
  v_mfma_f32_16x16x32_bf16 a[108:111], v[52:55], v[208:211], a[108:111]
  ds_read_b64_tr_b16 v[52:53], v31 offset:49152
  v_cvt_pk_bf16_f32 v176, v176, v177
  s_waitcnt lgkmcnt(6)
  v_mfma_f32_16x16x32_bf16 a[16:19], v[40:43], v[184:187], a[16:19]
  v_exp_f32 v178, v178
  v_mfma_f32_16x16x32_bf16 a[48:51], v[40:43], v[192:195], a[48:51]
  ds_read_b64_tr_b16 v[54:55], v31 offset:53248
  v_mfma_f32_16x16x32_bf16 a[80:83], v[40:43], v[200:203], a[80:83]
  v_exp_f32 v179, v179
  v_mfma_f32_16x16x32_bf16 a[112:115], v[40:43], v[208:211], a[112:115]
  v_cvt_pk_bf16_f32 v177, v178, v179
  s_waitcnt lgkmcnt(4)
  v_mfma_f32_16x16x32_bf16 a[20:23], v[44:47], v[184:187], a[20:23]
  v_exp_f32 v148, v148
  v_mfma_f32_16x16x32_bf16 a[52:55], v[44:47], v[192:195], a[52:55]
  v_mfma_f32_16x16x32_bf16 a[84:87], v[44:47], v[200:203], a[84:87]
  v_exp_f32 v149, v149
  v_mfma_f32_16x16x32_bf16 a[116:119], v[44:47], v[208:211], a[116:119]
  v_cvt_pk_bf16_f32 v146, v148, v149
  s_waitcnt lgkmcnt(2)
  v_mfma_f32_16x16x32_bf16 a[24:27], v[48:51], v[184:187], a[24:27]
  v_exp_f32 v150, v150
  v_mfma_f32_16x16x32_bf16 a[56:59], v[48:51], v[192:195], a[56:59]
  v_mfma_f32_16x16x32_bf16 a[88:91], v[48:51], v[200:203], a[88:91]
  v_exp_f32 v151, v151
  v_mfma_f32_16x16x32_bf16 a[120:123], v[48:51], v[208:211], a[120:123]
  v_cvt_pk_bf16_f32 v147, v150, v151
  s_waitcnt lgkmcnt(0)
  v_mfma_f32_16x16x32_bf16 a[28:31], v[52:55], v[184:187], a[28:31]
  v_exp_f32 v156, v156
  v_mfma_f32_16x16x32_bf16 a[60:63], v[52:55], v[192:195], a[60:63]
  ds_read_b64_tr_b16 v[40:41], v16 offset:0
  ds_read_b64_tr_b16 v[42:43], v16 offset:4096
  v_mfma_f32_16x16x32_bf16 a[92:95], v[52:55], v[200:203], a[92:95]
  v_exp_f32 v157, v157
  v_mfma_f32_16x16x32_bf16 a[124:127], v[52:55], v[208:211], a[124:127]
  v_cvt_pk_bf16_f32 v154, v156, v157
  v_mfma_f32_16x16x32_bf16 v[184:187], a[240:243], v[64:67], v[216:219]
  v_exp_f32 v158, v158
  v_mfma_f32_16x16x32_bf16 v[192:195], a[240:243], v[68:71], v[220:223]
  v_mfma_f32_16x16x32_bf16 v[200:203], a[240:243], v[72:75], v[224:227]
  v_exp_f32 v159, v159
  v_mfma_f32_16x16x32_bf16 v[208:211], a[240:243], v[76:79], v[228:231]
  ds_read_b128 a[240:243], v12 offset:4096
  v_cvt_pk_bf16_f32 v155, v158, v159
  v_mfma_f32_16x16x32_bf16 v[184:187], a[244:247], v[84:87], v[184:187]
  v_exp_f32 v164, v164
  v_mfma_f32_16x16x32_bf16 v[192:195], a[244:247], v[88:91], v[192:195]
  ds_read_b64_tr_b16 v[44:45], v17 offset:0
  ds_read_b64_tr_b16 v[46:47], v17 offset:4096
  v_mfma_f32_16x16x32_bf16 v[200:203], a[244:247], v[92:95], v[200:203]
  v_exp_f32 v165, v165
  v_mfma_f32_16x16x32_bf16 v[208:211], a[244:247], v[96:99], v[208:211]
  ds_read_b128 a[244:247], v13 offset:4096
  v_cvt_pk_bf16_f32 v162, v164, v165
  v_mfma_f32_16x16x32_bf16 v[184:187], a[248:251], v[104:107], v[184:187]
  v_exp_f32 v166, v166
  v_mfma_f32_16x16x32_bf16 v[192:195], a[248:251], v[108:111], v[192:195]
  ds_read_b64_tr_b16 v[48:49], v18 offset:0
  ds_read_b64_tr_b16 v[50:51], v18 offset:4096
  v_mfma_f32_16x16x32_bf16 v[200:203], a[248:251], v[112:115], v[200:203]
  v_exp_f32 v167, v167
  v_mfma_f32_16x16x32_bf16 v[208:211], a[248:251], v[116:119], v[208:211]
  ds_read_b128 a[248:251], v14 offset:4096
  v_cvt_pk_bf16_f32 v163, v166, v167
  v_mfma_f32_16x16x32_bf16 v[184:187], a[252:255], v[124:127], v[184:187]
  v_exp_f32 v172, v172
  v_mfma_f32_16x16x32_bf16 v[192:195], a[252:255], v[128:131], v[192:195]
  ds_read_b64_tr_b16 v[52:53], v19 offset:0
  ds_read_b64_tr_b16 v[54:55], v19 offset:4096
  v_mfma_f32_16x16x32_bf16 v[200:203], a[252:255], v[132:135], v[200:203]
  v_exp_f32 v173, v173
  v_mfma_f32_16x16x32_bf16 v[208:211], a[252:255], v[136:139], v[208:211]
  ds_read_b128 a[252:255], v15 offset:4096
  v_cvt_pk_bf16_f32 v170, v172, v173
  s_waitcnt lgkmcnt(9)
  v_mfma_f32_16x16x32_bf16 v[188:191], a[240:243], v[64:67], v[216:219]
  v_exp_f32 v174, v174
  v_mfma_f32_16x16x32_bf16 v[196:199], a[240:243], v[68:71], v[220:223]
  v_mfma_f32_16x16x32_bf16 v[204:207], a[240:243], v[72:75], v[224:227]
  v_exp_f32 v175, v175
  v_mfma_f32_16x16x32_bf16 v[212:215], a[240:243], v[76:79], v[228:231]
  v_cvt_pk_bf16_f32 v171, v174, v175
  s_waitcnt lgkmcnt(6)
  v_mfma_f32_16x16x32_bf16 v[188:191], a[244:247], v[84:87], v[188:191]
  v_exp_f32 v180, v180
  v_mfma_f32_16x16x32_bf16 v[196:199], a[244:247], v[88:91], v[196:199]
  v_mfma_f32_16x16x32_bf16 v[204:207], a[244:247], v[92:95], v[204:207]
  v_exp_f32 v181, v181
  v_mfma_f32_16x16x32_bf16 v[212:215], a[244:247], v[96:99], v[212:215]
  v_cvt_pk_bf16_f32 v178, v180, v181
  s_waitcnt lgkmcnt(3)
  v_mfma_f32_16x16x32_bf16 v[188:191], a[248:251], v[104:107], v[188:191]
  v_exp_f32 v182, v182
  v_mfma_f32_16x16x32_bf16 v[196:199], a[248:251], v[108:111], v[196:199]
  v_mfma_f32_16x16x32_bf16 v[204:207], a[248:251], v[112:115], v[204:207]
  v_exp_f32 v183, v183
  v_mfma_f32_16x16x32_bf16 v[212:215], a[248:251], v[116:119], v[212:215]
  v_cvt_pk_bf16_f32 v179, v182, v183
  s_waitcnt lgkmcnt(0)
  v_mfma_f32_16x16x32_bf16 v[188:191], a[252:255], v[124:127], v[188:191]
  v_exp_f32 v184, v184
  v_mfma_f32_16x16x32_bf16 v[196:199], a[252:255], v[128:131], v[196:199]
  v_mfma_f32_16x16x32_bf16 v[204:207], a[252:255], v[132:135], v[204:207]
  v_exp_f32 v185, v185
  v_mfma_f32_16x16x32_bf16 v[212:215], a[252:255], v[136:139], v[212:215]
  v_cvt_pk_bf16_f32 v184, v184, v185
  v_mfma_f32_16x16x32_bf16 v[236:239], v[56:59], v[144:147], v[236:239]
  v_exp_f32 v186, v186
  v_mfma_f32_16x16x32_bf16 v[240:243], v[56:59], v[152:155], v[240:243]
  v_mfma_f32_16x16x32_bf16 v[244:247], v[56:59], v[160:163], v[244:247]
  v_exp_f32 v187, v187
  v_mfma_f32_16x16x32_bf16 v[248:251], v[56:59], v[168:171], v[248:251]
  v_cvt_pk_bf16_f32 v185, v186, v187
  v_mfma_f32_16x16x32_bf16 v[252:255], v[56:59], v[176:179], v[252:255]
  v_exp_f32 v192, v192
  v_mfma_f32_16x16x32_bf16 a[0:3], v[40:43], v[144:147], a[0:3]
  v_mfma_f32_16x16x32_bf16 a[32:35], v[40:43], v[152:155], a[32:35]
  v_exp_f32 v193, v193
  v_mfma_f32_16x16x32_bf16 a[64:67], v[40:43], v[160:163], a[64:67]
  v_cvt_pk_bf16_f32 v192, v192, v193
  v_mfma_f32_16x16x32_bf16 a[96:99], v[40:43], v[168:171], a[96:99]
  v_exp_f32 v194, v194
  v_mfma_f32_16x16x32_bf16 a[128:131], v[40:43], v[176:179], a[128:131]
  ds_read_b64_tr_b16 v[40:41], v20 offset:0
  ds_read_b64_tr_b16 v[42:43], v20 offset:4096
  v_mfma_f32_16x16x32_bf16 a[4:7], v[44:47], v[144:147], a[4:7]
  v_exp_f32 v195, v195
  v_mfma_f32_16x16x32_bf16 a[36:39], v[44:47], v[152:155], a[36:39]
  v_cvt_pk_bf16_f32 v193, v194, v195
  v_mfma_f32_16x16x32_bf16 a[68:71], v[44:47], v[160:163], a[68:71]
  v_exp_f32 v200, v200
  v_mfma_f32_16x16x32_bf16 a[100:103], v[44:47], v[168:171], a[100:103]
  v_mfma_f32_16x16x32_bf16 a[132:135], v[44:47], v[176:179], a[132:135]
  v_exp_f32 v201, v201
  v_mfma_f32_16x16x32_bf16 a[8:11], v[48:51], v[144:147], a[8:11]
  ds_read_b64_tr_b16 v[44:45], v21 offset:0
  v_cvt_pk_bf16_f32 v200, v200, v201
  v_mfma_f32_16x16x32_bf16 a[40:43], v[48:51], v[152:155], a[40:43]
  v_exp_f32 v202, v202
  v_mfma_f32_16x16x32_bf16 a[72:75], v[48:51], v[160:163], a[72:75]
  ds_read_b64_tr_b16 v[46:47], v21 offset:4096
  v_mfma_f32_16x16x32_bf16 a[104:107], v[48:51], v[168:171], a[104:107]
  v_exp_f32 v203, v203
  v_mfma_f32_16x16x32_bf16 a[136:139], v[48:51], v[176:179], a[136:139]
  ds_read_b64_tr_b16 v[48:49], v22 offset:0
  v_cvt_pk_bf16_f32 v201, v202, v203
  v_mfma_f32_16x16x32_bf16 a[12:15], v[52:55], v[144:147], a[12:15]
  s_waitcnt vmcnt(8)
  s_barrier
  v_exp_f32 v208, v208
  v_mfma_f32_16x16x32_bf16 a[44:47], v[52:55], v[152:155], a[44:47]
  ds_read_b64_tr_b16 v[50:51], v22 offset:4096
  ds_read_b128 a[240:243], v8 offset:16384
  v_mfma_f32_16x16x32_bf16 a[76:79], v[52:55], v[160:163], a[76:79]
  v_exp_f32 v209, v209
  v_mfma_f32_16x16x32_bf16 a[108:111], v[52:55], v[168:171], a[108:111]
  ds_read_b128 a[244:247], v9 offset:16384
  v_cvt_pk_bf16_f32 v208, v208, v209
  v_mfma_f32_16x16x32_bf16 a[140:143], v[52:55], v[176:179], a[140:143]
  v_exp_f32 v210, v210
  s_waitcnt lgkmcnt(6)
  v_mfma_f32_16x16x32_bf16 a[16:19], v[40:43], v[144:147], a[16:19]
  ds_read_b64_tr_b16 v[52:53], v23 offset:0
  ds_read_b64_tr_b16 v[54:55], v23 offset:4096
  v_mfma_f32_16x16x32_bf16 a[48:51], v[40:43], v[152:155], a[48:51]
  v_exp_f32 v211, v211
  v_mfma_f32_16x16x32_bf16 a[80:83], v[40:43], v[160:163], a[80:83]
  ds_read_b128 a[248:251], v10 offset:16384
  v_cvt_pk_bf16_f32 v209, v210, v211
  v_mfma_f32_16x16x32_bf16 a[112:115], v[40:43], v[168:171], a[112:115]
  v_exp_f32 v188, v188
  v_mfma_f32_16x16x32_bf16 a[144:147], v[40:43], v[176:179], a[144:147]
  ds_read_b128 a[252:255], v11 offset:16384
  s_add_u32 m0, s43, 114688
  s_nop 0
  buffer_load_dwordx4 v38, s[20:23], s54 offen offset:0 nt lds
  s_waitcnt lgkmcnt(8)
  v_mfma_f32_16x16x32_bf16 a[20:23], v[44:47], v[144:147], a[20:23]
  v_exp_f32 v189, v189
  v_mfma_f32_16x16x32_bf16 a[52:55], v[44:47], v[152:155], a[52:55]
  v_cvt_pk_bf16_f32 v186, v188, v189
  v_mfma_f32_16x16x32_bf16 a[84:87], v[44:47], v[160:163], a[84:87]
  v_exp_f32 v190, v190
  v_mfma_f32_16x16x32_bf16 a[116:119], v[44:47], v[168:171], a[116:119]
  v_mfma_f32_16x16x32_bf16 a[148:151], v[44:47], v[176:179], a[148:151]
  v_exp_f32 v191, v191
  s_waitcnt lgkmcnt(6)
  v_mfma_f32_16x16x32_bf16 a[24:27], v[48:51], v[144:147], a[24:27]
  v_cvt_pk_bf16_f32 v187, v190, v191
  v_mfma_f32_16x16x32_bf16 a[56:59], v[48:51], v[152:155], a[56:59]
  v_exp_f32 v196, v196
  v_mfma_f32_16x16x32_bf16 a[88:91], v[48:51], v[160:163], a[88:91]
  buffer_load_dwordx4 v39, s[20:23], s54 offen offset:1024 nt lds
  v_mfma_f32_16x16x32_bf16 a[120:123], v[48:51], v[168:171], a[120:123]
  v_exp_f32 v197, v197
  v_mfma_f32_16x16x32_bf16 a[152:155], v[48:51], v[176:179], a[152:155]
  v_cvt_pk_bf16_f32 v194, v196, v197
  s_waitcnt lgkmcnt(2)
  v_mfma_f32_16x16x32_bf16 a[28:31], v[52:55], v[144:147], a[28:31]
  v_exp_f32 v198, v198
  v_mfma_f32_16x16x32_bf16 a[60:63], v[52:55], v[152:155], a[60:63]
  v_mfma_f32_16x16x32_bf16 a[92:95], v[52:55], v[160:163], a[92:95]
  v_exp_f32 v199, v199
  v_mfma_f32_16x16x32_bf16 a[124:127], v[52:55], v[168:171], a[124:127]
  v_cvt_pk_bf16_f32 v195, v198, v199
  v_mfma_f32_16x16x32_bf16 a[156:159], v[52:55], v[176:179], a[156:159]
  v_exp_f32 v204, v204
  v_mfma_f32_16x16x32_bf16 v[144:147], a[240:243], v[64:67], v[216:219]
  buffer_load_dwordx4 v38, s[20:23], s54 offen offset:2048 nt lds
  v_mfma_f32_16x16x32_bf16 v[152:155], a[240:243], v[68:71], v[220:223]
  v_exp_f32 v205, v205
  v_mfma_f32_16x16x32_bf16 v[160:163], a[240:243], v[72:75], v[224:227]
  v_cvt_pk_bf16_f32 v202, v204, v205
  v_mfma_f32_16x16x32_bf16 v[168:171], a[240:243], v[76:79], v[228:231]
  v_exp_f32 v206, v206
  v_mfma_f32_16x16x32_bf16 v[176:179], a[240:243], v[80:83], v[232:235]
  ds_read_b128 a[240:243], v8 offset:20480
  ds_read_b64_tr_b16 v[40:41], v24 offset:0
  v_mfma_f32_16x16x32_bf16 v[144:147], a[244:247], v[84:87], v[144:147]
  v_exp_f32 v207, v207
  v_mfma_f32_16x16x32_bf16 v[152:155], a[244:247], v[88:91], v[152:155]
  ds_read_b64_tr_b16 v[42:43], v24 offset:4096
  v_cvt_pk_bf16_f32 v203, v206, v207
  v_mfma_f32_16x16x32_bf16 v[160:163], a[244:247], v[92:95], v[160:163]
  v_exp_f32 v212, v212
  v_mfma_f32_16x16x32_bf16 v[168:171], a[244:247], v[96:99], v[168:171]
  ds_read_b64_tr_b16 v[44:45], v25 offset:0
  ds_read_b64_tr_b16 v[46:47], v25 offset:4096
  v_mfma_f32_16x16x32_bf16 v[176:179], a[244:247], v[100:103], v[176:179]
  v_exp_f32 v213, v213
  s_waitcnt lgkmcnt(6)
  v_mfma_f32_16x16x32_bf16 v[144:147], a[248:251], v[104:107], v[144:147]
  ds_read_b128 a[244:247], v9 offset:20480
  v_cvt_pk_bf16_f32 v210, v212, v213
  v_mfma_f32_16x16x32_bf16 v[152:155], a[248:251], v[108:111], v[152:155]
  v_exp_f32 v214, v214
  v_mfma_f32_16x16x32_bf16 v[160:163], a[248:251], v[112:115], v[160:163]
  ds_read_b64_tr_b16 v[48:49], v26 offset:0
  ds_read_b64_tr_b16 v[50:51], v26 offset:4096
  v_mfma_f32_16x16x32_bf16 v[168:171], a[248:251], v[116:119], v[168:171]
  v_exp_f32 v215, v215
  v_mfma_f32_16x16x32_bf16 v[176:179], a[248:251], v[120:123], v[176:179]
  ds_read_b128 a[248:251], v10 offset:20480
  v_cvt_pk_bf16_f32 v211, v214, v215
  s_waitcnt lgkmcnt(9)
  v_mfma_f32_16x16x32_bf16 v[144:147], a[252:255], v[124:127], v[144:147]
  buffer_load_dwordx4 v39, s[20:23], s54 offen offset:3072 nt lds
  s_add_u32 s54, s54, 16384
  v_mfma_f32_16x16x32_bf16 v[152:155], a[252:255], v[128:131], v[152:155]
  ds_read_b64_tr_b16 v[52:53], v27 offset:0
  ds_read_b64_tr_b16 v[54:55], v27 offset:4096
  v_mfma_f32_16x16x32_bf16 v[160:163], a[252:255], v[132:135], v[160:163]
  v_mfma_f32_16x16x32_bf16 v[168:171], a[252:255], v[136:139], v[168:171]
  v_mfma_f32_16x16x32_bf16 v[176:179], a[252:255], v[140:143], v[176:179]
  ds_read_b128 a[252:255], v11 offset:20480
  s_waitcnt lgkmcnt(11)
  v_mfma_f32_16x16x32_bf16 v[148:151], a[240:243], v[64:67], v[216:219]
  v_mfma_f32_16x16x32_bf16 v[156:159], a[240:243], v[68:71], v[220:223]
  v_mfma_f32_16x16x32_bf16 v[164:167], a[240:243], v[72:75], v[224:227]
  v_mfma_f32_16x16x32_bf16 v[172:175], a[240:243], v[76:79], v[228:231]
  s_add_u32 m0, s43, 49152
  s_nop 0
  buffer_load_dwordx4 v34, s[16:19], s47 offen offset:0 nt lds
  v_mfma_f32_16x16x32_bf16 v[180:183], a[240:243], v[80:83], v[232:235]
  v_exp_f32 v144, v144
  s_waitcnt lgkmcnt(6)
  v_mfma_f32_16x16x32_bf16 v[148:151], a[244:247], v[84:87], v[148:151]
  v_mfma_f32_16x16x32_bf16 v[156:159], a[244:247], v[88:91], v[156:159]
  v_exp_f32 v145, v145
  v_mfma_f32_16x16x32_bf16 v[164:167], a[244:247], v[92:95], v[164:167]
  v_cvt_pk_bf16_f32 v144, v144, v145
  v_mfma_f32_16x16x32_bf16 v[172:175], a[244:247], v[96:99], v[172:175]
  v_exp_f32 v146, v146
  v_mfma_f32_16x16x32_bf16 v[180:183], a[244:247], v[100:103], v[180:183]
  s_waitcnt lgkmcnt(3)
  v_mfma_f32_16x16x32_bf16 v[148:151], a[248:251], v[104:107], v[148:151]
  v_exp_f32 v147, v147
  v_mfma_f32_16x16x32_bf16 v[156:159], a[248:251], v[108:111], v[156:159]
  buffer_load_dwordx4 v35, s[16:19], s47 offen offset:1024 nt lds
  v_cvt_pk_bf16_f32 v145, v146, v147
  v_mfma_f32_16x16x32_bf16 v[164:167], a[248:251], v[112:115], v[164:167]
  v_exp_f32 v152, v152
  v_mfma_f32_16x16x32_bf16 v[172:175], a[248:251], v[116:119], v[172:175]
  v_mfma_f32_16x16x32_bf16 v[180:183], a[248:251], v[120:123], v[180:183]
  v_exp_f32 v153, v153
  s_waitcnt lgkmcnt(0)
  v_mfma_f32_16x16x32_bf16 v[148:151], a[252:255], v[124:127], v[148:151]
  v_cvt_pk_bf16_f32 v152, v152, v153
  v_mfma_f32_16x16x32_bf16 v[156:159], a[252:255], v[128:131], v[156:159]
  v_exp_f32 v154, v154
  v_mfma_f32_16x16x32_bf16 v[164:167], a[252:255], v[132:135], v[164:167]
  ds_read_b128 a[240:243], v12 offset:16384
  v_mfma_f32_16x16x32_bf16 v[172:175], a[252:255], v[136:139], v[172:175]
  v_exp_f32 v155, v155
  v_mfma_f32_16x16x32_bf16 v[180:183], a[252:255], v[140:143], v[180:183]
  buffer_load_dwordx4 v36, s[16:19], s47 offen offset:2048 nt lds
  v_cvt_pk_bf16_f32 v153, v154, v155
  v_mfma_f32_16x16x32_bf16 v[236:239], v[56:59], v[184:187], v[236:239]
  v_exp_f32 v160, v160
  v_mfma_f32_16x16x32_bf16 v[240:243], v[56:59], v[192:195], v[240:243]
  ds_read_b128 a[244:247], v13 offset:16384
  v_mfma_f32_16x16x32_bf16 v[244:247], v[56:59], v[200:203], v[244:247]
  v_exp_f32 v161, v161
  v_mfma_f32_16x16x32_bf16 v[248:251], v[56:59], v[208:211], v[248:251]
  v_cvt_pk_bf16_f32 v160, v160, v161
  v_mfma_f32_16x16x32_bf16 a[0:3], v[40:43], v[184:187], a[0:3]
  v_exp_f32 v162, v162
  v_mfma_f32_16x16x32_bf16 a[32:35], v[40:43], v[192:195], a[32:35]
  ds_read_b128 a[248:251], v14 offset:16384
  v_mfma_f32_16x16x32_bf16 a[64:67], v[40:43], v[200:203], a[64:67]
  v_exp_f32 v163, v163
  v_mfma_f32_16x16x32_bf16 a[96:99], v[40:43], v[208:211], a[96:99]
  ds_read_b64_tr_b16 v[40:41], v28 offset:0
  v_cvt_pk_bf16_f32 v161, v162, v163
  v_mfma_f32_16x16x32_bf16 a[4:7], v[44:47], v[184:187], a[4:7]
  v_exp_f32 v168, v168
  v_mfma_f32_16x16x32_bf16 a[36:39], v[44:47], v[192:195], a[36:39]
  ds_read_b64_tr_b16 v[42:43], v28 offset:4096
  ds_read_b128 a[252:255], v15 offset:16384
  v_mfma_f32_16x16x32_bf16 a[68:71], v[44:47], v[200:203], a[68:71]
  v_exp_f32 v169, v169
  v_mfma_f32_16x16x32_bf16 a[100:103], v[44:47], v[208:211], a[100:103]
  ds_read_b64_tr_b16 v[44:45], v29 offset:0
  v_cvt_pk_bf16_f32 v168, v168, v169
  v_mfma_f32_16x16x32_bf16 a[8:11], v[48:51], v[184:187], a[8:11]
  v_exp_f32 v170, v170
  v_mfma_f32_16x16x32_bf16 a[40:43], v[48:51], v[192:195], a[40:43]
  ds_read_b64_tr_b16 v[46:47], v29 offset:4096
  buffer_load_dwordx4 v37, s[16:19], s47 offen offset:3072 nt lds
  s_add_u32 s47, s47, 16384
  v_mfma_f32_16x16x32_bf16 a[72:75], v[48:51], v[200:203], a[72:75]
  v_exp_f32 v171, v171
  v_mfma_f32_16x16x32_bf16 a[104:107], v[48:51], v[208:211], a[104:107]
  ds_read_b64_tr_b16 v[48:49], v30 offset:0
  v_cvt_pk_bf16_f32 v169, v170, v171
  v_mfma_f32_16x16x32_bf16 a[12:15], v[52:55], v[184:187], a[12:15]
  v_exp_f32 v176, v176
  v_mfma_f32_16x16x32_bf16 a[44:47], v[52:55], v[192:195], a[44:47]
  ds_read_b64_tr_b16 v[50:51], v30 offset:4096
  v_mfma_f32_16x16x32_bf16 a[76:79], v[52:55], v[200:203], a[76:79]
  v_exp_f32 v177, v177
  v_mfma_f32_16x16x32_bf16 a[108:111], v[52:55], v[208:211], a[108:111]
  ds_read_b64_tr_b16 v[52:53], v31 offset:0
  v_cvt_pk_bf16_f32 v176, v176, v177
  s_waitcnt lgkmcnt(6)
  v_mfma_f32_16x16x32_bf16 a[16:19], v[40:43], v[184:187], a[16:19]
  v_exp_f32 v178, v178
  v_mfma_f32_16x16x32_bf16 a[48:51], v[40:43], v[192:195], a[48:51]
  ds_read_b64_tr_b16 v[54:55], v31 offset:4096
  v_mfma_f32_16x16x32_bf16 a[80:83], v[40:43], v[200:203], a[80:83]
  v_exp_f32 v179, v179
  v_mfma_f32_16x16x32_bf16 a[112:115], v[40:43], v[208:211], a[112:115]
  v_cvt_pk_bf16_f32 v177, v178, v179
  s_waitcnt lgkmcnt(4)
  v_mfma_f32_16x16x32_bf16 a[20:23], v[44:47], v[184:187], a[20:23]
  v_exp_f32 v148, v148
  v_mfma_f32_16x16x32_bf16 a[52:55], v[44:47], v[192:195], a[52:55]
  v_mfma_f32_16x16x32_bf16 a[84:87], v[44:47], v[200:203], a[84:87]
  v_exp_f32 v149, v149
  v_mfma_f32_16x16x32_bf16 a[116:119], v[44:47], v[208:211], a[116:119]
  v_cvt_pk_bf16_f32 v146, v148, v149
  s_waitcnt lgkmcnt(2)
  v_mfma_f32_16x16x32_bf16 a[24:27], v[48:51], v[184:187], a[24:27]
  v_exp_f32 v150, v150
  v_mfma_f32_16x16x32_bf16 a[56:59], v[48:51], v[192:195], a[56:59]
  v_mfma_f32_16x16x32_bf16 a[88:91], v[48:51], v[200:203], a[88:91]
  v_exp_f32 v151, v151
  v_mfma_f32_16x16x32_bf16 a[120:123], v[48:51], v[208:211], a[120:123]
  v_cvt_pk_bf16_f32 v147, v150, v151
  s_waitcnt lgkmcnt(0)
  v_mfma_f32_16x16x32_bf16 a[28:31], v[52:55], v[184:187], a[28:31]
  v_exp_f32 v156, v156
  v_mfma_f32_16x16x32_bf16 a[60:63], v[52:55], v[192:195], a[60:63]
  ds_read_b64_tr_b16 v[40:41], v16 offset:16384
  ds_read_b64_tr_b16 v[42:43], v16 offset:20480
  v_mfma_f32_16x16x32_bf16 a[92:95], v[52:55], v[200:203], a[92:95]
  v_exp_f32 v157, v157
  v_mfma_f32_16x16x32_bf16 a[124:127], v[52:55], v[208:211], a[124:127]
  v_cvt_pk_bf16_f32 v154, v156, v157
  v_mfma_f32_16x16x32_bf16 v[184:187], a[240:243], v[64:67], v[216:219]
  v_exp_f32 v158, v158
  v_mfma_f32_16x16x32_bf16 v[192:195], a[240:243], v[68:71], v[220:223]
  v_mfma_f32_16x16x32_bf16 v[200:203], a[240:243], v[72:75], v[224:227]
  v_exp_f32 v159, v159
  v_mfma_f32_16x16x32_bf16 v[208:211], a[240:243], v[76:79], v[228:231]
  ds_read_b128 a[240:243], v12 offset:20480
  v_cvt_pk_bf16_f32 v155, v158, v159
  v_mfma_f32_16x16x32_bf16 v[184:187], a[244:247], v[84:87], v[184:187]
  v_exp_f32 v164, v164
  v_mfma_f32_16x16x32_bf16 v[192:195], a[244:247], v[88:91], v[192:195]
  ds_read_b64_tr_b16 v[44:45], v17 offset:16384
  ds_read_b64_tr_b16 v[46:47], v17 offset:20480
  v_mfma_f32_16x16x32_bf16 v[200:203], a[244:247], v[92:95], v[200:203]
  v_exp_f32 v165, v165
  v_mfma_f32_16x16x32_bf16 v[208:211], a[244:247], v[96:99], v[208:211]
  ds_read_b128 a[244:247], v13 offset:20480
  v_cvt_pk_bf16_f32 v162, v164, v165
  v_mfma_f32_16x16x32_bf16 v[184:187], a[248:251], v[104:107], v[184:187]
  v_exp_f32 v166, v166
  v_mfma_f32_16x16x32_bf16 v[192:195], a[248:251], v[108:111], v[192:195]
  ds_read_b64_tr_b16 v[48:49], v18 offset:16384
  ds_read_b64_tr_b16 v[50:51], v18 offset:20480
  v_mfma_f32_16x16x32_bf16 v[200:203], a[248:251], v[112:115], v[200:203]
  v_exp_f32 v167, v167
  v_mfma_f32_16x16x32_bf16 v[208:211], a[248:251], v[116:119], v[208:211]
  ds_read_b128 a[248:251], v14 offset:20480
  v_cvt_pk_bf16_f32 v163, v166, v167
  v_mfma_f32_16x16x32_bf16 v[184:187], a[252:255], v[124:127], v[184:187]
  v_exp_f32 v172, v172
  v_mfma_f32_16x16x32_bf16 v[192:195], a[252:255], v[128:131], v[192:195]
  ds_read_b64_tr_b16 v[52:53], v19 offset:16384
  ds_read_b64_tr_b16 v[54:55], v19 offset:20480
  v_mfma_f32_16x16x32_bf16 v[200:203], a[252:255], v[132:135], v[200:203]
  v_exp_f32 v173, v173
  v_mfma_f32_16x16x32_bf16 v[208:211], a[252:255], v[136:139], v[208:211]
  ds_read_b128 a[252:255], v15 offset:20480
  v_cvt_pk_bf16_f32 v170, v172, v173
  s_waitcnt lgkmcnt(9)
  v_mfma_f32_16x16x32_bf16 v[188:191], a[240:243], v[64:67], v[216:219]
  v_exp_f32 v174, v174
  v_mfma_f32_16x16x32_bf16 v[196:199], a[240:243], v[68:71], v[220:223]
  v_mfma_f32_16x16x32_bf16 v[204:207], a[240:243], v[72:75], v[224:227]
  v_exp_f32 v175, v175
  v_mfma_f32_16x16x32_bf16 v[212:215], a[240:243], v[76:79], v[228:231]
  v_cvt_pk_bf16_f32 v171, v174, v175
  s_waitcnt lgkmcnt(6)
  v_mfma_f32_16x16x32_bf16 v[188:191], a[244:247], v[84:87], v[188:191]
  v_exp_f32 v180, v180
  v_mfma_f32_16x16x32_bf16 v[196:199], a[244:247], v[88:91], v[196:199]
  v_mfma_f32_16x16x32_bf16 v[204:207], a[244:247], v[92:95], v[204:207]
  v_exp_f32 v181, v181
  v_mfma_f32_16x16x32_bf16 v[212:215], a[244:247], v[96:99], v[212:215]
  v_cvt_pk_bf16_f32 v178, v180, v181
  s_waitcnt lgkmcnt(3)
  v_mfma_f32_16x16x32_bf16 v[188:191], a[248:251], v[104:107], v[188:191]
  v_exp_f32 v182, v182
  v_mfma_f32_16x16x32_bf16 v[196:199], a[248:251], v[108:111], v[196:199]
  v_mfma_f32_16x16x32_bf16 v[204:207], a[248:251], v[112:115], v[204:207]
  v_exp_f32 v183, v183
  v_mfma_f32_16x16x32_bf16 v[212:215], a[248:251], v[116:119], v[212:215]
  v_cvt_pk_bf16_f32 v179, v182, v183
  s_waitcnt lgkmcnt(0)
  v_mfma_f32_16x16x32_bf16 v[188:191], a[252:255], v[124:127], v[188:191]
  v_exp_f32 v184, v184
  v_mfma_f32_16x16x32_bf16 v[196:199], a[252:255], v[128:131], v[196:199]
  v_mfma_f32_16x16x32_bf16 v[204:207], a[252:255], v[132:135], v[204:207]
  v_exp_f32 v185, v185
  v_mfma_f32_16x16x32_bf16 v[212:215], a[252:255], v[136:139], v[212:215]
  v_cvt_pk_bf16_f32 v184, v184, v185
  v_mfma_f32_16x16x32_bf16 v[236:239], v[56:59], v[144:147], v[236:239]
  v_exp_f32 v186, v186
  v_mfma_f32_16x16x32_bf16 v[240:243], v[56:59], v[152:155], v[240:243]
  v_mfma_f32_16x16x32_bf16 v[244:247], v[56:59], v[160:163], v[244:247]
  v_exp_f32 v187, v187
  v_mfma_f32_16x16x32_bf16 v[248:251], v[56:59], v[168:171], v[248:251]
  v_cvt_pk_bf16_f32 v185, v186, v187
  v_mfma_f32_16x16x32_bf16 v[252:255], v[56:59], v[176:179], v[252:255]
  v_exp_f32 v192, v192
  v_mfma_f32_16x16x32_bf16 a[0:3], v[40:43], v[144:147], a[0:3]
  v_mfma_f32_16x16x32_bf16 a[32:35], v[40:43], v[152:155], a[32:35]
  v_exp_f32 v193, v193
  v_mfma_f32_16x16x32_bf16 a[64:67], v[40:43], v[160:163], a[64:67]
  v_cvt_pk_bf16_f32 v192, v192, v193
  v_mfma_f32_16x16x32_bf16 a[96:99], v[40:43], v[168:171], a[96:99]
  v_exp_f32 v194, v194
  v_mfma_f32_16x16x32_bf16 a[128:131], v[40:43], v[176:179], a[128:131]
  ds_read_b64_tr_b16 v[40:41], v20 offset:16384
  ds_read_b64_tr_b16 v[42:43], v20 offset:20480
  v_mfma_f32_16x16x32_bf16 a[4:7], v[44:47], v[144:147], a[4:7]
  v_exp_f32 v195, v195
  v_mfma_f32_16x16x32_bf16 a[36:39], v[44:47], v[152:155], a[36:39]
  v_cvt_pk_bf16_f32 v193, v194, v195
  v_mfma_f32_16x16x32_bf16 a[68:71], v[44:47], v[160:163], a[68:71]
  v_exp_f32 v200, v200
  v_mfma_f32_16x16x32_bf16 a[100:103], v[44:47], v[168:171], a[100:103]
  v_mfma_f32_16x16x32_bf16 a[132:135], v[44:47], v[176:179], a[132:135]
  v_exp_f32 v201, v201
  v_mfma_f32_16x16x32_bf16 a[8:11], v[48:51], v[144:147], a[8:11]
  ds_read_b64_tr_b16 v[44:45], v21 offset:16384
  v_cvt_pk_bf16_f32 v200, v200, v201
  v_mfma_f32_16x16x32_bf16 a[40:43], v[48:51], v[152:155], a[40:43]
  v_exp_f32 v202, v202
  v_mfma_f32_16x16x32_bf16 a[72:75], v[48:51], v[160:163], a[72:75]
  ds_read_b64_tr_b16 v[46:47], v21 offset:20480
  v_mfma_f32_16x16x32_bf16 a[104:107], v[48:51], v[168:171], a[104:107]
  v_exp_f32 v203, v203
  v_mfma_f32_16x16x32_bf16 a[136:139], v[48:51], v[176:179], a[136:139]
  ds_read_b64_tr_b16 v[48:49], v22 offset:16384
  v_cvt_pk_bf16_f32 v201, v202, v203
  s_branch K1_L1
K1_T:
  v_mfma_f32_16x16x32_bf16 a[12:15], v[52:55], v[144:147], a[12:15]
  s_waitcnt vmcnt(8)
  s_barrier
  v_exp_f32 v208, v208
  v_mfma_f32_16x16x32_bf16 a[44:47], v[52:55], v[152:155], a[44:47]
  ds_read_b64_tr_b16 v[50:51], v22 offset:53248
  v_mfma_f32_16x16x32_bf16 a[76:79], v[52:55], v[160:163], a[76:79]
  v_exp_f32 v209, v209
  v_mfma_f32_16x16x32_bf16 a[108:111], v[52:55], v[168:171], a[108:111]
  v_cvt_pk_bf16_f32 v208, v208, v209
  v_mfma_f32_16x16x32_bf16 a[140:143], v[52:55], v[176:179], a[140:143]
  v_exp_f32 v210, v210
  s_waitcnt lgkmcnt(4)
  v_mfma_f32_16x16x32_bf16 a[16:19], v[40:43], v[144:147], a[16:19]
  ds_read_b64_tr_b16 v[52:53], v23 offset:49152
  ds_read_b64_tr_b16 v[54:55], v23 offset:53248
  v_mfma_f32_16x16x32_bf16 a[48:51], v[40:43], v[152:155], a[48:51]
  v_exp_f32 v211, v211
  v_mfma_f32_16x16x32_bf16 a[80:83], v[40:43], v[160:163], a[80:83]
  v_cvt_pk_bf16_f32 v209, v210, v211
  v_mfma_f32_16x16x32_bf16 a[112:115], v[40:43], v[168:171], a[112:115]
  v_exp_f32 v188, v188
  v_mfma_f32_16x16x32_bf16 a[144:147], v[40:43], v[176:179], a[144:147]
  s_add_u32 m0, s43, 98304
  s_nop 0
  buffer_load_dwordx4 v38, s[20:23], s54 offen offset:0 nt lds
  s_waitcnt lgkmcnt(4)
  v_mfma_f32_16x16x32_bf16 a[20:23], v[44:47], v[144:147], a[20:23]
  v_exp_f32 v189, v189
  v_mfma_f32_16x16x32_bf16 a[52:55], v[44:47], v[152:155], a[52:55]
  v_cvt_pk_bf16_f32 v186, v188, v189
  v_mfma_f32_16x16x32_bf16 a[84:87], v[44:47], v[160:163], a[84:87]
  v_exp_f32 v190, v190
  v_mfma_f32_16x16x32_bf16 a[116:119], v[44:47], v[168:171], a[116:119]
  v_mfma_f32_16x16x32_bf16 a[148:151], v[44:47], v[176:179], a[148:151]
  v_exp_f32 v191, v191
  s_waitcnt lgkmcnt(2)
  v_mfma_f32_16x16x32_bf16 a[24:27], v[48:51], v[144:147], a[24:27]
  v_cvt_pk_bf16_f32 v187, v190, v191
  v_mfma_f32_16x16x32_bf16 a[56:59], v[48:51], v[152:155], a[56:59]
  v_exp_f32 v196, v196
  v_mfma_f32_16x16x32_bf16 a[88:91], v[48:51], v[160:163], a[88:91]
  buffer_load_dwordx4 v39, s[20:23], s54 offen offset:1024 nt lds
  v_mfma_f32_16x16x32_bf16 a[120:123], v[48:51], v[168:171], a[120:123]
  v_exp_f32 v197, v197
  v_mfma_f32_16x16x32_bf16 a[152:155], v[48:51], v[176:179], a[152:155]
  v_cvt_pk_bf16_f32 v194, v196, v197
  s_waitcnt lgkmcnt(0)
  v_mfma_f32_16x16x32_bf16 a[28:31], v[52:55], v[144:147], a[28:31]
  v_exp_f32 v198, v198
  v_mfma_f32_16x16x32_bf16 a[60:63], v[52:55], v[152:155], a[60:63]
  v_mfma_f32_16x16x32_bf16 a[92:95], v[52:55], v[160:163], a[92:95]
  v_exp_f32 v199, v199
  v_mfma_f32_16x16x32_bf16 a[124:127], v[52:55], v[168:171], a[124:127]
  v_cvt_pk_bf16_f32 v195, v198, v199
  v_mfma_f32_16x16x32_bf16 a[156:159], v[52:55], v[176:179], a[156:159]
  v_exp_f32 v204, v204
  v_exp_f32 v205, v205
  s_nop 0
  v_cvt_pk_bf16_f32 v202, v204, v205
  v_exp_f32 v206, v206
  ds_read_b64_tr_b16 v[40:41], v24 offset:49152
  v_exp_f32 v207, v207
  ds_read_b64_tr_b16 v[42:43], v24 offset:53248
  v_cvt_pk_bf16_f32 v203, v206, v207
  v_exp_f32 v212, v212
  ds_read_b64_tr_b16 v[44:45], v25 offset:49152
  ds_read_b64_tr_b16 v[46:47], v25 offset:53248
  v_exp_f32 v213, v213
  s_nop 0
  v_cvt_pk_bf16_f32 v210, v212, v213
  v_exp_f32 v214, v214
  ds_read_b64_tr_b16 v[48:49], v26 offset:49152
  ds_read_b64_tr_b16 v[50:51], v26 offset:53248
  v_exp_f32 v215, v215
  s_nop 0
  v_cvt_pk_bf16_f32 v211, v214, v215
  ds_read_b64_tr_b16 v[52:53], v27 offset:49152
  ds_read_b64_tr_b16 v[54:55], v27 offset:53248
  v_mfma_f32_16x16x32_bf16 v[236:239], v[56:59], v[184:187], v[236:239]
  v_mfma_f32_16x16x32_bf16 v[240:243], v[56:59], v[192:195], v[240:243]
  v_mfma_f32_16x16x32_bf16 v[244:247], v[56:59], v[200:203], v[244:247]
  v_mfma_f32_16x16x32_bf16 v[248:251], v[56:59], v[208:211], v[248:251]
  s_waitcnt lgkmcnt(6)
  v_mfma_f32_16x16x32_bf16 a[0:3], v[40:43], v[184:187], a[0:3]
  v_mfma_f32_16x16x32_bf16 a[32:35], v[40:43], v[192:195], a[32:35]
  v_mfma_f32_16x16x32_bf16 a[64:67], v[40:43], v[200:203], a[64:67]
  v_mfma_f32_16x16x32_bf16 a[96:99], v[40:43], v[208:211], a[96:99]
  ds_read_b64_tr_b16 v[40:41], v28 offset:49152
  s_waitcnt lgkmcnt(5)
  v_mfma_f32_16x16x32_bf16 a[4:7], v[44:47], v[184:187], a[4:7]
  v_mfma_f32_16x16x32_bf16 a[36:39], v[44:47], v[192:195], a[36:39]
  ds_read_b64_tr_b16 v[42:43], v28 offset:53248
  v_mfma_f32_16x16x32_bf16 a[68:71], v[44:47], v[200:203], a[68:71]
  v_mfma_f32_16x16x32_bf16 a[100:103], v[44:47], v[208:211], a[100:103]
  ds_read_b64_tr_b16 v[44:45], v29 offset:49152
  s_waitcnt lgkmcnt(5)
  v_mfma_f32_16x16x32_bf16 a[8:11], v[48:51], v[184:187], a[8:11]
  v_mfma_f32_16x16x32_bf16 a[40:43], v[48:51], v[192:195], a[40:43]
  ds_read_b64_tr_b16 v[46:47], v29 offset:53248
  v_mfma_f32_16x16x32_bf16 a[72:75], v[48:51], v[200:203], a[72:75]
  v_mfma_f32_16x16x32_bf16 a[104:107], v[48:51], v[208:211], a[104:107]
  ds_read_b64_tr_b16 v[48:49], v30 offset:49152
  s_waitcnt lgkmcnt(5)
  v_mfma_f32_16x16x32_bf16 a[12:15], v[52:55], v[184:187], a[12:15]
  v_mfma_f32_16x16x32_bf16 a[44:47], v[52:55], v[192:195], a[44:47]
  ds_read_b64_tr_b16 v[50:51], v30 offset:53248
  v_mfma_f32_16x16x32_bf16 a[76:79], v[52:55], v[200:203], a[76:79]
  v_mfma_f32_16x16x32_bf16 a[108:111], v[52:55], v[208:211], a[108:111]
  ds_read_b64_tr_b16 v[52:53], v31 offset:49152
  s_waitcnt lgkmcnt(5)
  v_mfma_f32_16x16x32_bf16 a[16:19], v[40:43], v[184:187], a[16:19]
  v_mfma_f32_16x16x32_bf16 a[48:51], v[40:43], v[192:195], a[48:51]
  ds_read_b64_tr_b16 v[54:55], v31 offset:53248
  v_mfma_f32_16x16x32_bf16 a[80:83], v[40:43], v[200:203], a[80:83]
  v_mfma_f32_16x16x32_bf16 a[112:115], v[40:43], v[208:211], a[112:115]
  s_waitcnt lgkmcnt(4)
  v_mfma_f32_16x16x32_bf16 a[20:23], v[44:47], v[184:187], a[20:23]
  v_mfma_f32_16x16x32_bf16 a[52:55], v[44:47], v[192:195], a[52:55]
  v_mfma_f32_16x16x32_bf16 a[84:87], v[44:47], v[200:203], a[84:87]
  v_mfma_f32_16x16x32_bf16 a[116:119], v[44:47], v[208:211], a[116:119]
  s_waitcnt lgkmcnt(2)
  v_mfma_f32_16x16x32_bf16 a[24:27], v[48:51], v[184:187], a[24:27]
  v_mfma_f32_16x16x32_bf16 a[56:59], v[48:51], v[192:195], a[56:59]
  v_mfma_f32_16x16x32_bf16 a[88:91], v[48:51], v[200:203], a[88:91]
  v_mfma_f32_16x16x32_bf16 a[120:123], v[48:51], v[208:211], a[120:123]
  s_waitcnt lgkmcnt(0)
  v_mfma_f32_16x16x32_bf16 a[28:31], v[52:55], v[184:187], a[28:31]
  v_mfma_f32_16x16x32_bf16 a[60:63], v[52:55], v[192:195], a[60:63]
  v_mfma_f32_16x16x32_bf16 a[92:95], v[52:55], v[200:203], a[92:95]
  v_mfma_f32_16x16x32_bf16 a[124:127], v[52:55], v[208:211], a[124:127]
  s_mov_b64 s[62:63], 0
  v_mov_b32 v60, s52
  v_cmp_nlt_f32 vcc, v236, v60
  s_nop 3
  s_or_b64 s[62:63], s[62:63], vcc
  v_cmp_nlt_f32 vcc, v240, v60
  s_nop 3
  s_or_b64 s[62:63], s[62:63], vcc
  v_cmp_nlt_f32 vcc, v244, v60
  s_nop 3
  s_or_b64 s[62:63], s[62:63], vcc
  v_cmp_nlt_f32 vcc, v248, v60
  s_nop 3
  s_or_b64 s[62:63], s[62:63], vcc
  v_cmp_nlt_f32 vcc, v252, v60
  s_nop 3
  s_or_b64 s[62:63], s[62:63], vcc
  s_cmp_lg_u64 s[62:63], 0
  s_cselect_b32 s37, 1, 0
  v_mov_b32 v61, s37
  s_lshl_b32 s38, s32, 2
  s_add_u32 s38, s38, 147456
  v_mov_b32 v62, s38
  ds_write_b32 v62, v61
  v_mov_b32 v60, v232
  v_mov_b32 v61, v252
  s_lshl_b32 s38, s32, 9
  s_add_u32 s38, s38, 147712
  v_lshlrev_b32 v62, 3, v2
  v_add_u32 v62, s38, v62
  ds_write_b64 v62, v[60:61]
  s_xor_b32 s38, s38, 512
  v_lshlrev_b32 v63, 3, v2
  v_add_u32 v63, s38, v63
  s_lshl_b32 s38, s32, 12
  s_add_u32 s38, s38, 131072
  v_add_u32 v32, s38, v7
  s_xor_b32 s38, s38, 4096
  v_add_u32 v33, s38, v7
  s_cmp_eq_u32 s33, 1
  s_cbranch_scc1 K1_E1
  ds_write_b128 v32, a[144:147] offset:0
  ds_write_b128 v32, a[148:151] offset:1024
  ds_write_b128 v32, a[152:155] offset:2048
  ds_write_b128 v32, a[156:159] offset:3072
  v_rcp_f32 v218, v236
  v_rcp_f32 v222, v240
  v_rcp_f32 v226, v244
  v_rcp_f32 v230, v248
  v_accvgpr_read_b32 v40, a0
  v_accvgpr_read_b32 v41, a1
  v_accvgpr_read_b32 v42, a2
  v_accvgpr_read_b32 v43, a3
  v_accvgpr_read_b32 v44, a4
  v_accvgpr_read_b32 v45, a5
  v_accvgpr_read_b32 v46, a6
  v_accvgpr_read_b32 v47, a7
  v_pk_mul_f32 v[40:41], v[40:41], v[218:219] op_sel_hi:[1,0]
  v_pk_mul_f32 v[42:43], v[42:43], v[218:219] op_sel_hi:[1,0]
  v_pk_mul_f32 v[44:45], v[44:45], v[218:219] op_sel_hi:[1,0]
  v_pk_mul_f32 v[46:47], v[46:47], v[218:219] op_sel_hi:[1,0]
  v_cvt_pk_bf16_f32 v144, v40, v41
  v_cvt_pk_bf16_f32 v145, v42, v43
  v_cvt_pk_bf16_f32 v146, v44, v45
  v_cvt_pk_bf16_f32 v147, v46, v47
  v_accvgpr_read_b32 v48, a8
  v_accvgpr_read_b32 v49, a9
  v_accvgpr_read_b32 v50, a10
  v_accvgpr_read_b32 v51, a11
  v_accvgpr_read_b32 v52, a12
  v_accvgpr_read_b32 v53, a13
  v_accvgpr_read_b32 v54, a14
  v_accvgpr_read_b32 v55, a15
  v_pk_mul_f32 v[48:49], v[48:49], v[218:219] op_sel_hi:[1,0]
  v_pk_mul_f32 v[50:51], v[50:51], v[218:219] op_sel_hi:[1,0]
  v_pk_mul_f32 v[52:53], v[52:53], v[218:219] op_sel_hi:[1,0]
  v_pk_mul_f32 v[54:55], v[54:55], v[218:219] op_sel_hi:[1,0]
  v_cvt_pk_bf16_f32 v148, v48, v49
  v_cvt_pk_bf16_f32 v149, v50, v51
  v_cvt_pk_bf16_f32 v150, v52, v53
  v_cvt_pk_bf16_f32 v151, v54, v55
  v_accvgpr_read_b32 v40, a16
  v_accvgpr_read_b32 v41, a17
  v_accvgpr_read_b32 v42, a18
  v_accvgpr_read_b32 v43, a19
  v_accvgpr_read_b32 v44, a20
  v_accvgpr_read_b32 v45, a21
  v_accvgpr_read_b32 v46, a22
  v_accvgpr_read_b32 v47, a23
  v_pk_mul_f32 v[40:41], v[40:41], v[218:219] op_sel_hi:[1,0]
  v_pk_mul_f32 v[42:43], v[42:43], v[218:219] op_sel_hi:[1,0]
  v_pk_mul_f32 v[44:45], v[44:45], v[218:219] op_sel_hi:[1,0]
  v_pk_mul_f32 v[46:47], v[46:47], v[218:219] op_sel_hi:[1,0]
  v_cvt_pk_bf16_f32 v152, v40, v41
  v_cvt_pk_bf16_f32 v153, v42, v43
  v_cvt_pk_bf16_f32 v154, v44, v45
  v_cvt_pk_bf16_f32 v155, v46, v47
  v_accvgpr_read_b32 v48, a24
  v_accvgpr_read_b32 v49, a25
  v_accvgpr_read_b32 v50, a26
  v_accvgpr_read_b32 v51, a27
  v_accvgpr_read_b32 v52, a28
  v_accvgpr_read_b32 v53, a29
  v_accvgpr_read_b32 v54, a30
  v_accvgpr_read_b32 v55, a31
  v_pk_mul_f32 v[48:49], v[48:49], v[218:219] op_sel_hi:[1,0]
  v_pk_mul_f32 v[50:51], v[50:51], v[218:219] op_sel_hi:[1,0]
  v_pk_mul_f32 v[52:53], v[52:53], v[218:219] op_sel_hi:[1,0]
  v_pk_mul_f32 v[54:55], v[54:55], v[218:219] op_sel_hi:[1,0]
  v_cvt_pk_bf16_f32 v156, v48, v49
  v_cvt_pk_bf16_f32 v157, v50, v51
  v_cvt_pk_bf16_f32 v158, v52, v53
  v_cvt_pk_bf16_f32 v159, v54, v55
  v_accvgpr_read_b32 v40, a32
  v_accvgpr_read_b32 v41, a33
  v_accvgpr_read_b32 v42, a34
  v_accvgpr_read_b32 v43, a35
  v_accvgpr_read_b32 v44, a36
  v_accvgpr_read_b32 v45, a37
  v_accvgpr_read_b32 v46, a38
  v_accvgpr_read_b32 v47, a39
  v_pk_mul_f32 v[40:41], v[40:41], v[222:223] op_sel_hi:[1,0]
  v_pk_mul_f32 v[42:43], v[42:43], v[222:223] op_sel_hi:[1,0]
  v_pk_mul_f32 v[44:45], v[44:45], v[222:223] op_sel_hi:[1,0]
  v_pk_mul_f32 v[46:47], v[46:47], v[222:223] op_sel_hi:[1,0]
  v_cvt_pk_bf16_f32 v160, v40, v41
  v_cvt_pk_bf16_f32 v161, v42, v43
  v_cvt_pk_bf16_f32 v162, v44, v45
  v_cvt_pk_bf16_f32 v163, v46, v47
  v_accvgpr_read_b32 v48, a40
  v_accvgpr_read_b32 v49, a41
  v_accvgpr_read_b32 v50, a42
  v_accvgpr_read_b32 v51, a43
  v_accvgpr_read_b32 v52, a44
  v_accvgpr_read_b32 v53, a45
  v_accvgpr_read_b32 v54, a46
  v_accvgpr_read_b32 v55, a47
  v_pk_mul_f32 v[48:49], v[48:49], v[222:223] op_sel_hi:[1,0]
  v_pk_mul_f32 v[50:51], v[50:51], v[222:223] op_sel_hi:[1,0]
  v_pk_mul_f32 v[52:53], v[52:53], v[222:223] op_sel_hi:[1,0]
  v_pk_mul_f32 v[54:55], v[54:55], v[222:223] op_sel_hi:[1,0]
  v_cvt_pk_bf16_f32 v164, v48, v49
  v_cvt_pk_bf16_f32 v165, v50, v51
  v_cvt_pk_bf16_f32 v166, v52, v53
  v_cvt_pk_bf16_f32 v167, v54, v55
  v_accvgpr_read_b32 v40, a48
  v_accvgpr_read_b32 v41, a49
  v_accvgpr_read_b32 v42, a50
  v_accvgpr_read_b32 v43, a51
  v_accvgpr_read_b32 v44, a52
  v_accvgpr_read_b32 v45, a53
  v_accvgpr_read_b32 v46, a54
  v_accvgpr_read_b32 v47, a55
  v_pk_mul_f32 v[40:41], v[40:41], v[222:223] op_sel_hi:[1,0]
  v_pk_mul_f32 v[42:43], v[42:43], v[222:223] op_sel_hi:[1,0]
  v_pk_mul_f32 v[44:45], v[44:45], v[222:223] op_sel_hi:[1,0]
  v_pk_mul_f32 v[46:47], v[46:47], v[222:223] op_sel_hi:[1,0]
  v_cvt_pk_bf16_f32 v168, v40, v41
  v_cvt_pk_bf16_f32 v169, v42, v43
  v_cvt_pk_bf16_f32 v170, v44, v45
  v_cvt_pk_bf16_f32 v171, v46, v47
  v_accvgpr_read_b32 v48, a56
  v_accvgpr_read_b32 v49, a57
  v_accvgpr_read_b32 v50, a58
  v_accvgpr_read_b32 v51, a59
  v_accvgpr_read_b32 v52, a60
  v_accvgpr_read_b32 v53, a61
  v_accvgpr_read_b32 v54, a62
  v_accvgpr_read_b32 v55, a63
  v_pk_mul_f32 v[48:49], v[48:49], v[222:223] op_sel_hi:[1,0]
  v_pk_mul_f32 v[50:51], v[50:51], v[222:223] op_sel_hi:[1,0]
  v_pk_mul_f32 v[52:53], v[52:53], v[222:223] op_sel_hi:[1,0]
  v_pk_mul_f32 v[54:55], v[54:55], v[222:223] op_sel_hi:[1,0]
  v_cvt_pk_bf16_f32 v172, v48, v49
  v_cvt_pk_bf16_f32 v173, v50, v51
  v_cvt_pk_bf16_f32 v174, v52, v53
  v_cvt_pk_bf16_f32 v175, v54, v55
  v_accvgpr_read_b32 v40, a64
  v_accvgpr_read_b32 v41, a65
  v_accvgpr_read_b32 v42, a66
  v_accvgpr_read_b32 v43, a67
  v_accvgpr_read_b32 v44, a68
  v_accvgpr_read_b32 v45, a69
  v_accvgpr_read_b32 v46, a70
  v_accvgpr_read_b32 v47, a71
  v_pk_mul_f32 v[40:41], v[40:41], v[226:227] op_sel_hi:[1,0]
  v_pk_mul_f32 v[42:43], v[42:43], v[226:227] op_sel_hi:[1,0]
  v_pk_mul_f32 v[44:45], v[44:45], v[226:227] op_sel_hi:[1,0]
  v_pk_mul_f32 v[46:47], v[46:47], v[226:227] op_sel_hi:[1,0]
  v_cvt_pk_bf16_f32 v176, v40, v41
  v_cvt_pk_bf16_f32 v177, v42, v43
  v_cvt_pk_bf16_f32 v178, v44, v45
  v_cvt_pk_bf16_f32 v179, v46, v47
  v_accvgpr_read_b32 v48, a72
  v_accvgpr_read_b32 v49, a73
  v_accvgpr_read_b32 v50, a74
  v_accvgpr_read_b32 v51, a75
  v_accvgpr_read_b32 v52, a76
  v_accvgpr_read_b32 v53, a77
  v_accvgpr_read_b32 v54, a78
  v_accvgpr_read_b32 v55, a79
  v_pk_mul_f32 v[48:49], v[48:49], v[226:227] op_sel_hi:[1,0]
  v_pk_mul_f32 v[50:51], v[50:51], v[226:227] op_sel_hi:[1,0]
  v_pk_mul_f32 v[52:53], v[52:53], v[226:227] op_sel_hi:[1,0]
  v_pk_mul_f32 v[54:55], v[54:55], v[226:227] op_sel_hi:[1,0]
  v_cvt_pk_bf16_f32 v180, v48, v49
  v_cvt_pk_bf16_f32 v181, v50, v51
  v_cvt_pk_bf16_f32 v182, v52, v53
  v_cvt_pk_bf16_f32 v183, v54, v55
  v_accvgpr_read_b32 v40, a80
  v_accvgpr_read_b32 v41, a81
  v_accvgpr_read_b32 v42, a82
  v_accvgpr_read_b32 v43, a83
  v_accvgpr_read_b32 v44, a84
  v_accvgpr_read_b32 v45, a85
  v_accvgpr_read_b32 v46, a86
  v_accvgpr_read_b32 v47, a87
  v_pk_mul_f32 v[40:41], v[40:41], v[226:227] op_sel_hi:[1,0]
  v_pk_mul_f32 v[42:43], v[42:43], v[226:227] op_sel_hi:[1,0]
  v_pk_mul_f32 v[44:45], v[44:45], v[226:227] op_sel_hi:[1,0]
  v_pk_mul_f32 v[46:47], v[46:47], v[226:227] op_sel_hi:[1,0]
  v_cvt_pk_bf16_f32 v184, v40, v41
  v_cvt_pk_bf16_f32 v185, v42, v43
  v_cvt_pk_bf16_f32 v186, v44, v45
  v_cvt_pk_bf16_f32 v187, v46, v47
  v_accvgpr_read_b32 v48, a88
  v_accvgpr_read_b32 v49, a89
  v_accvgpr_read_b32 v50, a90
  v_accvgpr_read_b32 v51, a91
  v_accvgpr_read_b32 v52, a92
  v_accvgpr_read_b32 v53, a93
  v_accvgpr_read_b32 v54, a94
  v_accvgpr_read_b32 v55, a95
  v_pk_mul_f32 v[48:49], v[48:49], v[226:227] op_sel_hi:[1,0]
  v_pk_mul_f32 v[50:51], v[50:51], v[226:227] op_sel_hi:[1,0]
  v_pk_mul_f32 v[52:53], v[52:53], v[226:227] op_sel_hi:[1,0]
  v_pk_mul_f32 v[54:55], v[54:55], v[226:227] op_sel_hi:[1,0]
  v_cvt_pk_bf16_f32 v188, v48, v49
  v_cvt_pk_bf16_f32 v189, v50, v51
  v_cvt_pk_bf16_f32 v190, v52, v53
  v_cvt_pk_bf16_f32 v191, v54, v55
  v_accvgpr_read_b32 v40, a96
  v_accvgpr_read_b32 v41, a97
  v_accvgpr_read_b32 v42, a98
  v_accvgpr_read_b32 v43, a99
  v_accvgpr_read_b32 v44, a100
  v_accvgpr_read_b32 v45, a101
  v_accvgpr_read_b32 v46, a102
  v_accvgpr_read_b32 v47, a103
  v_pk_mul_f32 v[40:41], v[40:41], v[230:231] op_sel_hi:[1,0]
  v_pk_mul_f32 v[42:43], v[42:43], v[230:231] op_sel_hi:[1,0]
  v_pk_mul_f32 v[44:45], v[44:45], v[230:231] op_sel_hi:[1,0]
  v_pk_mul_f32 v[46:47], v[46:47], v[230:231] op_sel_hi:[1,0]
  v_cvt_pk_bf16_f32 v192, v40, v41
  v_cvt_pk_bf16_f32 v193, v42, v43
  v_cvt_pk_bf16_f32 v194, v44, v45
  v_cvt_pk_bf16_f32 v195, v46, v47
  v_accvgpr_read_b32 v48, a104
  v_accvgpr_read_b32 v49, a105
  v_accvgpr_read_b32 v50, a106
  v_accvgpr_read_b32 v51, a107
  v_accvgpr_read_b32 v52, a108
  v_accvgpr_read_b32 v53, a109
  v_accvgpr_read_b32 v54, a110
  v_accvgpr_read_b32 v55, a111
  v_pk_mul_f32 v[48:49], v[48:49], v[230:231] op_sel_hi:[1,0]
  v_pk_mul_f32 v[50:51], v[50:51], v[230:231] op_sel_hi:[1,0]
  v_pk_mul_f32 v[52:53], v[52:53], v[230:231] op_sel_hi:[1,0]
  v_pk_mul_f32 v[54:55], v[54:55], v[230:231] op_sel_hi:[1,0]
  v_cvt_pk_bf16_f32 v196, v48, v49
  v_cvt_pk_bf16_f32 v197, v50, v51
  v_cvt_pk_bf16_f32 v198, v52, v53
  v_cvt_pk_bf16_f32 v199, v54, v55
  v_accvgpr_read_b32 v40, a112
  v_accvgpr_read_b32 v41, a113
  v_accvgpr_read_b32 v42, a114
  v_accvgpr_read_b32 v43, a115
  v_accvgpr_read_b32 v44, a116
  v_accvgpr_read_b32 v45, a117
  v_accvgpr_read_b32 v46, a118
  v_accvgpr_read_b32 v47, a119
  v_pk_mul_f32 v[40:41], v[40:41], v[230:231] op_sel_hi:[1,0]
  v_pk_mul_f32 v[42:43], v[42:43], v[230:231] op_sel_hi:[1,0]
  v_pk_mul_f32 v[44:45], v[44:45], v[230:231] op_sel_hi:[1,0]
  v_pk_mul_f32 v[46:47], v[46:47], v[230:231] op_sel_hi:[1,0]
  v_cvt_pk_bf16_f32 v200, v40, v41
  v_cvt_pk_bf16_f32 v201, v42, v43
  v_cvt_pk_bf16_f32 v202, v44, v45
  v_cvt_pk_bf16_f32 v203, v46, v47
  v_accvgpr_read_b32 v48, a120
  v_accvgpr_read_b32 v49, a121
  v_accvgpr_read_b32 v50, a122
  v_accvgpr_read_b32 v51, a123
  v_accvgpr_read_b32 v52, a124
  v_accvgpr_read_b32 v53, a125
  v_accvgpr_read_b32 v54, a126
  v_accvgpr_read_b32 v55, a127
  v_pk_mul_f32 v[48:49], v[48:49], v[230:231] op_sel_hi:[1,0]
  v_pk_mul_f32 v[50:51], v[50:51], v[230:231] op_sel_hi:[1,0]
  v_pk_mul_f32 v[52:53], v[52:53], v[230:231] op_sel_hi:[1,0]
  v_pk_mul_f32 v[54:55], v[54:55], v[230:231] op_sel_hi:[1,0]
  v_cvt_pk_bf16_f32 v204, v48, v49
  v_cvt_pk_bf16_f32 v205, v50, v51
  v_cvt_pk_bf16_f32 v206, v52, v53
  v_cvt_pk_bf16_f32 v207, v54, v55
  s_waitcnt lgkmcnt(0)
  s_barrier
  ds_read_b128 v[236:239], v33 offset:0
  ds_read_b128 v[240:243], v33 offset:1024
  ds_read_b128 v[244:247], v33 offset:2048
  ds_read_b128 v[248:251], v33 offset:3072
  ds_read_b64 v[60:61], v63
  v_mov_b32 v62, 147456
  ds_read_b128 v[40:43], v62
  s_waitcnt lgkmcnt(0)
  v_or_b32 v40, v40, v41
  v_or_b32 v42, v42, v43
  v_or_b32 v40, v40, v42
  s_nop 0
  v_readfirstlane_b32 s37, v40
  s_nop 3
  s_andn2_b32 s37, s37, s49
  s_cmp_lg_u32 s37, 0
  s_cbranch_scc1 K1_FB
  v_min_f32 v62, v60, v232
  v_sub_f32 v63, v62, v232
  v_sub_f32 v62, v62, v60
  v_exp_f32 v63, v63
  v_exp_f32 v62, v62
  s_nop 0
  v_mul_f32 v61, v61, v62
  v_fma_f32 v61, v252, v63, v61
  v_rcp_f32 v61, v61
  s_nop 0
  v_mul_f32 v63, v63, v61
  v_mul_f32 v62, v62, v61
  v_accvgpr_read_b32 v40, a128
  v_accvgpr_read_b32 v41, a129
  v_accvgpr_read_b32 v42, a130
  v_accvgpr_read_b32 v43, a131
  v_accvgpr_read_b32 v44, a132
  v_accvgpr_read_b32 v45, a133
  v_accvgpr_read_b32 v46, a134
  v_accvgpr_read_b32 v47, a135
  v_mul_f32 v40, v63, v40
  v_mul_f32 v41, v63, v41
  v_mul_f32 v42, v63, v42
  v_mul_f32 v43, v63, v43
  v_mul_f32 v44, v63, v44
  v_mul_f32 v45, v63, v45
  v_mul_f32 v46, v63, v46
  v_mul_f32 v47, v63, v47
  v_fma_f32 v40, v236, v62, v40
  v_fma_f32 v41, v237, v62, v41
  v_fma_f32 v42, v238, v62, v42
  v_fma_f32 v43, v239, v62, v43
  v_fma_f32 v44, v240, v62, v44
  v_fma_f32 v45, v241, v62, v45
  v_fma_f32 v46, v242, v62, v46
  v_fma_f32 v47, v243, v62, v47
  v_cvt_pk_bf16_f32 v208, v40, v41
  v_cvt_pk_bf16_f32 v209, v42, v43
  v_cvt_pk_bf16_f32 v210, v44, v45
  v_cvt_pk_bf16_f32 v211, v46, v47
  v_accvgpr_read_b32 v48, a136
  v_accvgpr_read_b32 v49, a137
  v_accvgpr_read_b32 v50, a138
  v_accvgpr_read_b32 v51, a139
  v_accvgpr_read_b32 v52, a140
  v_accvgpr_read_b32 v53, a141
  v_accvgpr_read_b32 v54, a142
  v_accvgpr_read_b32 v55, a143
  v_mul_f32 v48, v63, v48
  v_mul_f32 v49, v63, v49
  v_mul_f32 v50, v63, v50
  v_mul_f32 v51, v63, v51
  v_mul_f32 v52, v63, v52
  v_mul_f32 v53, v63, v53
  v_mul_f32 v54, v63, v54
  v_mul_f32 v55, v63, v55
  v_fma_f32 v48, v244, v62, v48
  v_fma_f32 v49, v245, v62, v49
  v_fma_f32 v50, v246, v62, v50
  v_fma_f32 v51, v247, v62, v51
  v_fma_f32 v52, v248, v62, v52
  v_fma_f32 v53, v249, v62, v53
  v_fma_f32 v54, v250, v62, v54
  v_fma_f32 v55, v251, v62, v55
  v_cvt_pk_bf16_f32 v212, v48, v49
  v_cvt_pk_bf16_f32 v213, v50, v51
  v_cvt_pk_bf16_f32 v214, v52, v53
  v_cvt_pk_bf16_f32 v215, v54, v55
  s_branch K1_N
K1_E1:
  ds_write_b128 v32, a[128:131] offset:0
  ds_write_b128 v32, a[132:135] offset:1024
  ds_write_b128 v32, a[136:139] offset:2048
  ds_write_b128 v32, a[140:143] offset:3072
  v_rcp_f32 v218, v236
  v_rcp_f32 v222, v240
  v_rcp_f32 v226, v244
  v_rcp_f32 v230, v248
  v_accvgpr_read_b32 v40, a0
  v_accvgpr_read_b32 v41, a1
  v_accvgpr_read_b32 v42, a2
  v_accvgpr_read_b32 v43, a3
  v_accvgpr_read_b32 v44, a4
  v_accvgpr_read_b32 v45, a5
  v_accvgpr_read_b32 v46, a6
  v_accvgpr_read_b32 v47, a7
  v_pk_mul_f32 v[40:41], v[40:41], v[218:219] op_sel_hi:[1,0]
  v_pk_mul_f32 v[42:43], v[42:43], v[218:219] op_sel_hi:[1,0]
  v_pk_mul_f32 v[44:45], v[44:45], v[218:219] op_sel_hi:[1,0]
  v_pk_mul_f32 v[46:47], v[46:47], v[218:219] op_sel_hi:[1,0]
  v_cvt_pk_bf16_f32 v144, v40, v41
  v_cvt_pk_bf16_f32 v145, v42, v43
  v_cvt_pk_bf16_f32 v146, v44, v45
  v_cvt_pk_bf16_f32 v147, v46, v47
  v_accvgpr_read_b32 v48, a8
  v_accvgpr_read_b32 v49, a9
  v_accvgpr_read_b32 v50, a10
  v_accvgpr_read_b32 v51, a11
  v_accvgpr_read_b32 v52, a12
  v_accvgpr_read_b32 v53, a13
  v_accvgpr_read_b32 v54, a14
  v_accvgpr_read_b32 v55, a15
  v_pk_mul_f32 v[48:49], v[48:49], v[218:219] op_sel_hi:[1,0]
  v_pk_mul_f32 v[50:51], v[50:51], v[218:219] op_sel_hi:[1,0]
  v_pk_mul_f32 v[52:53], v[52:53], v[218:219] op_sel_hi:[1,0]
  v_pk_mul_f32 v[54:55], v[54:55], v[218:219] op_sel_hi:[1,0]
  v_cvt_pk_bf16_f32 v148, v48, v49
  v_cvt_pk_bf16_f32 v149, v50, v51
  v_cvt_pk_bf16_f32 v150, v52, v53
  v_cvt_pk_bf16_f32 v151, v54, v55
  v_accvgpr_read_b32 v40, a16
  v_accvgpr_read_b32 v41, a17
  v_accvgpr_read_b32 v42, a18
  v_accvgpr_read_b32 v43, a19
  v_accvgpr_read_b32 v44, a20
  v_accvgpr_read_b32 v45, a21
  v_accvgpr_read_b32 v46, a22
  v_accvgpr_read_b32 v47, a23
  v_pk_mul_f32 v[40:41], v[40:41], v[218:219] op_sel_hi:[1,0]
  v_pk_mul_f32 v[42:43], v[42:43], v[218:219] op_sel_hi:[1,0]
  v_pk_mul_f32 v[44:45], v[44:45], v[218:219] op_sel_hi:[1,0]
  v_pk_mul_f32 v[46:47], v[46:47], v[218:219] op_sel_hi:[1,0]
  v_cvt_pk_bf16_f32 v152, v40, v41
  v_cvt_pk_bf16_f32 v153, v42, v43
  v_cvt_pk_bf16_f32 v154, v44, v45
  v_cvt_pk_bf16_f32 v155, v46, v47
  v_accvgpr_read_b32 v48, a24
  v_accvgpr_read_b32 v49, a25
  v_accvgpr_read_b32 v50, a26
  v_accvgpr_read_b32 v51, a27
  v_accvgpr_read_b32 v52, a28
  v_accvgpr_read_b32 v53, a29
  v_accvgpr_read_b32 v54, a30
  v_accvgpr_read_b32 v55, a31
  v_pk_mul_f32 v[48:49], v[48:49], v[218:219] op_sel_hi:[1,0]
  v_pk_mul_f32 v[50:51], v[50:51], v[218:219] op_sel_hi:[1,0]
  v_pk_mul_f32 v[52:53], v[52:53], v[218:219] op_sel_hi:[1,0]
  v_pk_mul_f32 v[54:55], v[54:55], v[218:219] op_sel_hi:[1,0]
  v_cvt_pk_bf16_f32 v156, v48, v49
  v_cvt_pk_bf16_f32 v157, v50, v51
  v_cvt_pk_bf16_f32 v158, v52, v53
  v_cvt_pk_bf16_f32 v159, v54, v55
  v_accvgpr_read_b32 v40, a32
  v_accvgpr_read_b32 v41, a33
  v_accvgpr_read_b32 v42, a34
  v_accvgpr_read_b32 v43, a35
  v_accvgpr_read_b32 v44, a36
  v_accvgpr_read_b32 v45, a37
  v_accvgpr_read_b32 v46, a38
  v_accvgpr_read_b32 v47, a39
  v_pk_mul_f32 v[40:41], v[40:41], v[222:223] op_sel_hi:[1,0]
  v_pk_mul_f32 v[42:43], v[42:43], v[222:223] op_sel_hi:[1,0]
  v_pk_mul_f32 v[44:45], v[44:45], v[222:223] op_sel_hi:[1,0]
  v_pk_mul_f32 v[46:47], v[46:47], v[222:223] op_sel_hi:[1,0]
  v_cvt_pk_bf16_f32 v160, v40, v41
  v_cvt_pk_bf16_f32 v161, v42, v43
  v_cvt_pk_bf16_f32 v162, v44, v45
  v_cvt_pk_bf16_f32 v163, v46, v47
  v_accvgpr_read_b32 v48, a40
  v_accvgpr_read_b32 v49, a41
  v_accvgpr_read_b32 v50, a42
  v_accvgpr_read_b32 v51, a43
  v_accvgpr_read_b32 v52, a44
  v_accvgpr_read_b32 v53, a45
  v_accvgpr_read_b32 v54, a46
  v_accvgpr_read_b32 v55, a47
  v_pk_mul_f32 v[48:49], v[48:49], v[222:223] op_sel_hi:[1,0]
  v_pk_mul_f32 v[50:51], v[50:51], v[222:223] op_sel_hi:[1,0]
  v_pk_mul_f32 v[52:53], v[52:53], v[222:223] op_sel_hi:[1,0]
  v_pk_mul_f32 v[54:55], v[54:55], v[222:223] op_sel_hi:[1,0]
  v_cvt_pk_bf16_f32 v164, v48, v49
  v_cvt_pk_bf16_f32 v165, v50, v51
  v_cvt_pk_bf16_f32 v166, v52, v53
  v_cvt_pk_bf16_f32 v167, v54, v55
  v_accvgpr_read_b32 v40, a48
  v_accvgpr_read_b32 v41, a49
  v_accvgpr_read_b32 v42, a50
  v_accvgpr_read_b32 v43, a51
  v_accvgpr_read_b32 v44, a52
  v_accvgpr_read_b32 v45, a53
  v_accvgpr_read_b32 v46, a54
  v_accvgpr_read_b32 v47, a55
  v_pk_mul_f32 v[40:41], v[40:41], v[222:223] op_sel_hi:[1,0]
  v_pk_mul_f32 v[42:43], v[42:43], v[222:223] op_sel_hi:[1,0]
  v_pk_mul_f32 v[44:45], v[44:45], v[222:223] op_sel_hi:[1,0]
  v_pk_mul_f32 v[46:47], v[46:47], v[222:223] op_sel_hi:[1,0]
  v_cvt_pk_bf16_f32 v168, v40, v41
  v_cvt_pk_bf16_f32 v169, v42, v43
  v_cvt_pk_bf16_f32 v170, v44, v45
  v_cvt_pk_bf16_f32 v171, v46, v47
  v_accvgpr_read_b32 v48, a56
  v_accvgpr_read_b32 v49, a57
  v_accvgpr_read_b32 v50, a58
  v_accvgpr_read_b32 v51, a59
  v_accvgpr_read_b32 v52, a60
  v_accvgpr_read_b32 v53, a61
  v_accvgpr_read_b32 v54, a62
  v_accvgpr_read_b32 v55, a63
  v_pk_mul_f32 v[48:49], v[48:49], v[222:223] op_sel_hi:[1,0]
  v_pk_mul_f32 v[50:51], v[50:51], v[222:223] op_sel_hi:[1,0]
  v_pk_mul_f32 v[52:53], v[52:53], v[222:223] op_sel_hi:[1,0]
  v_pk_mul_f32 v[54:55], v[54:55], v[222:223] op_sel_hi:[1,0]
  v_cvt_pk_bf16_f32 v172, v48, v49
  v_cvt_pk_bf16_f32 v173, v50, v51
  v_cvt_pk_bf16_f32 v174, v52, v53
  v_cvt_pk_bf16_f32 v175, v54, v55
  v_accvgpr_read_b32 v40, a64
  v_accvgpr_read_b32 v41, a65
  v_accvgpr_read_b32 v42, a66
  v_accvgpr_read_b32 v43, a67
  v_accvgpr_read_b32 v44, a68
  v_accvgpr_read_b32 v45, a69
  v_accvgpr_read_b32 v46, a70
  v_accvgpr_read_b32 v47, a71
  v_pk_mul_f32 v[40:41], v[40:41], v[226:227] op_sel_hi:[1,0]
  v_pk_mul_f32 v[42:43], v[42:43], v[226:227] op_sel_hi:[1,0]
  v_pk_mul_f32 v[44:45], v[44:45], v[226:227] op_sel_hi:[1,0]
  v_pk_mul_f32 v[46:47], v[46:47], v[226:227] op_sel_hi:[1,0]
  v_cvt_pk_bf16_f32 v176, v40, v41
  v_cvt_pk_bf16_f32 v177, v42, v43
  v_cvt_pk_bf16_f32 v178, v44, v45
  v_cvt_pk_bf16_f32 v179, v46, v47
  v_accvgpr_read_b32 v48, a72
  v_accvgpr_read_b32 v49, a73
  v_accvgpr_read_b32 v50, a74
  v_accvgpr_read_b32 v51, a75
  v_accvgpr_read_b32 v52, a76
  v_accvgpr_read_b32 v53, a77
  v_accvgpr_read_b32 v54, a78
  v_accvgpr_read_b32 v55, a79
  v_pk_mul_f32 v[48:49], v[48:49], v[226:227] op_sel_hi:[1,0]
  v_pk_mul_f32 v[50:51], v[50:51], v[226:227] op_sel_hi:[1,0]
  v_pk_mul_f32 v[52:53], v[52:53], v[226:227] op_sel_hi:[1,0]
  v_pk_mul_f32 v[54:55], v[54:55], v[226:227] op_sel_hi:[1,0]
  v_cvt_pk_bf16_f32 v180, v48, v49
  v_cvt_pk_bf16_f32 v181, v50, v51
  v_cvt_pk_bf16_f32 v182, v52, v53
  v_cvt_pk_bf16_f32 v183, v54, v55
  v_accvgpr_read_b32 v40, a80
  v_accvgpr_read_b32 v41, a81
  v_accvgpr_read_b32 v42, a82
  v_accvgpr_read_b32 v43, a83
  v_accvgpr_read_b32 v44, a84
  v_accvgpr_read_b32 v45, a85
  v_accvgpr_read_b32 v46, a86
  v_accvgpr_read_b32 v47, a87
  v_pk_mul_f32 v[40:41], v[40:41], v[226:227] op_sel_hi:[1,0]
  v_pk_mul_f32 v[42:43], v[42:43], v[226:227] op_sel_hi:[1,0]
  v_pk_mul_f32 v[44:45], v[44:45], v[226:227] op_sel_hi:[1,0]
  v_pk_mul_f32 v[46:47], v[46:47], v[226:227] op_sel_hi:[1,0]
  v_cvt_pk_bf16_f32 v184, v40, v41
  v_cvt_pk_bf16_f32 v185, v42, v43
  v_cvt_pk_bf16_f32 v186, v44, v45
  v_cvt_pk_bf16_f32 v187, v46, v47
  v_accvgpr_read_b32 v48, a88
  v_accvgpr_read_b32 v49, a89
  v_accvgpr_read_b32 v50, a90
  v_accvgpr_read_b32 v51, a91
  v_accvgpr_read_b32 v52, a92
  v_accvgpr_read_b32 v53, a93
  v_accvgpr_read_b32 v54, a94
  v_accvgpr_read_b32 v55, a95
  v_pk_mul_f32 v[48:49], v[48:49], v[226:227] op_sel_hi:[1,0]
  v_pk_mul_f32 v[50:51], v[50:51], v[226:227] op_sel_hi:[1,0]
  v_pk_mul_f32 v[52:53], v[52:53], v[226:227] op_sel_hi:[1,0]
  v_pk_mul_f32 v[54:55], v[54:55], v[226:227] op_sel_hi:[1,0]
  v_cvt_pk_bf16_f32 v188, v48, v49
  v_cvt_pk_bf16_f32 v189, v50, v51
  v_cvt_pk_bf16_f32 v190, v52, v53
  v_cvt_pk_bf16_f32 v191, v54, v55
  v_accvgpr_read_b32 v40, a96
  v_accvgpr_read_b32 v41, a97
  v_accvgpr_read_b32 v42, a98
  v_accvgpr_read_b32 v43, a99
  v_accvgpr_read_b32 v44, a100
  v_accvgpr_read_b32 v45, a101
  v_accvgpr_read_b32 v46, a102
  v_accvgpr_read_b32 v47, a103
  v_pk_mul_f32 v[40:41], v[40:41], v[230:231] op_sel_hi:[1,0]
  v_pk_mul_f32 v[42:43], v[42:43], v[230:231] op_sel_hi:[1,0]
  v_pk_mul_f32 v[44:45], v[44:45], v[230:231] op_sel_hi:[1,0]
  v_pk_mul_f32 v[46:47], v[46:47], v[230:231] op_sel_hi:[1,0]
  v_cvt_pk_bf16_f32 v192, v40, v41
  v_cvt_pk_bf16_f32 v193, v42, v43
  v_cvt_pk_bf16_f32 v194, v44, v45
  v_cvt_pk_bf16_f32 v195, v46, v47
  v_accvgpr_read_b32 v48, a104
  v_accvgpr_read_b32 v49, a105
  v_accvgpr_read_b32 v50, a106
  v_accvgpr_read_b32 v51, a107
  v_accvgpr_read_b32 v52, a108
  v_accvgpr_read_b32 v53, a109
  v_accvgpr_read_b32 v54, a110
  v_accvgpr_read_b32 v55, a111
  v_pk_mul_f32 v[48:49], v[48:49], v[230:231] op_sel_hi:[1,0]
  v_pk_mul_f32 v[50:51], v[50:51], v[230:231] op_sel_hi:[1,0]
  v_pk_mul_f32 v[52:53], v[52:53], v[230:231] op_sel_hi:[1,0]
  v_pk_mul_f32 v[54:55], v[54:55], v[230:231] op_sel_hi:[1,0]
  v_cvt_pk_bf16_f32 v196, v48, v49
  v_cvt_pk_bf16_f32 v197, v50, v51
  v_cvt_pk_bf16_f32 v198, v52, v53
  v_cvt_pk_bf16_f32 v199, v54, v55
  v_accvgpr_read_b32 v40, a112
  v_accvgpr_read_b32 v41, a113
  v_accvgpr_read_b32 v42, a114
  v_accvgpr_read_b32 v43, a115
  v_accvgpr_read_b32 v44, a116
  v_accvgpr_read_b32 v45, a117
  v_accvgpr_read_b32 v46, a118
  v_accvgpr_read_b32 v47, a119
  v_pk_mul_f32 v[40:41], v[40:41], v[230:231] op_sel_hi:[1,0]
  v_pk_mul_f32 v[42:43], v[42:43], v[230:231] op_sel_hi:[1,0]
  v_pk_mul_f32 v[44:45], v[44:45], v[230:231] op_sel_hi:[1,0]
  v_pk_mul_f32 v[46:47], v[46:47], v[230:231] op_sel_hi:[1,0]
  v_cvt_pk_bf16_f32 v200, v40, v41
  v_cvt_pk_bf16_f32 v201, v42, v43
  v_cvt_pk_bf16_f32 v202, v44, v45
  v_cvt_pk_bf16_f32 v203, v46, v47
  v_accvgpr_read_b32 v48, a120
  v_accvgpr_read_b32 v49, a121
  v_accvgpr_read_b32 v50, a122
  v_accvgpr_read_b32 v51, a123
  v_accvgpr_read_b32 v52, a124
  v_accvgpr_read_b32 v53, a125
  v_accvgpr_read_b32 v54, a126
  v_accvgpr_read_b32 v55, a127
  v_pk_mul_f32 v[48:49], v[48:49], v[230:231] op_sel_hi:[1,0]
  v_pk_mul_f32 v[50:51], v[50:51], v[230:231] op_sel_hi:[1,0]
  v_pk_mul_f32 v[52:53], v[52:53], v[230:231] op_sel_hi:[1,0]
  v_pk_mul_f32 v[54:55], v[54:55], v[230:231] op_sel_hi:[1,0]
  v_cvt_pk_bf16_f32 v204, v48, v49
  v_cvt_pk_bf16_f32 v205, v50, v51
  v_cvt_pk_bf16_f32 v206, v52, v53
  v_cvt_pk_bf16_f32 v207, v54, v55
  s_waitcnt lgkmcnt(0)
  s_barrier
  ds_read_b128 v[236:239], v33 offset:0
  ds_read_b128 v[240:243], v33 offset:1024
  ds_read_b128 v[244:247], v33 offset:2048
  ds_read_b128 v[248:251], v33 offset:3072
  ds_read_b64 v[60:61], v63
  v_mov_b32 v62, 147456
  ds_read_b128 v[40:43], v62
  s_waitcnt lgkmcnt(0)
  v_or_b32 v40, v40, v41
  v_or_b32 v42, v42, v43
  v_or_b32 v40, v40, v42
  s_nop 0
  v_readfirstlane_b32 s37, v40
  s_nop 3
  s_andn2_b32 s37, s37, s49
  s_cmp_lg_u32 s37, 0
  s_cbranch_scc1 K1_FB
  v_min_f32 v62, v60, v232
  v_sub_f32 v63, v62, v232
  v_sub_f32 v62, v62, v60
  v_exp_f32 v63, v63
  v_exp_f32 v62, v62
  s_nop 0
  v_mul_f32 v61, v61, v62
  v_fma_f32 v61, v252, v63, v61
  v_rcp_f32 v61, v61
  s_nop 0
  v_mul_f32 v63, v63, v61
  v_mul_f32 v62, v62, v61
  v_accvgpr_read_b32 v40, a144
  v_accvgpr_read_b32 v41, a145
  v_accvgpr_read_b32 v42, a146
  v_accvgpr_read_b32 v43, a147
  v_accvgpr_read_b32 v44, a148
  v_accvgpr_read_b32 v45, a149
  v_accvgpr_read_b32 v46, a150
  v_accvgpr_read_b32 v47, a151
  v_mul_f32 v40, v63, v40
  v_mul_f32 v41, v63, v41
  v_mul_f32 v42, v63, v42
  v_mul_f32 v43, v63, v43
  v_mul_f32 v44, v63, v44
  v_mul_f32 v45, v63, v45
  v_mul_f32 v46, v63, v46
  v_mul_f32 v47, v63, v47
  v_fma_f32 v40, v236, v62, v40
  v_fma_f32 v41, v237, v62, v41
  v_fma_f32 v42, v238, v62, v42
  v_fma_f32 v43, v239, v62, v43
  v_fma_f32 v44, v240, v62, v44
  v_fma_f32 v45, v241, v62, v45
  v_fma_f32 v46, v242, v62, v46
  v_fma_f32 v47, v243, v62, v47
  v_cvt_pk_bf16_f32 v208, v40, v41
  v_cvt_pk_bf16_f32 v209, v42, v43
  v_cvt_pk_bf16_f32 v210, v44, v45
  v_cvt_pk_bf16_f32 v211, v46, v47
  v_accvgpr_read_b32 v48, a152
  v_accvgpr_read_b32 v49, a153
  v_accvgpr_read_b32 v50, a154
  v_accvgpr_read_b32 v51, a155
  v_accvgpr_read_b32 v52, a156
  v_accvgpr_read_b32 v53, a157
  v_accvgpr_read_b32 v54, a158
  v_accvgpr_read_b32 v55, a159
  v_mul_f32 v48, v63, v48
  v_mul_f32 v49, v63, v49
  v_mul_f32 v50, v63, v50
  v_mul_f32 v51, v63, v51
  v_mul_f32 v52, v63, v52
  v_mul_f32 v53, v63, v53
  v_mul_f32 v54, v63, v54
  v_mul_f32 v55, v63, v55
  v_fma_f32 v48, v244, v62, v48
  v_fma_f32 v49, v245, v62, v49
  v_fma_f32 v50, v246, v62, v50
  v_fma_f32 v51, v247, v62, v51
  v_fma_f32 v52, v248, v62, v52
  v_fma_f32 v53, v249, v62, v53
  v_fma_f32 v54, v250, v62, v54
  v_fma_f32 v55, v251, v62, v55
  v_cvt_pk_bf16_f32 v212, v48, v49
  v_cvt_pk_bf16_f32 v213, v50, v51
  v_cvt_pk_bf16_f32 v214, v52, v53
  v_cvt_pk_bf16_f32 v215, v54, v55
K1_N:
  s_cmp_eq_u32 s48, 1
  s_cbranch_scc1 K1_ST
  s_mov_b32 s48, 1
  s_mov_b32 s49, 0
  s_add_u32 s50, s50, 36864
  v_accvgpr_read_b32 v64, a160
  v_accvgpr_read_b32 v65, a161
  v_accvgpr_read_b32 v66, a162
  v_accvgpr_read_b32 v67, a163
  v_accvgpr_read_b32 v68, a164
  v_accvgpr_read_b32 v69, a165
  v_accvgpr_read_b32 v70, a166
  v_accvgpr_read_b32 v71, a167
  v_accvgpr_read_b32 v72, a168
  v_accvgpr_read_b32 v73, a169
  v_accvgpr_read_b32 v74, a170
  v_accvgpr_read_b32 v75, a171
  v_accvgpr_read_b32 v76, a172
  v_accvgpr_read_b32 v77, a173
  v_accvgpr_read_b32 v78, a174
  v_accvgpr_read_b32 v79, a175
  v_accvgpr_read_b32 v80, a176
  v_accvgpr_read_b32 v81, a177
  v_accvgpr_read_b32 v82, a178
  v_accvgpr_read_b32 v83, a179
  v_accvgpr_read_b32 v84, a180
  v_accvgpr_read_b32 v85, a181
  v_accvgpr_read_b32 v86, a182
  v_accvgpr_read_b32 v87, a183
  v_accvgpr_read_b32 v88, a184
  v_accvgpr_read_b32 v89, a185
  v_accvgpr_read_b32 v90, a186
  v_accvgpr_read_b32 v91, a187
  v_accvgpr_read_b32 v92, a188
  v_accvgpr_read_b32 v93, a189
  v_accvgpr_read_b32 v94, a190
  v_accvgpr_read_b32 v95, a191
  v_accvgpr_read_b32 v96, a192
  v_accvgpr_read_b32 v97, a193
  v_accvgpr_read_b32 v98, a194
  v_accvgpr_read_b32 v99, a195
  v_accvgpr_read_b32 v100, a196
  v_accvgpr_read_b32 v101, a197
  v_accvgpr_read_b32 v102, a198
  v_accvgpr_read_b32 v103, a199
  v_accvgpr_read_b32 v104, a200
  v_accvgpr_read_b32 v105, a201
  v_accvgpr_read_b32 v106, a202
  v_accvgpr_read_b32 v107, a203
  v_accvgpr_read_b32 v108, a204
  v_accvgpr_read_b32 v109, a205
  v_accvgpr_read_b32 v110, a206
  v_accvgpr_read_b32 v111, a207
  v_accvgpr_read_b32 v112, a208
  v_accvgpr_read_b32 v113, a209
  v_accvgpr_read_b32 v114, a210
  v_accvgpr_read_b32 v115, a211
  v_accvgpr_read_b32 v116, a212
  v_accvgpr_read_b32 v117, a213
  v_accvgpr_read_b32 v118, a214
  v_accvgpr_read_b32 v119, a215
  v_accvgpr_read_b32 v120, a216
  v_accvgpr_read_b32 v121, a217
  v_accvgpr_read_b32 v122, a218
  v_accvgpr_read_b32 v123, a219
  v_accvgpr_read_b32 v124, a220
  v_accvgpr_read_b32 v125, a221
  v_accvgpr_read_b32 v126, a222
  v_accvgpr_read_b32 v127, a223
  v_accvgpr_read_b32 v128, a224
  v_accvgpr_read_b32 v129, a225
  v_accvgpr_read_b32 v130, a226
  v_accvgpr_read_b32 v131, a227
  v_accvgpr_read_b32 v132, a228
  v_accvgpr_read_b32 v133, a229
  v_accvgpr_read_b32 v134, a230
  v_accvgpr_read_b32 v135, a231
  v_accvgpr_read_b32 v136, a232
  v_accvgpr_read_b32 v137, a233
  v_accvgpr_read_b32 v138, a234
  v_accvgpr_read_b32 v139, a235
  v_accvgpr_read_b32 v140, a236
  v_accvgpr_read_b32 v141, a237
  v_accvgpr_read_b32 v142, a238
  v_accvgpr_read_b32 v143, a239
  v_accvgpr_write_b32 a160, v144
  v_accvgpr_write_b32 a161, v145
  v_accvgpr_write_b32 a162, v146
  v_accvgpr_write_b32 a163, v147
  v_accvgpr_write_b32 a164, v148
  v_accvgpr_write_b32 a165, v149
  v_accvgpr_write_b32 a166, v150
  v_accvgpr_write_b32 a167, v151
  v_accvgpr_write_b32 a168, v152
  v_accvgpr_write_b32 a169, v153
  v_accvgpr_write_b32 a170, v154
  v_accvgpr_write_b32 a171, v155
  v_accvgpr_write_b32 a172, v156
  v_accvgpr_write_b32 a173, v157
  v_accvgpr_write_b32 a174, v158
  v_accvgpr_write_b32 a175, v159
  v_accvgpr_write_b32 a176, v160
  v_accvgpr_write_b32 a177, v161
  v_accvgpr_write_b32 a178, v162
  v_accvgpr_write_b32 a179, v163
  v_accvgpr_write_b32 a180, v164
  v_accvgpr_write_b32 a181, v165
  v_accvgpr_write_b32 a182, v166
  v_accvgpr_write_b32 a183, v167
  v_accvgpr_write_b32 a184, v168
  v_accvgpr_write_b32 a185, v169
  v_accvgpr_write_b32 a186, v170
  v_accvgpr_write_b32 a187, v171
  v_accvgpr_write_b32 a188, v172
  v_accvgpr_write_b32 a189, v173
  v_accvgpr_write_b32 a190, v174
  v_accvgpr_write_b32 a191, v175
  v_accvgpr_write_b32 a192, v176
  v_accvgpr_write_b32 a193, v177
  v_accvgpr_write_b32 a194, v178
  v_accvgpr_write_b32 a195, v179
  v_accvgpr_write_b32 a196, v180
  v_accvgpr_write_b32 a197, v181
  v_accvgpr_write_b32 a198, v182
  v_accvgpr_write_b32 a199, v183
  v_accvgpr_write_b32 a200, v184
  v_accvgpr_write_b32 a201, v185
  v_accvgpr_write_b32 a202, v186
  v_accvgpr_write_b32 a203, v187
  v_accvgpr_write_b32 a204, v188
  v_accvgpr_write_b32 a205, v189
  v_accvgpr_write_b32 a206, v190
  v_accvgpr_write_b32 a207, v191
  v_accvgpr_write_b32 a208, v192
  v_accvgpr_write_b32 a209, v193
  v_accvgpr_write_b32 a210, v194
  v_accvgpr_write_b32 a211, v195
  v_accvgpr_write_b32 a212, v196
  v_accvgpr_write_b32 a213, v197
  v_accvgpr_write_b32 a214, v198
  v_accvgpr_write_b32 a215, v199
  v_accvgpr_write_b32 a216, v200
  v_accvgpr_write_b32 a217, v201
  v_accvgpr_write_b32 a218, v202
  v_accvgpr_write_b32 a219, v203
  v_accvgpr_write_b32 a220, v204
  v_accvgpr_write_b32 a221, v205
  v_accvgpr_write_b32 a222, v206
  v_accvgpr_write_b32 a223, v207
  v_accvgpr_write_b32 a224, v208
  v_accvgpr_write_b32 a225, v209
  v_accvgpr_write_b32 a226, v210
  v_accvgpr_write_b32 a227, v211
  v_accvgpr_write_b32 a228, v212
  v_accvgpr_write_b32 a229, v213
  v_accvgpr_write_b32 a230, v214
  v_accvgpr_write_b32 a231, v215
  s_branch K1_A
K1_ST:
  s_mul_i32 s40, s33, 18432
  s_add_u32 s40, s40, s60
  s_add_u32 s38, s56, s50
  buffer_store_dwordx4 v[144:147], v7, s[24:27], s38 offen sc1
  s_add_u32 s38, s38, 9216
  buffer_store_dwordx4 v[148:151], v7, s[24:27], s38 offen sc1
  s_add_u32 s38, s38, 9216
  buffer_store_dwordx4 v[152:155], v7, s[24:27], s38 offen sc1
  s_add_u32 s38, s38, 9216
  buffer_store_dwordx4 v[156:159], v7, s[24:27], s38 offen sc1
  s_add_u32 s38, s57, s50
  buffer_store_dwordx4 v[160:163], v7, s[24:27], s38 offen sc1
  s_add_u32 s38, s38, 9216
  buffer_store_dwordx4 v[164:167], v7, s[24:27], s38 offen sc1
  s_add_u32 s38, s38, 9216
  buffer_store_dwordx4 v[168:171], v7, s[24:27], s38 offen sc1
  s_add_u32 s38, s38, 9216
  buffer_store_dwordx4 v[172:175], v7, s[24:27], s38 offen sc1
  s_add_u32 s38, s58, s50
  buffer_store_dwordx4 v[176:179], v7, s[24:27], s38 offen sc1
  s_add_u32 s38, s38, 9216
  buffer_store_dwordx4 v[180:183], v7, s[24:27], s38 offen sc1
  s_add_u32 s38, s38, 9216
  buffer_store_dwordx4 v[184:187], v7, s[24:27], s38 offen sc1
  s_add_u32 s38, s38, 9216
  buffer_store_dwordx4 v[188:191], v7, s[24:27], s38 offen sc1
  s_add_u32 s38, s59, s50
  buffer_store_dwordx4 v[192:195], v7, s[24:27], s38 offen sc1
  s_add_u32 s38, s38, 9216
  buffer_store_dwordx4 v[196:199], v7, s[24:27], s38 offen sc1
  s_add_u32 s38, s38, 9216
  buffer_store_dwordx4 v[200:203], v7, s[24:27], s38 offen sc1
  s_add_u32 s38, s38, 9216
  buffer_store_dwordx4 v[204:207], v7, s[24:27], s38 offen sc1
  s_add_u32 s38, s40, s50
  buffer_store_dwordx4 v[208:211], v7, s[24:27], s38 offen sc1
  s_add_u32 s38, s38, 9216
  buffer_store_dwordx4 v[212:215], v7, s[24:27], s38 offen sc1
  s_sub_u32 s50, s50, 36864
  s_add_u32 s38, s56, s50
  buffer_store_dwordx4 a[160:163], v7, s[24:27], s38 offen sc1
  s_add_u32 s38, s38, 9216
  buffer_store_dwordx4 a[164:167], v7, s[24:27], s38 offen sc1
  s_add_u32 s38, s38, 9216
  buffer_store_dwordx4 a[168:171], v7, s[24:27], s38 offen sc1
  s_add_u32 s38, s38, 9216
  buffer_store_dwordx4 a[172:175], v7, s[24:27], s38 offen sc1
  s_add_u32 s38, s57, s50
  buffer_store_dwordx4 a[176:179], v7, s[24:27], s38 offen sc1
  s_add_u32 s38, s38, 9216
  buffer_store_dwordx4 a[180:183], v7, s[24:27], s38 offen sc1
  s_add_u32 s38, s38, 9216
  buffer_store_dwordx4 a[184:187], v7, s[24:27], s38 offen sc1
  s_add_u32 s38, s38, 9216
  buffer_store_dwordx4 a[188:191], v7, s[24:27], s38 offen sc1
  s_add_u32 s38, s58, s50
  buffer_store_dwordx4 a[192:195], v7, s[24:27], s38 offen sc1
  s_add_u32 s38, s38, 9216
  buffer_store_dwordx4 a[196:199], v7, s[24:27], s38 offen sc1
  s_add_u32 s38, s38, 9216
  buffer_store_dwordx4 a[200:203], v7, s[24:27], s38 offen sc1
  s_add_u32 s38, s38, 9216
  buffer_store_dwordx4 a[204:207], v7, s[24:27], s38 offen sc1
  s_add_u32 s38, s59, s50
  buffer_store_dwordx4 a[208:211], v7, s[24:27], s38 offen sc1
  s_add_u32 s38, s38, 9216
  buffer_store_dwordx4 a[212:215], v7, s[24:27], s38 offen sc1
  s_add_u32 s38, s38, 9216
  buffer_store_dwordx4 a[216:219], v7, s[24:27], s38 offen sc1
  s_add_u32 s38, s38, 9216
  buffer_store_dwordx4 a[220:223], v7, s[24:27], s38 offen sc1
  s_add_u32 s38, s40, s50
  buffer_store_dwordx4 a[224:227], v7, s[24:27], s38 offen sc1
  s_add_u32 s38, s38, 9216
  buffer_store_dwordx4 a[228:231], v7, s[24:27], s38 offen sc1
  s_branch K1_FIN
K1_FB:
  s_waitcnt vmcnt(0) lgkmcnt(0)
  s_barrier
  v_lshlrev_b32 v60, 8, v3
  v_lshlrev_b32 v61, 4, v4
  v_add_u32 v60, v60, v61
  s_lshl_b32 s37, s48, 18
  s_mov_b32 s44, 64
  v_mov_b32 v216, 0xff800000
  v_mov_b32 v220, 0xff800000
  v_mov_b32 v224, 0xff800000
  v_mov_b32 v228, 0xff800000
  v_mov_b32 v232, 0xff800000
K1_FBL:
  buffer_load_dwordx4 v[40:43], v60, s[16:19], s37 offen offset:0
  buffer_load_dwordx4 v[44:47], v60, s[16:19], s37 offen offset:64
  buffer_load_dwordx4 v[48:51], v60, s[16:19], s37 offen offset:128
  buffer_load_dwordx4 v[52:55], v60, s[16:19], s37 offen offset:192
  s_waitcnt vmcnt(3)
  v_mfma_f32_16x16x32_bf16 v[144:147], v[40:43], v[64:67], 0
  v_mfma_f32_16x16x32_bf16 v[152:155], v[40:43], v[68:71], 0
  v_mfma_f32_16x16x32_bf16 v[160:163], v[40:43], v[72:75], 0
  v_mfma_f32_16x16x32_bf16 v[168:171], v[40:43], v[76:79], 0
  v_mfma_f32_16x16x32_bf16 v[176:179], v[40:43], v[80:83], 0
  s_waitcnt vmcnt(2)
  v_mfma_f32_16x16x32_bf16 v[144:147], v[44:47], v[84:87], v[144:147]
  v_mfma_f32_16x16x32_bf16 v[152:155], v[44:47], v[88:91], v[152:155]
  v_mfma_f32_16x16x32_bf16 v[160:163], v[44:47], v[92:95], v[160:163]
  v_mfma_f32_16x16x32_bf16 v[168:171], v[44:47], v[96:99], v[168:171]
  v_mfma_f32_16x16x32_bf16 v[176:179], v[44:47], v[100:103], v[176:179]
  s_waitcnt vmcnt(1)
  v_mfma_f32_16x16x32_bf16 v[144:147], v[48:51], v[104:107], v[144:147]
  v_mfma_f32_16x16x32_bf16 v[152:155], v[48:51], v[108:111], v[152:155]
  v_mfma_f32_16x16x32_bf16 v[160:163], v[48:51], v[112:115], v[160:163]
  v_mfma_f32_16x16x32_bf16 v[168:171], v[48:51], v[116:119], v[168:171]
  v_mfma_f32_16x16x32_bf16 v[176:179], v[48:51], v[120:123], v[176:179]
  s_waitcnt vmcnt(0)
  v_mfma_f32_16x16x32_bf16 v[144:147], v[52:55], v[124:127], v[144:147]
  v_mfma_f32_16x16x32_bf16 v[152:155], v[52:55], v[128:131], v[152:155]
  v_mfma_f32_16x16x32_bf16 v[160:163], v[52:55], v[132:135], v[160:163]
  v_mfma_f32_16x16x32_bf16 v[168:171], v[52:55], v[136:139], v[168:171]
  v_mfma_f32_16x16x32_bf16 v[176:179], v[52:55], v[140:143], v[176:179]
  s_nop 3
  v_max3_f32 v216, v216, v144, v145
  v_max3_f32 v220, v220, v152, v153
  v_max3_f32 v224, v224, v160, v161
  v_max3_f32 v228, v228, v168, v169
  v_max3_f32 v232, v232, v176, v177
  v_max3_f32 v216, v216, v146, v147
  v_max3_f32 v220, v220, v154, v155
  v_max3_f32 v224, v224, v162, v163
  v_max3_f32 v228, v228, v170, v171
  v_max3_f32 v232, v232, v178, v179
  s_add_u32 s37, s37, 4096
  s_sub_u32 s44, s44, 1
  s_cmp_lg_u32 s44, 0
  s_cbranch_scc1 K1_FBL
  v_mov_b32 v217, v216
  v_mov_b32 v221, v220
  v_mov_b32 v225, v224
  v_mov_b32 v229, v228
  v_mov_b32 v233, v232
  v_permlane32_swap_b32 v216, v217
  v_permlane32_swap_b32 v220, v221
  v_permlane32_swap_b32 v224, v225
  v_permlane32_swap_b32 v228, v229
  v_permlane32_swap_b32 v232, v233
  v_max_f32 v216, v216, v217
  v_max_f32 v220, v220, v221
  v_max_f32 v224, v224, v225
  v_max_f32 v228, v228, v229
  v_max_f32 v232, v232, v233
  v_mov_b32 v217, v216
  v_mov_b32 v221, v220
  v_mov_b32 v225, v224
  v_mov_b32 v229, v228
  v_mov_b32 v233, v232
  v_permlane16_swap_b32 v216, v217
  v_permlane16_swap_b32 v220, v221
  v_permlane16_swap_b32 v224, v225
  v_permlane16_swap_b32 v228, v229
  v_permlane16_swap_b32 v232, v233
  v_max_f32 v216, v216, v217
  v_max_f32 v220, v220, v221
  v_max_f32 v224, v224, v225
  v_max_f32 v228, v228, v229
  v_max_f32 v232, v232, v233
  v_sub_f32 v216, 0, v216
  v_sub_f32 v220, 0, v220
  v_sub_f32 v224, 0, v224
  v_sub_f32 v228, 0, v228
  v_sub_f32 v232, 0, v232
  v_mov_b32 v217, v216
  v_mov_b32 v221, v220
  v_mov_b32 v225, v224
  v_mov_b32 v229, v228
  v_mov_b32 v233, v232
  v_mov_b32 v218, v216
  v_mov_b32 v222, v220
  v_mov_b32 v226, v224
  v_mov_b32 v230, v228
  v_mov_b32 v234, v232
  v_mov_b32 v219, v216
  v_mov_b32 v223, v220
  v_mov_b32 v227, v224
  v_mov_b32 v231, v228
  v_mov_b32 v235, v232
  s_mov_b32 s49, 1
  s_lshl_b32 s47, s48, 18
  s_lshl_b32 s54, s48, 18
  s_add_u32 m0, s43, 0
  s_nop 0
  buffer_load_dwordx4 v34, s[16:19], s47 offen offset:0 nt lds
  buffer_load_dwordx4 v35, s[16:19], s47 offen offset:1024 nt lds
  buffer_load_dwordx4 v36, s[16:19], s47 offen offset:2048 nt lds
  buffer_load_dwordx4 v37, s[16:19], s47 offen offset:3072 nt lds
  s_add_u32 s47, s47, 16384
  s_add_u32 m0, s43, 65536
  s_nop 0
  buffer_load_dwordx4 v38, s[20:23], s54 offen offset:0 nt lds
  buffer_load_dwordx4 v39, s[20:23], s54 offen offset:1024 nt lds
  buffer_load_dwordx4 v38, s[20:23], s54 offen offset:2048 nt lds
  buffer_load_dwordx4 v39, s[20:23], s54 offen offset:3072 nt lds
  s_add_u32 s54, s54, 16384
  s_add_u32 m0, s43, 16384
  s_nop 0
  buffer_load_dwordx4 v34, s[16:19], s47 offen offset:0 nt lds
  buffer_load_dwordx4 v35, s[16:19], s47 offen offset:1024 nt lds
  buffer_load_dwordx4 v36, s[16:19], s47 offen offset:2048 nt lds
  buffer_load_dwordx4 v37, s[16:19], s47 offen offset:3072 nt lds
  s_add_u32 s47, s47, 16384
  s_add_u32 m0, s43, 81920
  s_nop 0
  buffer_load_dwordx4 v38, s[20:23], s54 offen offset:0 nt lds
  buffer_load_dwordx4 v39, s[20:23], s54 offen offset:1024 nt lds
  buffer_load_dwordx4 v38, s[20:23], s54 offen offset:2048 nt lds
  buffer_load_dwordx4 v39, s[20:23], s54 offen offset:3072 nt lds
  s_add_u32 s54, s54, 16384
  s_add_u32 m0, s43, 98304
  s_nop 0
  buffer_load_dwordx4 v38, s[20:23], s54 offen offset:0 nt lds
  buffer_load_dwordx4 v39, s[20:23], s54 offen offset:1024 nt lds
  s_waitcnt vmcnt(10)
  s_barrier
  s_branch K1_A
K1_FIN:
K1_DONE:
  s_endpgm
.p2align 8
.globl oproj_kernel
.type oproj_kernel,@function
oproj_kernel:
  s_cmp_ge_u32 s2, 256
  s_cbranch_scc1 K2_DONE
K2_START:
  s_load_dwordx2 s[36:37], s[0:1], 88
  s_load_dwordx2 s[4:5], s[0:1], 96
  s_load_dwordx2 s[6:7], s[0:1], 80
  v_lshrrev_b32 v1, 6, v0
  v_and_b32 v2, 63, v0
  v_readfirstlane_b32 s20, v1
  v_lshlrev_b32 v3, 4, v2
  s_and_b32 s21, s2, 7
  s_lshr_b32 s22, s2, 3
  s_lshr_b32 s23, s21, 2
  s_and_b32 s24, s21, 2
  s_lshl_b32 s24, s24, 1
  s_and_b32 s25, s22, 3
  s_add_u32 s24, s24, s25
  s_lshl_b32 s38, s23, 3
  s_add_u32 s38, s38, s24
  s_lshl_b32 s24, s24, 1
  s_and_b32 s25, s21, 1
  s_add_u32 s24, s24, s25
  s_lshr_b32 s25, s22, 2
  s_waitcnt lgkmcnt(0)
  s_lshl_b32 s26, s23, 4
  s_add_u32 s26, s26, s24
  s_mul_i32 s26, s26, 1179648
  s_add_u32 s8, s4, s26
  s_addc_u32 s9, s5, 0
  s_mov_b32 s10, 1179648
  s_mov_b32 s11, 0x00020000
  s_lshl_b32 s26, s23, 3
  s_add_u32 s26, s26, s25
  s_mul_i32 s26, s26, 655360
  s_add_u32 s26, s26, 37748736
  s_add_u32 s12, s4, s26
  s_addc_u32 s13, s5, 0
  s_mov_b32 s14, 655360
  s_mov_b32 s15, 0x00020000
  s_mov_b32 s16, s6
  s_mov_b32 s17, s7
  s_mov_b32 s18, 5898240
  s_mov_b32 s19, 0x00020000
  s_mul_i32 s30, s20, 9216
  s_mul_i32 s31, s20, 5120
  buffer_load_dwordx4 a[0:3], v3, s[12:15], s31 offen
  s_add_u32 s32, s30, 4096
  s_add_u32 s33, s30, 8192
  buffer_load_dwordx4 a[20:23], v3, s[8:11], s30 offen
  buffer_load_dwordx4 a[24:27], v3, s[8:11], s30 offen offset:1024
  buffer_load_dwordx4 a[28:31], v3, s[8:11], s30 offen offset:2048
  buffer_load_dwordx4 a[32:35], v3, s[8:11], s30 offen offset:3072
  buffer_load_dwordx4 a[36:39], v3, s[8:11], s32 offen offset:0
  buffer_load_dwordx4 a[40:43], v3, s[8:11], s32 offen offset:1024
  buffer_load_dwordx4 a[44:47], v3, s[8:11], s32 offen offset:2048
  buffer_load_dwordx4 a[48:51], v3, s[8:11], s32 offen offset:3072
  buffer_load_dwordx4 a[52:55], v3, s[8:11], s33 offen
  buffer_load_dwordx4 a[4:7], v3, s[12:15], s31 offen offset:1024
  buffer_load_dwordx4 a[8:11], v3, s[12:15], s31 offen offset:2048
  buffer_load_dwordx4 a[12:15], v3, s[12:15], s31 offen offset:3072
  s_add_u32 s34, s31, 4096
  buffer_load_dwordx4 a[16:19], v3, s[12:15], s34 offen
  s_add_u32 s30, s30, 36864
  s_add_u32 s31, s31, 20480
  buffer_load_dwordx4 a[56:59], v3, s[12:15], s31 offen
  s_add_u32 s32, s30, 4096
  s_add_u32 s33, s30, 8192
  buffer_load_dwordx4 a[76:79], v3, s[8:11], s30 offen
  buffer_load_dwordx4 a[80:83], v3, s[8:11], s30 offen offset:1024
  buffer_load_dwordx4 a[84:87], v3, s[8:11], s30 offen offset:2048
  buffer_load_dwordx4 a[88:91], v3, s[8:11], s30 offen offset:3072
  buffer_load_dwordx4 a[92:95], v3, s[8:11], s32 offen offset:0
  buffer_load_dwordx4 a[96:99], v3, s[8:11], s32 offen offset:1024
  buffer_load_dwordx4 a[100:103], v3, s[8:11], s32 offen offset:2048
  buffer_load_dwordx4 a[104:107], v3, s[8:11], s32 offen offset:3072
  buffer_load_dwordx4 a[108:111], v3, s[8:11], s33 offen
  buffer_load_dwordx4 a[60:63], v3, s[12:15], s31 offen offset:1024
  buffer_load_dwordx4 a[64:67], v3, s[12:15], s31 offen offset:2048
  buffer_load_dwordx4 a[68:71], v3, s[12:15], s31 offen offset:3072
  s_add_u32 s34, s31, 4096
  buffer_load_dwordx4 a[72:75], v3, s[12:15], s34 offen
  s_add_u32 s30, s30, 36864
  s_add_u32 s31, s31, 20480
  buffer_load_dwordx4 a[112:115], v3, s[12:15], s31 offen
  s_add_u32 s32, s30, 4096
  s_add_u32 s33, s30, 8192
  buffer_load_dwordx4 a[132:135], v3, s[8:11], s30 offen
  buffer_load_dwordx4 a[136:139], v3, s[8:11], s30 offen offset:1024
  buffer_load_dwordx4 a[140:143], v3, s[8:11], s30 offen offset:2048
  buffer_load_dwordx4 a[144:147], v3, s[8:11], s30 offen offset:3072
  buffer_load_dwordx4 a[148:151], v3, s[8:11], s32 offen offset:0
  buffer_load_dwordx4 a[152:155], v3, s[8:11], s32 offen offset:1024
  buffer_load_dwordx4 a[156:159], v3, s[8:11], s32 offen offset:2048
  buffer_load_dwordx4 a[160:163], v3, s[8:11], s32 offen offset:3072
  buffer_load_dwordx4 a[164:167], v3, s[8:11], s33 offen
  buffer_load_dwordx4 a[116:119], v3, s[12:15], s31 offen offset:1024
  buffer_load_dwordx4 a[120:123], v3, s[12:15], s31 offen offset:2048
  buffer_load_dwordx4 a[124:127], v3, s[12:15], s31 offen offset:3072
  s_add_u32 s34, s31, 4096
  buffer_load_dwordx4 a[128:131], v3, s[12:15], s34 offen
  s_add_u32 s30, s30, 36864
  s_add_u32 s31, s31, 20480
  v_mov_b32 v64, 0
  v_mov_b32 v65, 0
  v_mov_b32 v66, 0
  v_mov_b32 v67, 0
  v_mov_b32 v68, 0
  v_mov_b32 v69, 0
  v_mov_b32 v70, 0
  v_mov_b32 v71, 0
  v_mov_b32 v72, 0
  v_mov_b32 v73, 0
  v_mov_b32 v74, 0
  v_mov_b32 v75, 0
  v_mov_b32 v76, 0
  v_mov_b32 v77, 0
  v_mov_b32 v78, 0
  v_mov_b32 v79, 0
  v_mov_b32 v80, 0
  v_mov_b32 v81, 0
  v_mov_b32 v82, 0
  v_mov_b32 v83, 0
  v_mov_b32 v84, 0
  v_mov_b32 v85, 0
  v_mov_b32 v86, 0
  v_mov_b32 v87, 0
  v_mov_b32 v88, 0
  v_mov_b32 v89, 0
  v_mov_b32 v90, 0
  v_mov_b32 v91, 0
  v_mov_b32 v92, 0
  v_mov_b32 v93, 0
  v_mov_b32 v94, 0
  v_mov_b32 v95, 0
  v_mov_b32 v96, 0
  v_mov_b32 v97, 0
  v_mov_b32 v98, 0
  v_mov_b32 v99, 0
  v_mov_b32 v100, 0
  v_mov_b32 v101, 0
  v_mov_b32 v102, 0
  v_mov_b32 v103, 0
  v_mov_b32 v104, 0
  v_mov_b32 v105, 0
  v_mov_b32 v106, 0
  v_mov_b32 v107, 0
  v_mov_b32 v108, 0
  v_mov_b32 v109, 0
  v_mov_b32 v110, 0
  v_mov_b32 v111, 0
  v_mov_b32 v112, 0
  v_mov_b32 v113, 0
  v_mov_b32 v114, 0
  v_mov_b32 v115, 0
  v_mov_b32 v116, 0
  v_mov_b32 v117, 0
  v_mov_b32 v118, 0
  v_mov_b32 v119, 0
  v_mov_b32 v120, 0
  v_mov_b32 v121, 0
  v_mov_b32 v122, 0
  v_mov_b32 v123, 0
  v_mov_b32 v124, 0
  v_mov_b32 v125, 0
  v_mov_b32 v126, 0
  v_mov_b32 v127, 0
  v_mov_b32 v128, 0
  v_mov_b32 v129, 0
  v_mov_b32 v130, 0
  v_mov_b32 v131, 0
  v_mov_b32 v132, 0
  v_mov_b32 v133, 0
  v_mov_b32 v134, 0
  v_mov_b32 v135, 0
  v_mov_b32 v136, 0
  v_mov_b32 v137, 0
  v_mov_b32 v138, 0
  v_mov_b32 v139, 0
  v_mov_b32 v140, 0
  v_mov_b32 v141, 0
  v_mov_b32 v142, 0
  v_mov_b32 v143, 0
  v_mov_b32 v144, 0
  v_mov_b32 v145, 0
  v_mov_b32 v146, 0
  v_mov_b32 v147, 0
  v_mov_b32 v148, 0
  v_mov_b32 v149, 0
  v_mov_b32 v150, 0
  v_mov_b32 v151, 0
  v_mov_b32 v152, 0
  v_mov_b32 v153, 0
  v_mov_b32 v154, 0
  v_mov_b32 v155, 0
  v_mov_b32 v156, 0
  v_mov_b32 v157, 0
  v_mov_b32 v158, 0
  v_mov_b32 v159, 0
  v_mov_b32 v160, 0
  v_mov_b32 v161, 0
  v_mov_b32 v162, 0
  v_mov_b32 v163, 0
  v_mov_b32 v164, 0
  v_mov_b32 v165, 0
  v_mov_b32 v166, 0
  v_mov_b32 v167, 0
  v_mov_b32 v168, 0
  v_mov_b32 v169, 0
  v_mov_b32 v170, 0
  v_mov_b32 v171, 0
  v_mov_b32 v172, 0
  v_mov_b32 v173, 0
  v_mov_b32 v174, 0
  v_mov_b32 v175, 0
  v_mov_b32 v176, 0
  v_mov_b32 v177, 0
  v_mov_b32 v178, 0
  v_mov_b32 v179, 0
  v_mov_b32 v180, 0
  v_mov_b32 v181, 0
  v_mov_b32 v182, 0
  v_mov_b32 v183, 0
  v_mov_b32 v184, 0
  v_mov_b32 v185, 0
  v_mov_b32 v186, 0
  v_mov_b32 v187, 0
  v_mov_b32 v188, 0
  v_mov_b32 v189, 0
  v_mov_b32 v190, 0
  v_mov_b32 v191, 0
  v_mov_b32 v192, 0
  v_mov_b32 v193, 0
  v_mov_b32 v194, 0
  v_mov_b32 v195, 0
  v_mov_b32 v196, 0
  v_mov_b32 v197, 0
  v_mov_b32 v198, 0
  v_mov_b32 v199, 0
  v_mov_b32 v200, 0
  v_mov_b32 v201, 0
  v_mov_b32 v202, 0
  v_mov_b32 v203, 0
  v_mov_b32 v204, 0
  v_mov_b32 v205, 0
  v_mov_b32 v206, 0
  v_mov_b32 v207, 0
  v_mov_b32 v208, 0
  v_mov_b32 v209, 0
  v_mov_b32 v210, 0
  v_mov_b32 v211, 0
  v_mov_b32 v212, 0
  v_mov_b32 v213, 0
  v_mov_b32 v214, 0
  v_mov_b32 v215, 0
  v_mov_b32 v216, 0
  v_mov_b32 v217, 0
  v_mov_b32 v218, 0
  v_mov_b32 v219, 0
  v_mov_b32 v220, 0
  v_mov_b32 v221, 0
  v_mov_b32 v222, 0
  v_mov_b32 v223, 0
  v_mov_b32 v224, 0
  v_mov_b32 v225, 0
  v_mov_b32 v226, 0
  v_mov_b32 v227, 0
  v_mov_b32 v228, 0
  v_mov_b32 v229, 0
  v_mov_b32 v230, 0
  v_mov_b32 v231, 0
  v_mov_b32 v232, 0
  v_mov_b32 v233, 0
  v_mov_b32 v234, 0
  v_mov_b32 v235, 0
  v_mov_b32 v236, 0
  v_mov_b32 v237, 0
  v_mov_b32 v238, 0
  v_mov_b32 v239, 0
  v_mov_b32 v240, 0
  v_mov_b32 v241, 0
  v_mov_b32 v242, 0
  v_mov_b32 v243, 0
  s_mov_b32 s35, 8
K2_LOOP:
  s_waitcnt vmcnt(40)
  v_mfma_f32_16x16x32_bf16 v[64:67], a[0:3], a[20:23], v[64:67]
  s_waitcnt vmcnt(39)
  v_mfma_f32_16x16x32_bf16 v[68:71], a[0:3], a[24:27], v[68:71]
  buffer_load_dwordx4 a[168:171], v3, s[12:15], s31 offen
  s_waitcnt vmcnt(39)
  v_mfma_f32_16x16x32_bf16 v[72:75], a[0:3], a[28:31], v[72:75]
  s_waitcnt vmcnt(38)
  v_mfma_f32_16x16x32_bf16 v[76:79], a[0:3], a[32:35], v[76:79]
  s_waitcnt vmcnt(37)
  v_mfma_f32_16x16x32_bf16 v[80:83], a[0:3], a[36:39], v[80:83]
  s_add_u32 s32, s30, 4096
  s_add_u32 s33, s30, 8192
  buffer_load_dwordx4 a[188:191], v3, s[8:11], s30 offen
  s_waitcnt vmcnt(37)
  v_mfma_f32_16x16x32_bf16 v[84:87], a[0:3], a[40:43], v[84:87]
  s_waitcnt vmcnt(36)
  v_mfma_f32_16x16x32_bf16 v[88:91], a[0:3], a[44:47], v[88:91]
  s_waitcnt vmcnt(35)
  v_mfma_f32_16x16x32_bf16 v[92:95], a[0:3], a[48:51], v[92:95]
  buffer_load_dwordx4 a[192:195], v3, s[8:11], s30 offen offset:1024
  s_waitcnt vmcnt(35)
  v_mfma_f32_16x16x32_bf16 v[96:99], a[0:3], a[52:55], v[96:99]
  s_waitcnt vmcnt(34)
  v_mfma_f32_16x16x32_bf16 v[100:103], a[4:7], a[20:23], v[100:103]
  v_mfma_f32_16x16x32_bf16 v[104:107], a[4:7], a[24:27], v[104:107]
  buffer_load_dwordx4 a[196:199], v3, s[8:11], s30 offen offset:2048
  v_mfma_f32_16x16x32_bf16 v[108:111], a[4:7], a[28:31], v[108:111]
  v_mfma_f32_16x16x32_bf16 v[112:115], a[4:7], a[32:35], v[112:115]
  v_mfma_f32_16x16x32_bf16 v[116:119], a[4:7], a[36:39], v[116:119]
  buffer_load_dwordx4 a[200:203], v3, s[8:11], s30 offen offset:3072
  v_mfma_f32_16x16x32_bf16 v[120:123], a[4:7], a[40:43], v[120:123]
  v_mfma_f32_16x16x32_bf16 v[124:127], a[4:7], a[44:47], v[124:127]
  v_mfma_f32_16x16x32_bf16 v[128:131], a[4:7], a[48:51], v[128:131]
  buffer_load_dwordx4 a[204:207], v3, s[8:11], s32 offen offset:0
  v_mfma_f32_16x16x32_bf16 v[132:135], a[4:7], a[52:55], v[132:135]
  s_waitcnt vmcnt(36)
  v_mfma_f32_16x16x32_bf16 v[136:139], a[8:11], a[20:23], v[136:139]
  v_mfma_f32_16x16x32_bf16 v[140:143], a[8:11], a[24:27], v[140:143]
  buffer_load_dwordx4 a[208:211], v3, s[8:11], s32 offen offset:1024
  v_mfma_f32_16x16x32_bf16 v[144:147], a[8:11], a[28:31], v[144:147]
  v_mfma_f32_16x16x32_bf16 v[148:151], a[8:11], a[32:35], v[148:151]
  v_mfma_f32_16x16x32_bf16 v[152:155], a[8:11], a[36:39], v[152:155]
  buffer_load_dwordx4 a[212:215], v3, s[8:11], s32 offen offset:2048
  v_mfma_f32_16x16x32_bf16 v[156:159], a[8:11], a[40:43], v[156:159]
  v_mfma_f32_16x16x32_bf16 v[160:163], a[8:11], a[44:47], v[160:163]
  v_mfma_f32_16x16x32_bf16 v[164:167], a[8:11], a[48:51], v[164:167]
  buffer_load_dwordx4 a[216:219], v3, s[8:11], s32 offen offset:3072
  v_mfma_f32_16x16x32_bf16 v[168:171], a[8:11], a[52:55], v[168:171]
  s_waitcnt vmcnt(38)
  v_mfma_f32_16x16x32_bf16 v[172:175], a[12:15], a[20:23], v[172:175]
  v_mfma_f32_16x16x32_bf16 v[176:179], a[12:15], a[24:27], v[176:179]
  buffer_load_dwordx4 a[220:223], v3, s[8:11], s33 offen
  v_mfma_f32_16x16x32_bf16 v[180:183], a[12:15], a[28:31], v[180:183]
  v_mfma_f32_16x16x32_bf16 v[184:187], a[12:15], a[32:35], v[184:187]
  v_mfma_f32_16x16x32_bf16 v[188:191], a[12:15], a[36:39], v[188:191]
  buffer_load_dwordx4 a[172:175], v3, s[12:15], s31 offen offset:1024
  v_mfma_f32_16x16x32_bf16 v[192:195], a[12:15], a[40:43], v[192:195]
  v_mfma_f32_16x16x32_bf16 v[196:199], a[12:15], a[44:47], v[196:199]
  v_mfma_f32_16x16x32_bf16 v[200:203], a[12:15], a[48:51], v[200:203]
  buffer_load_dwordx4 a[176:179], v3, s[12:15], s31 offen offset:2048
  v_mfma_f32_16x16x32_bf16 v[204:207], a[12:15], a[52:55], v[204:207]
  s_waitcnt vmcnt(40)
  v_mfma_f32_16x16x32_bf16 v[208:211], a[16:19], a[20:23], v[208:211]
  v_mfma_f32_16x16x32_bf16 v[212:215], a[16:19], a[24:27], v[212:215]
  buffer_load_dwordx4 a[180:183], v3, s[12:15], s31 offen offset:3072
  v_mfma_f32_16x16x32_bf16 v[216:219], a[16:19], a[28:31], v[216:219]
  v_mfma_f32_16x16x32_bf16 v[220:223], a[16:19], a[32:35], v[220:223]
  v_mfma_f32_16x16x32_bf16 v[224:227], a[16:19], a[36:39], v[224:227]
  s_add_u32 s34, s31, 4096
  buffer_load_dwordx4 a[184:187], v3, s[12:15], s34 offen
  s_add_u32 s30, s30, 36864
  s_add_u32 s31, s31, 20480
  v_mfma_f32_16x16x32_bf16 v[228:231], a[16:19], a[40:43], v[228:231]
  v_mfma_f32_16x16x32_bf16 v[232:235], a[16:19], a[44:47], v[232:235]
  v_mfma_f32_16x16x32_bf16 v[236:239], a[16:19], a[48:51], v[236:239]
  v_mfma_f32_16x16x32_bf16 v[240:243], a[16:19], a[52:55], v[240:243]
  s_waitcnt vmcnt(40)
  v_mfma_f32_16x16x32_bf16 v[64:67], a[56:59], a[76:79], v[64:67]
  s_waitcnt vmcnt(39)
  v_mfma_f32_16x16x32_bf16 v[68:71], a[56:59], a[80:83], v[68:71]
  buffer_load_dwordx4 a[0:3], v3, s[12:15], s31 offen
  s_waitcnt vmcnt(39)
  v_mfma_f32_16x16x32_bf16 v[72:75], a[56:59], a[84:87], v[72:75]
  s_waitcnt vmcnt(38)
  v_mfma_f32_16x16x32_bf16 v[76:79], a[56:59], a[88:91], v[76:79]
  s_waitcnt vmcnt(37)
  v_mfma_f32_16x16x32_bf16 v[80:83], a[56:59], a[92:95], v[80:83]
  s_add_u32 s32, s30, 4096
  s_add_u32 s33, s30, 8192
  buffer_load_dwordx4 a[20:23], v3, s[8:11], s30 offen
  s_waitcnt vmcnt(37)
  v_mfma_f32_16x16x32_bf16 v[84:87], a[56:59], a[96:99], v[84:87]
  s_waitcnt vmcnt(36)
  v_mfma_f32_16x16x32_bf16 v[88:91], a[56:59], a[100:103], v[88:91]
  s_waitcnt vmcnt(35)
  v_mfma_f32_16x16x32_bf16 v[92:95], a[56:59], a[104:107], v[92:95]
  buffer_load_dwordx4 a[24:27], v3, s[8:11], s30 offen offset:1024
  s_waitcnt vmcnt(35)
  v_mfma_f32_16x16x32_bf16 v[96:99], a[56:59], a[108:111], v[96:99]
  s_waitcnt vmcnt(34)
  v_mfma_f32_16x16x32_bf16 v[100:103], a[60:63], a[76:79], v[100:103]
  v_mfma_f32_16x16x32_bf16 v[104:107], a[60:63], a[80:83], v[104:107]
  buffer_load_dwordx4 a[28:31], v3, s[8:11], s30 offen offset:2048
  v_mfma_f32_16x16x32_bf16 v[108:111], a[60:63], a[84:87], v[108:111]
  v_mfma_f32_16x16x32_bf16 v[112:115], a[60:63], a[88:91], v[112:115]
  v_mfma_f32_16x16x32_bf16 v[116:119], a[60:63], a[92:95], v[116:119]
  buffer_load_dwordx4 a[32:35], v3, s[8:11], s30 offen offset:3072
  v_mfma_f32_16x16x32_bf16 v[120:123], a[60:63], a[96:99], v[120:123]
  v_mfma_f32_16x16x32_bf16 v[124:127], a[60:63], a[100:103], v[124:127]
  v_mfma_f32_16x16x32_bf16 v[128:131], a[60:63], a[104:107], v[128:131]
  buffer_load_dwordx4 a[36:39], v3, s[8:11], s32 offen offset:0
  v_mfma_f32_16x16x32_bf16 v[132:135], a[60:63], a[108:111], v[132:135]
  s_waitcnt vmcnt(36)
  v_mfma_f32_16x16x32_bf16 v[136:139], a[64:67], a[76:79], v[136:139]
  v_mfma_f32_16x16x32_bf16 v[140:143], a[64:67], a[80:83], v[140:143]
  buffer_load_dwordx4 a[40:43], v3, s[8:11], s32 offen offset:1024
  v_mfma_f32_16x16x32_bf16 v[144:147], a[64:67], a[84:87], v[144:147]
  v_mfma_f32_16x16x32_bf16 v[148:151], a[64:67], a[88:91], v[148:151]
  v_mfma_f32_16x16x32_bf16 v[152:155], a[64:67], a[92:95], v[152:155]
  buffer_load_dwordx4 a[44:47], v3, s[8:11], s32 offen offset:2048
  v_mfma_f32_16x16x32_bf16 v[156:159], a[64:67], a[96:99], v[156:159]
  v_mfma_f32_16x16x32_bf16 v[160:163], a[64:67], a[100:103], v[160:163]
  v_mfma_f32_16x16x32_bf16 v[164:167], a[64:67], a[104:107], v[164:167]
  buffer_load_dwordx4 a[48:51], v3, s[8:11], s32 offen offset:3072
  v_mfma_f32_16x16x32_bf16 v[168:171], a[64:67], a[108:111], v[168:171]
  s_waitcnt vmcnt(38)
  v_mfma_f32_16x16x32_bf16 v[172:175], a[68:71], a[76:79], v[172:175]
  v_mfma_f32_16x16x32_bf16 v[176:179], a[68:71], a[80:83], v[176:179]
  buffer_load_dwordx4 a[52:55], v3, s[8:11], s33 offen
  v_mfma_f32_16x16x32_bf16 v[180:183], a[68:71], a[84:87], v[180:183]
  v_mfma_f32_16x16x32_bf16 v[184:187], a[68:71], a[88:91], v[184:187]
  v_mfma_f32_16x16x32_bf16 v[188:191], a[68:71], a[92:95], v[188:191]
  buffer_load_dwordx4 a[4:7], v3, s[12:15], s31 offen offset:1024
  v_mfma_f32_16x16x32_bf16 v[192:195], a[68:71], a[96:99], v[192:195]
  v_mfma_f32_16x16x32_bf16 v[196:199], a[68:71], a[100:103], v[196:199]
  v_mfma_f32_16x16x32_bf16 v[200:203], a[68:71], a[104:107], v[200:203]
  buffer_load_dwordx4 a[8:11], v3, s[12:15], s31 offen offset:2048
  v_mfma_f32_16x16x32_bf16 v[204:207], a[68:71], a[108:111], v[204:207]
  s_waitcnt vmcnt(40)
  v_mfma_f32_16x16x32_bf16 v[208:211], a[72:75], a[76:79], v[208:211]
  v_mfma_f32_16x16x32_bf16 v[212:215], a[72:75], a[80:83], v[212:215]
  buffer_load_dwordx4 a[12:15], v3, s[12:15], s31 offen offset:3072
  v_mfma_f32_16x16x32_bf16 v[216:219], a[72:75], a[84:87], v[216:219]
  v_mfma_f32_16x16x32_bf16 v[220:223], a[72:75], a[88:91], v[220:223]
  v_mfma_f32_16x16x32_bf16 v[224:227], a[72:75], a[92:95], v[224:227]
  s_add_u32 s34, s31, 4096
  buffer_load_dwordx4 a[16:19], v3, s[12:15], s34 offen
  s_add_u32 s30, s30, 36864
  s_add_u32 s31, s31, 20480
  v_mfma_f32_16x16x32_bf16 v[228:231], a[72:75], a[96:99], v[228:231]
  v_mfma_f32_16x16x32_bf16 v[232:235], a[72:75], a[100:103], v[232:235]
  v_mfma_f32_16x16x32_bf16 v[236:239], a[72:75], a[104:107], v[236:239]
  v_mfma_f32_16x16x32_bf16 v[240:243], a[72:75], a[108:111], v[240:243]
  s_waitcnt vmcnt(40)
  v_mfma_f32_16x16x32_bf16 v[64:67], a[112:115], a[132:135], v[64:67]
  s_waitcnt vmcnt(39)
  v_mfma_f32_16x16x32_bf16 v[68:71], a[112:115], a[136:139], v[68:71]
  buffer_load_dwordx4 a[56:59], v3, s[12:15], s31 offen
  s_waitcnt vmcnt(39)
  v_mfma_f32_16x16x32_bf16 v[72:75], a[112:115], a[140:143], v[72:75]
  s_waitcnt vmcnt(38)
  v_mfma_f32_16x16x32_bf16 v[76:79], a[112:115], a[144:147], v[76:79]
  s_waitcnt vmcnt(37)
  v_mfma_f32_16x16x32_bf16 v[80:83], a[112:115], a[148:151], v[80:83]
  s_add_u32 s32, s30, 4096
  s_add_u32 s33, s30, 8192
  buffer_load_dwordx4 a[76:79], v3, s[8:11], s30 offen
  s_waitcnt vmcnt(37)
  v_mfma_f32_16x16x32_bf16 v[84:87], a[112:115], a[152:155], v[84:87]
  s_waitcnt vmcnt(36)
  v_mfma_f32_16x16x32_bf16 v[88:91], a[112:115], a[156:159], v[88:91]
  s_waitcnt vmcnt(35)
  v_mfma_f32_16x16x32_bf16 v[92:95], a[112:115], a[160:163], v[92:95]
  buffer_load_dwordx4 a[80:83], v3, s[8:11], s30 offen offset:1024
  s_waitcnt vmcnt(35)
  v_mfma_f32_16x16x32_bf16 v[96:99], a[112:115], a[164:167], v[96:99]
  s_waitcnt vmcnt(34)
  v_mfma_f32_16x16x32_bf16 v[100:103], a[116:119], a[132:135], v[100:103]
  v_mfma_f32_16x16x32_bf16 v[104:107], a[116:119], a[136:139], v[104:107]
  buffer_load_dwordx4 a[84:87], v3, s[8:11], s30 offen offset:2048
  v_mfma_f32_16x16x32_bf16 v[108:111], a[116:119], a[140:143], v[108:111]
  v_mfma_f32_16x16x32_bf16 v[112:115], a[116:119], a[144:147], v[112:115]
  v_mfma_f32_16x16x32_bf16 v[116:119], a[116:119], a[148:151], v[116:119]
  buffer_load_dwordx4 a[88:91], v3, s[8:11], s30 offen offset:3072
  v_mfma_f32_16x16x32_bf16 v[120:123], a[116:119], a[152:155], v[120:123]
  v_mfma_f32_16x16x32_bf16 v[124:127], a[116:119], a[156:159], v[124:127]
  v_mfma_f32_16x16x32_bf16 v[128:131], a[116:119], a[160:163], v[128:131]
  buffer_load_dwordx4 a[92:95], v3, s[8:11], s32 offen offset:0
  v_mfma_f32_16x16x32_bf16 v[132:135], a[116:119], a[164:167], v[132:135]
  s_waitcnt vmcnt(36)
  v_mfma_f32_16x16x32_bf16 v[136:139], a[120:123], a[132:135], v[136:139]
  v_mfma_f32_16x16x32_bf16 v[140:143], a[120:123], a[136:139], v[140:143]
  buffer_load_dwordx4 a[96:99], v3, s[8:11], s32 offen offset:1024
  v_mfma_f32_16x16x32_bf16 v[144:147], a[120:123], a[140:143], v[144:147]
  v_mfma_f32_16x16x32_bf16 v[148:151], a[120:123], a[144:147], v[148:151]
  v_mfma_f32_16x16x32_bf16 v[152:155], a[120:123], a[148:151], v[152:155]
  buffer_load_dwordx4 a[100:103], v3, s[8:11], s32 offen offset:2048
  v_mfma_f32_16x16x32_bf16 v[156:159], a[120:123], a[152:155], v[156:159]
  v_mfma_f32_16x16x32_bf16 v[160:163], a[120:123], a[156:159], v[160:163]
  v_mfma_f32_16x16x32_bf16 v[164:167], a[120:123], a[160:163], v[164:167]
  buffer_load_dwordx4 a[104:107], v3, s[8:11], s32 offen offset:3072
  v_mfma_f32_16x16x32_bf16 v[168:171], a[120:123], a[164:167], v[168:171]
  s_waitcnt vmcnt(38)
  v_mfma_f32_16x16x32_bf16 v[172:175], a[124:127], a[132:135], v[172:175]
  v_mfma_f32_16x16x32_bf16 v[176:179], a[124:127], a[136:139], v[176:179]
  buffer_load_dwordx4 a[108:111], v3, s[8:11], s33 offen
  v_mfma_f32_16x16x32_bf16 v[180:183], a[124:127], a[140:143], v[180:183]
  v_mfma_f32_16x16x32_bf16 v[184:187], a[124:127], a[144:147], v[184:187]
  v_mfma_f32_16x16x32_bf16 v[188:191], a[124:127], a[148:151], v[188:191]
  buffer_load_dwordx4 a[60:63], v3, s[12:15], s31 offen offset:1024
  v_mfma_f32_16x16x32_bf16 v[192:195], a[124:127], a[152:155], v[192:195]
  v_mfma_f32_16x16x32_bf16 v[196:199], a[124:127], a[156:159], v[196:199]
  v_mfma_f32_16x16x32_bf16 v[200:203], a[124:127], a[160:163], v[200:203]
  buffer_load_dwordx4 a[64:67], v3, s[12:15], s31 offen offset:2048
  v_mfma_f32_16x16x32_bf16 v[204:207], a[124:127], a[164:167], v[204:207]
  s_waitcnt vmcnt(40)
  v_mfma_f32_16x16x32_bf16 v[208:211], a[128:131], a[132:135], v[208:211]
  v_mfma_f32_16x16x32_bf16 v[212:215], a[128:131], a[136:139], v[212:215]
  buffer_load_dwordx4 a[68:71], v3, s[12:15], s31 offen offset:3072
  v_mfma_f32_16x16x32_bf16 v[216:219], a[128:131], a[140:143], v[216:219]
  v_mfma_f32_16x16x32_bf16 v[220:223], a[128:131], a[144:147], v[220:223]
  v_mfma_f32_16x16x32_bf16 v[224:227], a[128:131], a[148:151], v[224:227]
  s_add_u32 s34, s31, 4096
  buffer_load_dwordx4 a[72:75], v3, s[12:15], s34 offen
  s_add_u32 s30, s30, 36864
  s_add_u32 s31, s31, 20480
  v_mfma_f32_16x16x32_bf16 v[228:231], a[128:131], a[152:155], v[228:231]
  v_mfma_f32_16x16x32_bf16 v[232:235], a[128:131], a[156:159], v[232:235]
  v_mfma_f32_16x16x32_bf16 v[236:239], a[128:131], a[160:163], v[236:239]
  v_mfma_f32_16x16x32_bf16 v[240:243], a[128:131], a[164:167], v[240:243]
  s_waitcnt vmcnt(40)
  v_mfma_f32_16x16x32_bf16 v[64:67], a[168:171], a[188:191], v[64:67]
  s_waitcnt vmcnt(39)
  v_mfma_f32_16x16x32_bf16 v[68:71], a[168:171], a[192:195], v[68:71]
  buffer_load_dwordx4 a[112:115], v3, s[12:15], s31 offen
  s_waitcnt vmcnt(39)
  v_mfma_f32_16x16x32_bf16 v[72:75], a[168:171], a[196:199], v[72:75]
  s_waitcnt vmcnt(38)
  v_mfma_f32_16x16x32_bf16 v[76:79], a[168:171], a[200:203], v[76:79]
  s_waitcnt vmcnt(37)
  v_mfma_f32_16x16x32_bf16 v[80:83], a[168:171], a[204:207], v[80:83]
  s_add_u32 s32, s30, 4096
  s_add_u32 s33, s30, 8192
  buffer_load_dwordx4 a[132:135], v3, s[8:11], s30 offen
  s_waitcnt vmcnt(37)
  v_mfma_f32_16x16x32_bf16 v[84:87], a[168:171], a[208:211], v[84:87]
  s_waitcnt vmcnt(36)
  v_mfma_f32_16x16x32_bf16 v[88:91], a[168:171], a[212:215], v[88:91]
  s_waitcnt vmcnt(35)
  v_mfma_f32_16x16x32_bf16 v[92:95], a[168:171], a[216:219], v[92:95]
  buffer_load_dwordx4 a[136:139], v3, s[8:11], s30 offen offset:1024
  s_waitcnt vmcnt(35)
  v_mfma_f32_16x16x32_bf16 v[96:99], a[168:171], a[220:223], v[96:99]
  s_waitcnt vmcnt(34)
  v_mfma_f32_16x16x32_bf16 v[100:103], a[172:175], a[188:191], v[100:103]
  v_mfma_f32_16x16x32_bf16 v[104:107], a[172:175], a[192:195], v[104:107]
  buffer_load_dwordx4 a[140:143], v3, s[8:11], s30 offen offset:2048
  v_mfma_f32_16x16x32_bf16 v[108:111], a[172:175], a[196:199], v[108:111]
  v_mfma_f32_16x16x32_bf16 v[112:115], a[172:175], a[200:203], v[112:115]
  v_mfma_f32_16x16x32_bf16 v[116:119], a[172:175], a[204:207], v[116:119]
  buffer_load_dwordx4 a[144:147], v3, s[8:11], s30 offen offset:3072
  v_mfma_f32_16x16x32_bf16 v[120:123], a[172:175], a[208:211], v[120:123]
  v_mfma_f32_16x16x32_bf16 v[124:127], a[172:175], a[212:215], v[124:127]
  v_mfma_f32_16x16x32_bf16 v[128:131], a[172:175], a[216:219], v[128:131]
  buffer_load_dwordx4 a[148:151], v3, s[8:11], s32 offen offset:0
  v_mfma_f32_16x16x32_bf16 v[132:135], a[172:175], a[220:223], v[132:135]
  s_waitcnt vmcnt(36)
  v_mfma_f32_16x16x32_bf16 v[136:139], a[176:179], a[188:191], v[136:139]
  v_mfma_f32_16x16x32_bf16 v[140:143], a[176:179], a[192:195], v[140:143]
  buffer_load_dwordx4 a[152:155], v3, s[8:11], s32 offen offset:1024
  v_mfma_f32_16x16x32_bf16 v[144:147], a[176:179], a[196:199], v[144:147]
  v_mfma_f32_16x16x32_bf16 v[148:151], a[176:179], a[200:203], v[148:151]
  v_mfma_f32_16x16x32_bf16 v[152:155], a[176:179], a[204:207], v[152:155]
  buffer_load_dwordx4 a[156:159], v3, s[8:11], s32 offen offset:2048
  v_mfma_f32_16x16x32_bf16 v[156:159], a[176:179], a[208:211], v[156:159]
  v_mfma_f32_16x16x32_bf16 v[160:163], a[176:179], a[212:215], v[160:163]
  v_mfma_f32_16x16x32_bf16 v[164:167], a[176:179], a[216:219], v[164:167]
  buffer_load_dwordx4 a[160:163], v3, s[8:11], s32 offen offset:3072
  v_mfma_f32_16x16x32_bf16 v[168:171], a[176:179], a[220:223], v[168:171]
  s_waitcnt vmcnt(38)
  v_mfma_f32_16x16x32_bf16 v[172:175], a[180:183], a[188:191], v[172:175]
  v_mfma_f32_16x16x32_bf16 v[176:179], a[180:183], a[192:195], v[176:179]
  buffer_load_dwordx4 a[164:167], v3, s[8:11], s33 offen
  v_mfma_f32_16x16x32_bf16 v[180:183], a[180:183], a[196:199], v[180:183]
  v_mfma_f32_16x16x32_bf16 v[184:187], a[180:183], a[200:203], v[184:187]
  v_mfma_f32_16x16x32_bf16 v[188:191], a[180:183], a[204:207], v[188:191]
  buffer_load_dwordx4 a[116:119], v3, s[12:15], s31 offen offset:1024
  v_mfma_f32_16x16x32_bf16 v[192:195], a[180:183], a[208:211], v[192:195]
  v_mfma_f32_16x16x32_bf16 v[196:199], a[180:183], a[212:215], v[196:199]
  v_mfma_f32_16x16x32_bf16 v[200:203], a[180:183], a[216:219], v[200:203]
  buffer_load_dwordx4 a[120:123], v3, s[12:15], s31 offen offset:2048
  v_mfma_f32_16x16x32_bf16 v[204:207], a[180:183], a[220:223], v[204:207]
  s_waitcnt vmcnt(40)
  v_mfma_f32_16x16x32_bf16 v[208:211], a[184:187], a[188:191], v[208:211]
  v_mfma_f32_16x16x32_bf16 v[212:215], a[184:187], a[192:195], v[212:215]
  buffer_load_dwordx4 a[124:127], v3, s[12:15], s31 offen offset:3072
  v_mfma_f32_16x16x32_bf16 v[216:219], a[184:187], a[196:199], v[216:219]
  v_mfma_f32_16x16x32_bf16 v[220:223], a[184:187], a[200:203], v[220:223]
  v_mfma_f32_16x16x32_bf16 v[224:227], a[184:187], a[204:207], v[224:227]
  s_add_u32 s34, s31, 4096
  buffer_load_dwordx4 a[128:131], v3, s[12:15], s34 offen
  s_add_u32 s30, s30, 36864
  s_add_u32 s31, s31, 20480
  v_mfma_f32_16x16x32_bf16 v[228:231], a[184:187], a[208:211], v[228:231]
  v_mfma_f32_16x16x32_bf16 v[232:235], a[184:187], a[212:215], v[232:235]
  v_mfma_f32_16x16x32_bf16 v[236:239], a[184:187], a[216:219], v[236:239]
  v_mfma_f32_16x16x32_bf16 v[240:243], a[184:187], a[220:223], v[240:243]
  s_sub_u32 s35, s35, 1
  s_cmp_lg_u32 s35, 0
  s_cbranch_scc1 K2_LOOP
  s_waitcnt vmcnt(0)
  v_and_b32 v4, 15, v2
  v_lshrrev_b32 v5, 4, v2
  s_mul_i32 s26, s24, 144
  v_add_u32 v4, s26, v4
  s_movk_i32 s27, 2560
  v_mul_lo_u32 v4, v4, s27
  s_mul_i32 s26, s23, 1280
  s_mul_i32 s27, s25, 160
  s_add_u32 s26, s26, s27
  v_add_u32 v4, s26, v4
  v_lshlrev_b32 v6, 4, v5
  v_add_u32 v6, v4, v6
  v_lshlrev_b32 v7, 3, v5
  v_add_u32 v7, v4, v7
  v_add_u32 v7, 128, v7
  v_add_u32 v8, 0x10000, v3
  v_add_u32 v9, 0x20000, v3
  s_cmp_eq_u32 s20, 1
  s_cbranch_scc1 K2_W1
  s_cmp_eq_u32 s20, 2
  s_cbranch_scc1 K2_W2
  s_cmp_eq_u32 s20, 3
  s_cbranch_scc1 K2_W3
K2_W0:
  ds_write_b128 v3, v[84:87] offset:15360
  ds_write_b128 v3, v[88:91] offset:18432
  ds_write_b128 v3, v[92:95] offset:21504
  ds_write_b128 v3, v[96:99] offset:24576
  ds_write_b128 v3, v[120:123] offset:43008
  ds_write_b128 v3, v[124:127] offset:46080
  ds_write_b128 v3, v[128:131] offset:49152
  ds_write_b128 v3, v[132:135] offset:52224
  ds_write_b128 v3, v[136:139] offset:55296
  ds_write_b128 v3, v[140:143] offset:58368
  ds_write_b128 v3, v[144:147] offset:61440
  ds_write_b128 v3, v[148:151] offset:64512
  ds_write_b128 v8, v[152:155] offset:2048
  ds_write_b128 v8, v[156:159] offset:5120
  ds_write_b128 v8, v[160:163] offset:8192
  ds_write_b128 v8, v[164:167] offset:11264
  ds_write_b128 v8, v[168:171] offset:14336
  ds_write_b128 v8, v[172:175] offset:17408
  ds_write_b128 v8, v[176:179] offset:20480
  ds_write_b128 v8, v[180:183] offset:23552
  ds_write_b128 v8, v[184:187] offset:26624
  ds_write_b128 v8, v[188:191] offset:29696
  ds_write_b128 v8, v[192:195] offset:32768
  ds_write_b128 v8, v[196:199] offset:35840
  ds_write_b128 v8, v[200:203] offset:38912
  ds_write_b128 v8, v[204:207] offset:41984
  ds_write_b128 v8, v[212:215] offset:48128
  ds_write_b128 v8, v[216:219] offset:51200
  ds_write_b128 v8, v[220:223] offset:54272
  ds_write_b128 v8, v[224:227] offset:57344
  ds_write_b128 v8, v[228:231] offset:60416
  ds_write_b128 v8, v[232:235] offset:63488
  ds_write_b128 v9, v[236:239] offset:1024
  ds_write_b128 v9, v[240:243] offset:4096
  s_waitcnt lgkmcnt(0)
  s_barrier
  ds_read_b128 v[16:19], v3 offset:0
  ds_read_b128 v[20:23], v3 offset:1024
  ds_read_b128 v[24:27], v3 offset:2048
  ds_read_b128 v[28:31], v3 offset:27648
  ds_read_b128 v[32:35], v3 offset:28672
  ds_read_b128 v[36:39], v3 offset:29696
  ds_read_b128 v[40:43], v3 offset:3072
  ds_read_b128 v[44:47], v3 offset:4096
  ds_read_b128 v[48:51], v3 offset:5120
  ds_read_b128 v[52:55], v3 offset:30720
  ds_read_b128 v[56:59], v3 offset:31744
  ds_read_b128 v[60:63], v3 offset:32768
  s_waitcnt lgkmcnt(10)
  v_add_f32 v16, v16, v20
  s_waitcnt lgkmcnt(9)
  v_add_f32 v64, v64, v24
  v_add_f32 v17, v17, v21
  v_add_f32 v65, v65, v25
  v_add_f32 v18, v18, v22
  v_add_f32 v66, v66, v26
  v_add_f32 v19, v19, v23
  v_add_f32 v67, v67, v27
  v_add_f32 v64, v64, v16
  v_add_f32 v65, v65, v17
  v_add_f32 v66, v66, v18
  v_add_f32 v67, v67, v19
  s_waitcnt lgkmcnt(7)
  v_add_f32 v28, v28, v32
  s_waitcnt lgkmcnt(6)
  v_add_f32 v100, v100, v36
  v_add_f32 v29, v29, v33
  v_add_f32 v101, v101, v37
  v_add_f32 v30, v30, v34
  v_add_f32 v102, v102, v38
  v_add_f32 v31, v31, v35
  v_add_f32 v103, v103, v39
  v_add_f32 v100, v100, v28
  v_add_f32 v101, v101, v29
  v_add_f32 v102, v102, v30
  v_add_f32 v103, v103, v31
  v_cvt_pk_bf16_f32 v10, v64, v65
  v_cvt_pk_bf16_f32 v11, v66, v67
  v_cvt_pk_bf16_f32 v12, v100, v101
  v_cvt_pk_bf16_f32 v13, v102, v103
  s_mov_b32 s26, 0
  buffer_store_dwordx4 v[10:13], v6, s[16:19], s26 offen
  ds_read_b128 v[16:19], v3 offset:6144
  ds_read_b128 v[20:23], v3 offset:7168
  ds_read_b128 v[24:27], v3 offset:8192
  ds_read_b128 v[28:31], v3 offset:33792
  ds_read_b128 v[32:35], v3 offset:34816
  ds_read_b128 v[36:39], v3 offset:35840
  s_waitcnt lgkmcnt(10)
  v_add_f32 v40, v40, v44
  s_waitcnt lgkmcnt(9)
  v_add_f32 v68, v68, v48
  v_add_f32 v41, v41, v45
  v_add_f32 v69, v69, v49
  v_add_f32 v42, v42, v46
  v_add_f32 v70, v70, v50
  v_add_f32 v43, v43, v47
  v_add_f32 v71, v71, v51
  v_add_f32 v68, v68, v40
  v_add_f32 v69, v69, v41
  v_add_f32 v70, v70, v42
  v_add_f32 v71, v71, v43
  s_waitcnt lgkmcnt(7)
  v_add_f32 v52, v52, v56
  s_waitcnt lgkmcnt(6)
  v_add_f32 v104, v104, v60
  v_add_f32 v53, v53, v57
  v_add_f32 v105, v105, v61
  v_add_f32 v54, v54, v58
  v_add_f32 v106, v106, v62
  v_add_f32 v55, v55, v59
  v_add_f32 v107, v107, v63
  v_add_f32 v104, v104, v52
  v_add_f32 v105, v105, v53
  v_add_f32 v106, v106, v54
  v_add_f32 v107, v107, v55
  v_cvt_pk_bf16_f32 v10, v68, v69
  v_cvt_pk_bf16_f32 v11, v70, v71
  v_cvt_pk_bf16_f32 v12, v104, v105
  v_cvt_pk_bf16_f32 v13, v106, v107
  s_mov_b32 s26, 40960
  buffer_store_dwordx4 v[10:13], v6, s[16:19], s26 offen
  ds_read_b128 v[40:43], v3 offset:9216
  ds_read_b128 v[44:47], v3 offset:10240
  ds_read_b128 v[48:51], v3 offset:11264
  ds_read_b128 v[52:55], v3 offset:36864
  ds_read_b128 v[56:59], v3 offset:37888
  ds_read_b128 v[60:63], v3 offset:38912
  s_waitcnt lgkmcnt(10)
  v_add_f32 v16, v16, v20
  s_waitcnt lgkmcnt(9)
  v_add_f32 v72, v72, v24
  v_add_f32 v17, v17, v21
  v_add_f32 v73, v73, v25
  v_add_f32 v18, v18, v22
  v_add_f32 v74, v74, v26
  v_add_f32 v19, v19, v23
  v_add_f32 v75, v75, v27
  v_add_f32 v72, v72, v16
  v_add_f32 v73, v73, v17
  v_add_f32 v74, v74, v18
  v_add_f32 v75, v75, v19
  s_waitcnt lgkmcnt(7)
  v_add_f32 v28, v28, v32
  s_waitcnt lgkmcnt(6)
  v_add_f32 v108, v108, v36
  v_add_f32 v29, v29, v33
  v_add_f32 v109, v109, v37
  v_add_f32 v30, v30, v34
  v_add_f32 v110, v110, v38
  v_add_f32 v31, v31, v35
  v_add_f32 v111, v111, v39
  v_add_f32 v108, v108, v28
  v_add_f32 v109, v109, v29
  v_add_f32 v110, v110, v30
  v_add_f32 v111, v111, v31
  v_cvt_pk_bf16_f32 v10, v72, v73
  v_cvt_pk_bf16_f32 v11, v74, v75
  v_cvt_pk_bf16_f32 v12, v108, v109
  v_cvt_pk_bf16_f32 v13, v110, v111
  s_mov_b32 s26, 81920
  buffer_store_dwordx4 v[10:13], v6, s[16:19], s26 offen
  ds_read_b128 v[16:19], v3 offset:12288
  ds_read_b128 v[20:23], v3 offset:13312
  ds_read_b128 v[24:27], v3 offset:14336
  ds_read_b128 v[28:31], v3 offset:39936
  ds_read_b128 v[32:35], v3 offset:40960
  ds_read_b128 v[36:39], v3 offset:41984
  s_waitcnt lgkmcnt(10)
  v_add_f32 v40, v40, v44
  s_waitcnt lgkmcnt(9)
  v_add_f32 v76, v76, v48
  v_add_f32 v41, v41, v45
  v_add_f32 v77, v77, v49
  v_add_f32 v42, v42, v46
  v_add_f32 v78, v78, v50
  v_add_f32 v43, v43, v47
  v_add_f32 v79, v79, v51
  v_add_f32 v76, v76, v40
  v_add_f32 v77, v77, v41
  v_add_f32 v78, v78, v42
  v_add_f32 v79, v79, v43
  s_waitcnt lgkmcnt(7)
  v_add_f32 v52, v52, v56
  s_waitcnt lgkmcnt(6)
  v_add_f32 v112, v112, v60
  v_add_f32 v53, v53, v57
  v_add_f32 v113, v113, v61
  v_add_f32 v54, v54, v58
  v_add_f32 v114, v114, v62
  v_add_f32 v55, v55, v59
  v_add_f32 v115, v115, v63
  v_add_f32 v112, v112, v52
  v_add_f32 v113, v113, v53
  v_add_f32 v114, v114, v54
  v_add_f32 v115, v115, v55
  v_cvt_pk_bf16_f32 v10, v76, v77
  v_cvt_pk_bf16_f32 v11, v78, v79
  v_cvt_pk_bf16_f32 v12, v112, v113
  v_cvt_pk_bf16_f32 v13, v114, v115
  s_mov_b32 s26, 122880
  buffer_store_dwordx4 v[10:13], v6, s[16:19], s26 offen
  ds_read_b128 v[40:43], v8 offset:45056
  ds_read_b128 v[44:47], v8 offset:46080
  ds_read_b128 v[48:51], v8 offset:47104
  s_waitcnt lgkmcnt(7)
  v_add_f32 v16, v16, v20
  s_waitcnt lgkmcnt(6)
  v_add_f32 v80, v80, v24
  v_add_f32 v17, v17, v21
  v_add_f32 v81, v81, v25
  v_add_f32 v18, v18, v22
  v_add_f32 v82, v82, v26
  v_add_f32 v19, v19, v23
  v_add_f32 v83, v83, v27
  v_add_f32 v80, v80, v16
  v_add_f32 v81, v81, v17
  v_add_f32 v82, v82, v18
  v_add_f32 v83, v83, v19
  s_waitcnt lgkmcnt(4)
  v_add_f32 v28, v28, v32
  s_waitcnt lgkmcnt(3)
  v_add_f32 v116, v116, v36
  v_add_f32 v29, v29, v33
  v_add_f32 v117, v117, v37
  v_add_f32 v30, v30, v34
  v_add_f32 v118, v118, v38
  v_add_f32 v31, v31, v35
  v_add_f32 v119, v119, v39
  v_add_f32 v116, v116, v28
  v_add_f32 v117, v117, v29
  v_add_f32 v118, v118, v30
  v_add_f32 v119, v119, v31
  v_cvt_pk_bf16_f32 v10, v80, v81
  v_cvt_pk_bf16_f32 v11, v82, v83
  v_cvt_pk_bf16_f32 v12, v116, v117
  v_cvt_pk_bf16_f32 v13, v118, v119
  s_mov_b32 s26, 163840
  buffer_store_dwordx4 v[10:13], v6, s[16:19], s26 offen
  s_waitcnt lgkmcnt(1)
  v_add_f32 v40, v40, v44
  s_waitcnt lgkmcnt(0)
  v_add_f32 v208, v208, v48
  v_add_f32 v41, v41, v45
  v_add_f32 v209, v209, v49
  v_add_f32 v42, v42, v46
  v_add_f32 v210, v210, v50
  v_add_f32 v43, v43, v47
  v_add_f32 v211, v211, v51
  v_add_f32 v208, v208, v40
  v_add_f32 v209, v209, v41
  v_add_f32 v210, v210, v42
  v_add_f32 v211, v211, v43
  v_cvt_pk_bf16_f32 v14, v208, v209
  v_cvt_pk_bf16_f32 v15, v210, v211
  s_mov_b32 s26, 0
  buffer_store_dwordx2 v[14:15], v7, s[16:19], s26 offen
  s_endpgm
K2_W1:
  ds_write_b128 v3, v[64:67] offset:0
  ds_write_b128 v3, v[68:71] offset:3072
  ds_write_b128 v3, v[72:75] offset:6144
  ds_write_b128 v3, v[76:79] offset:9216
  ds_write_b128 v3, v[80:83] offset:12288
  ds_write_b128 v3, v[100:103] offset:27648
  ds_write_b128 v3, v[104:107] offset:30720
  ds_write_b128 v3, v[108:111] offset:33792
  ds_write_b128 v3, v[112:115] offset:36864
  ds_write_b128 v3, v[116:119] offset:39936
  ds_write_b128 v3, v[140:143] offset:59392
  ds_write_b128 v3, v[144:147] offset:62464
  ds_write_b128 v8, v[148:151] offset:0
  ds_write_b128 v8, v[152:155] offset:3072
  ds_write_b128 v8, v[156:159] offset:6144
  ds_write_b128 v8, v[160:163] offset:9216
  ds_write_b128 v8, v[164:167] offset:12288
  ds_write_b128 v8, v[168:171] offset:15360
  ds_write_b128 v8, v[176:179] offset:21504
  ds_write_b128 v8, v[180:183] offset:24576
  ds_write_b128 v8, v[184:187] offset:27648
  ds_write_b128 v8, v[188:191] offset:30720
  ds_write_b128 v8, v[192:195] offset:33792
  ds_write_b128 v8, v[196:199] offset:36864
  ds_write_b128 v8, v[200:203] offset:39936
  ds_write_b128 v8, v[204:207] offset:43008
  ds_write_b128 v8, v[208:211] offset:45056
  ds_write_b128 v8, v[216:219] offset:52224
  ds_write_b128 v8, v[220:223] offset:55296
  ds_write_b128 v8, v[224:227] offset:58368
  ds_write_b128 v8, v[228:231] offset:61440
  ds_write_b128 v8, v[232:235] offset:64512
  ds_write_b128 v9, v[236:239] offset:2048
  ds_write_b128 v9, v[240:243] offset:5120
  s_waitcnt lgkmcnt(0)
  s_barrier
  ds_read_b128 v[16:19], v3 offset:15360
  ds_read_b128 v[20:23], v3 offset:16384
  ds_read_b128 v[24:27], v3 offset:17408
  ds_read_b128 v[28:31], v3 offset:43008
  ds_read_b128 v[32:35], v3 offset:44032
  ds_read_b128 v[36:39], v3 offset:45056
  ds_read_b128 v[40:43], v3 offset:18432
  ds_read_b128 v[44:47], v3 offset:19456
  ds_read_b128 v[48:51], v3 offset:20480
  ds_read_b128 v[52:55], v3 offset:46080
  ds_read_b128 v[56:59], v3 offset:47104
  ds_read_b128 v[60:63], v3 offset:48128
  s_waitcnt lgkmcnt(10)
  v_add_f32 v16, v16, v20
  s_waitcnt lgkmcnt(9)
  v_add_f32 v84, v84, v24
  v_add_f32 v17, v17, v21
  v_add_f32 v85, v85, v25
  v_add_f32 v18, v18, v22
  v_add_f32 v86, v86, v26
  v_add_f32 v19, v19, v23
  v_add_f32 v87, v87, v27
  v_add_f32 v84, v84, v16
  v_add_f32 v85, v85, v17
  v_add_f32 v86, v86, v18
  v_add_f32 v87, v87, v19
  s_waitcnt lgkmcnt(7)
  v_add_f32 v28, v28, v32
  s_waitcnt lgkmcnt(6)
  v_add_f32 v120, v120, v36
  v_add_f32 v29, v29, v33
  v_add_f32 v121, v121, v37
  v_add_f32 v30, v30, v34
  v_add_f32 v122, v122, v38
  v_add_f32 v31, v31, v35
  v_add_f32 v123, v123, v39
  v_add_f32 v120, v120, v28
  v_add_f32 v121, v121, v29
  v_add_f32 v122, v122, v30
  v_add_f32 v123, v123, v31
  v_cvt_pk_bf16_f32 v10, v84, v85
  v_cvt_pk_bf16_f32 v11, v86, v87
  v_cvt_pk_bf16_f32 v12, v120, v121
  v_cvt_pk_bf16_f32 v13, v122, v123
  s_mov_b32 s26, 204800
  buffer_store_dwordx4 v[10:13], v6, s[16:19], s26 offen
  ds_read_b128 v[16:19], v3 offset:21504
  ds_read_b128 v[20:23], v3 offset:22528
  ds_read_b128 v[24:27], v3 offset:23552
  ds_read_b128 v[28:31], v3 offset:49152
  ds_read_b128 v[32:35], v3 offset:50176
  ds_read_b128 v[36:39], v3 offset:51200
  s_waitcnt lgkmcnt(10)
  v_add_f32 v40, v40, v44
  s_waitcnt lgkmcnt(9)
  v_add_f32 v88, v88, v48
  v_add_f32 v41, v41, v45
  v_add_f32 v89, v89, v49
  v_add_f32 v42, v42, v46
  v_add_f32 v90, v90, v50
  v_add_f32 v43, v43, v47
  v_add_f32 v91, v91, v51
  v_add_f32 v88, v88, v40
  v_add_f32 v89, v89, v41
  v_add_f32 v90, v90, v42
  v_add_f32 v91, v91, v43
  s_waitcnt lgkmcnt(7)
  v_add_f32 v52, v52, v56
  s_waitcnt lgkmcnt(6)
  v_add_f32 v124, v124, v60
  v_add_f32 v53, v53, v57
  v_add_f32 v125, v125, v61
  v_add_f32 v54, v54, v58
  v_add_f32 v126, v126, v62
  v_add_f32 v55, v55, v59
  v_add_f32 v127, v127, v63
  v_add_f32 v124, v124, v52
  v_add_f32 v125, v125, v53
  v_add_f32 v126, v126, v54
  v_add_f32 v127, v127, v55
  v_cvt_pk_bf16_f32 v10, v88, v89
  v_cvt_pk_bf16_f32 v11, v90, v91
  v_cvt_pk_bf16_f32 v12, v124, v125
  v_cvt_pk_bf16_f32 v13, v126, v127
  s_mov_b32 s26, 245760
  buffer_store_dwordx4 v[10:13], v6, s[16:19], s26 offen
  ds_read_b128 v[40:43], v3 offset:24576
  ds_read_b128 v[44:47], v3 offset:25600
  ds_read_b128 v[48:51], v3 offset:26624
  ds_read_b128 v[52:55], v3 offset:52224
  ds_read_b128 v[56:59], v3 offset:53248
  ds_read_b128 v[60:63], v3 offset:54272
  s_waitcnt lgkmcnt(10)
  v_add_f32 v16, v16, v20
  s_waitcnt lgkmcnt(9)
  v_add_f32 v92, v92, v24
  v_add_f32 v17, v17, v21
  v_add_f32 v93, v93, v25
  v_add_f32 v18, v18, v22
  v_add_f32 v94, v94, v26
  v_add_f32 v19, v19, v23
  v_add_f32 v95, v95, v27
  v_add_f32 v92, v92, v16
  v_add_f32 v93, v93, v17
  v_add_f32 v94, v94, v18
  v_add_f32 v95, v95, v19
  s_waitcnt lgkmcnt(7)
  v_add_f32 v28, v28, v32
  s_waitcnt lgkmcnt(6)
  v_add_f32 v128, v128, v36
  v_add_f32 v29, v29, v33
  v_add_f32 v129, v129, v37
  v_add_f32 v30, v30, v34
  v_add_f32 v130, v130, v38
  v_add_f32 v31, v31, v35
  v_add_f32 v131, v131, v39
  v_add_f32 v128, v128, v28
  v_add_f32 v129, v129, v29
  v_add_f32 v130, v130, v30
  v_add_f32 v131, v131, v31
  v_cvt_pk_bf16_f32 v10, v92, v93
  v_cvt_pk_bf16_f32 v11, v94, v95
  v_cvt_pk_bf16_f32 v12, v128, v129
  v_cvt_pk_bf16_f32 v13, v130, v131
  s_mov_b32 s26, 286720
  buffer_store_dwordx4 v[10:13], v6, s[16:19], s26 offen
  ds_read_b128 v[16:19], v3 offset:55296
  ds_read_b128 v[20:23], v3 offset:56320
  ds_read_b128 v[24:27], v3 offset:57344
  ds_read_b128 v[28:31], v8 offset:17408
  ds_read_b128 v[32:35], v8 offset:18432
  ds_read_b128 v[36:39], v8 offset:19456
  s_waitcnt lgkmcnt(10)
  v_add_f32 v40, v40, v44
  s_waitcnt lgkmcnt(9)
  v_add_f32 v96, v96, v48
  v_add_f32 v41, v41, v45
  v_add_f32 v97, v97, v49
  v_add_f32 v42, v42, v46
  v_add_f32 v98, v98, v50
  v_add_f32 v43, v43, v47
  v_add_f32 v99, v99, v51
  v_add_f32 v96, v96, v40
  v_add_f32 v97, v97, v41
  v_add_f32 v98, v98, v42
  v_add_f32 v99, v99, v43
  s_waitcnt lgkmcnt(7)
  v_add_f32 v52, v52, v56
  s_waitcnt lgkmcnt(6)
  v_add_f32 v132, v132, v60
  v_add_f32 v53, v53, v57
  v_add_f32 v133, v133, v61
  v_add_f32 v54, v54, v58
  v_add_f32 v134, v134, v62
  v_add_f32 v55, v55, v59
  v_add_f32 v135, v135, v63
  v_add_f32 v132, v132, v52
  v_add_f32 v133, v133, v53
  v_add_f32 v134, v134, v54
  v_add_f32 v135, v135, v55
  v_cvt_pk_bf16_f32 v10, v96, v97
  v_cvt_pk_bf16_f32 v11, v98, v99
  v_cvt_pk_bf16_f32 v12, v132, v133
  v_cvt_pk_bf16_f32 v13, v134, v135
  s_mov_b32 s26, 327680
  buffer_store_dwordx4 v[10:13], v6, s[16:19], s26 offen
  ds_read_b128 v[40:43], v8 offset:48128
  ds_read_b128 v[44:47], v8 offset:49152
  ds_read_b128 v[48:51], v8 offset:50176
  s_waitcnt lgkmcnt(7)
  v_add_f32 v16, v16, v20
  s_waitcnt lgkmcnt(6)
  v_add_f32 v136, v136, v24
  v_add_f32 v17, v17, v21
  v_add_f32 v137, v137, v25
  v_add_f32 v18, v18, v22
  v_add_f32 v138, v138, v26
  v_add_f32 v19, v19, v23
  v_add_f32 v139, v139, v27
  v_add_f32 v136, v136, v16
  v_add_f32 v137, v137, v17
  v_add_f32 v138, v138, v18
  v_add_f32 v139, v139, v19
  s_waitcnt lgkmcnt(4)
  v_add_f32 v28, v28, v32
  s_waitcnt lgkmcnt(3)
  v_add_f32 v172, v172, v36
  v_add_f32 v29, v29, v33
  v_add_f32 v173, v173, v37
  v_add_f32 v30, v30, v34
  v_add_f32 v174, v174, v38
  v_add_f32 v31, v31, v35
  v_add_f32 v175, v175, v39
  v_add_f32 v172, v172, v28
  v_add_f32 v173, v173, v29
  v_add_f32 v174, v174, v30
  v_add_f32 v175, v175, v31
  v_cvt_pk_bf16_f32 v10, v136, v137
  v_cvt_pk_bf16_f32 v11, v138, v139
  v_cvt_pk_bf16_f32 v12, v172, v173
  v_cvt_pk_bf16_f32 v13, v174, v175
  s_mov_b32 s26, 64
  buffer_store_dwordx4 v[10:13], v6, s[16:19], s26 offen
  s_waitcnt lgkmcnt(1)
  v_add_f32 v40, v40, v44
  s_waitcnt lgkmcnt(0)
  v_add_f32 v212, v212, v48
  v_add_f32 v41, v41, v45
  v_add_f32 v213, v213, v49
  v_add_f32 v42, v42, v46
  v_add_f32 v214, v214, v50
  v_add_f32 v43, v43, v47
  v_add_f32 v215, v215, v51
  v_add_f32 v212, v212, v40
  v_add_f32 v213, v213, v41
  v_add_f32 v214, v214, v42
  v_add_f32 v215, v215, v43
  v_cvt_pk_bf16_f32 v14, v212, v213
  v_cvt_pk_bf16_f32 v15, v214, v215
  s_mov_b32 s26, 40960
  buffer_store_dwordx2 v[14:15], v7, s[16:19], s26 offen
  s_endpgm
K2_W2:
  ds_write_b128 v3, v[64:67] offset:1024
  ds_write_b128 v3, v[68:71] offset:4096
  ds_write_b128 v3, v[72:75] offset:7168
  ds_write_b128 v3, v[76:79] offset:10240
  ds_write_b128 v3, v[80:83] offset:13312
  ds_write_b128 v3, v[84:87] offset:16384
  ds_write_b128 v3, v[88:91] offset:19456
  ds_write_b128 v3, v[92:95] offset:22528
  ds_write_b128 v3, v[96:99] offset:25600
  ds_write_b128 v3, v[100:103] offset:28672
  ds_write_b128 v3, v[104:107] offset:31744
  ds_write_b128 v3, v[108:111] offset:34816
  ds_write_b128 v3, v[112:115] offset:37888
  ds_write_b128 v3, v[116:119] offset:40960
  ds_write_b128 v3, v[120:123] offset:44032
  ds_write_b128 v3, v[124:127] offset:47104
  ds_write_b128 v3, v[128:131] offset:50176
  ds_write_b128 v3, v[132:135] offset:53248
  ds_write_b128 v3, v[136:139] offset:56320
  ds_write_b128 v8, v[156:159] offset:7168
  ds_write_b128 v8, v[160:163] offset:10240
  ds_write_b128 v8, v[164:167] offset:13312
  ds_write_b128 v8, v[168:171] offset:16384
  ds_write_b128 v8, v[172:175] offset:18432
  ds_write_b128 v8, v[192:195] offset:34816
  ds_write_b128 v8, v[196:199] offset:37888
  ds_write_b128 v8, v[200:203] offset:40960
  ds_write_b128 v8, v[204:207] offset:44032
  ds_write_b128 v8, v[208:211] offset:46080
  ds_write_b128 v8, v[212:215] offset:49152
  ds_write_b128 v8, v[228:231] offset:62464
  ds_write_b128 v9, v[232:235] offset:0
  ds_write_b128 v9, v[236:239] offset:3072
  ds_write_b128 v9, v[240:243] offset:6144
  s_waitcnt lgkmcnt(0)
  s_barrier
  ds_read_b128 v[16:19], v3 offset:58368
  ds_read_b128 v[20:23], v3 offset:59392
  ds_read_b128 v[24:27], v3 offset:60416
  ds_read_b128 v[28:31], v8 offset:20480
  ds_read_b128 v[32:35], v8 offset:21504
  ds_read_b128 v[36:39], v8 offset:22528
  ds_read_b128 v[40:43], v3 offset:61440
  ds_read_b128 v[44:47], v3 offset:62464
  ds_read_b128 v[48:51], v3 offset:63488
  ds_read_b128 v[52:55], v8 offset:23552
  ds_read_b128 v[56:59], v8 offset:24576
  ds_read_b128 v[60:63], v8 offset:25600
  s_waitcnt lgkmcnt(10)
  v_add_f32 v16, v16, v20
  s_waitcnt lgkmcnt(9)
  v_add_f32 v140, v140, v24
  v_add_f32 v17, v17, v21
  v_add_f32 v141, v141, v25
  v_add_f32 v18, v18, v22
  v_add_f32 v142, v142, v26
  v_add_f32 v19, v19, v23
  v_add_f32 v143, v143, v27
  v_add_f32 v140, v140, v16
  v_add_f32 v141, v141, v17
  v_add_f32 v142, v142, v18
  v_add_f32 v143, v143, v19
  s_waitcnt lgkmcnt(7)
  v_add_f32 v28, v28, v32
  s_waitcnt lgkmcnt(6)
  v_add_f32 v176, v176, v36
  v_add_f32 v29, v29, v33
  v_add_f32 v177, v177, v37
  v_add_f32 v30, v30, v34
  v_add_f32 v178, v178, v38
  v_add_f32 v31, v31, v35
  v_add_f32 v179, v179, v39
  v_add_f32 v176, v176, v28
  v_add_f32 v177, v177, v29
  v_add_f32 v178, v178, v30
  v_add_f32 v179, v179, v31
  v_cvt_pk_bf16_f32 v10, v140, v141
  v_cvt_pk_bf16_f32 v11, v142, v143
  v_cvt_pk_bf16_f32 v12, v176, v177
  v_cvt_pk_bf16_f32 v13, v178, v179
  s_mov_b32 s26, 41024
  buffer_store_dwordx4 v[10:13], v6, s[16:19], s26 offen
  ds_read_b128 v[16:19], v3 offset:64512
  ds_read_b128 v[20:23], v8 offset:0
  ds_read_b128 v[24:27], v8 offset:1024
  ds_read_b128 v[28:31], v8 offset:26624
  ds_read_b128 v[32:35], v8 offset:27648
  ds_read_b128 v[36:39], v8 offset:28672
  s_waitcnt lgkmcnt(10)
  v_add_f32 v40, v40, v44
  s_waitcnt lgkmcnt(9)
  v_add_f32 v144, v144, v48
  v_add_f32 v41, v41, v45
  v_add_f32 v145, v145, v49
  v_add_f32 v42, v42, v46
  v_add_f32 v146, v146, v50
  v_add_f32 v43, v43, v47
  v_add_f32 v147, v147, v51
  v_add_f32 v144, v144, v40
  v_add_f32 v145, v145, v41
  v_add_f32 v146, v146, v42
  v_add_f32 v147, v147, v43
  s_waitcnt lgkmcnt(7)
  v_add_f32 v52, v52, v56
  s_waitcnt lgkmcnt(6)
  v_add_f32 v180, v180, v60
  v_add_f32 v53, v53, v57
  v_add_f32 v181, v181, v61
  v_add_f32 v54, v54, v58
  v_add_f32 v182, v182, v62
  v_add_f32 v55, v55, v59
  v_add_f32 v183, v183, v63
  v_add_f32 v180, v180, v52
  v_add_f32 v181, v181, v53
  v_add_f32 v182, v182, v54
  v_add_f32 v183, v183, v55
  v_cvt_pk_bf16_f32 v10, v144, v145
  v_cvt_pk_bf16_f32 v11, v146, v147
  v_cvt_pk_bf16_f32 v12, v180, v181
  v_cvt_pk_bf16_f32 v13, v182, v183
  s_mov_b32 s26, 81984
  buffer_store_dwordx4 v[10:13], v6, s[16:19], s26 offen
  ds_read_b128 v[40:43], v8 offset:2048
  ds_read_b128 v[44:47], v8 offset:3072
  ds_read_b128 v[48:51], v8 offset:4096
  ds_read_b128 v[52:55], v8 offset:29696
  ds_read_b128 v[56:59], v8 offset:30720
  ds_read_b128 v[60:63], v8 offset:31744
  s_waitcnt lgkmcnt(10)
  v_add_f32 v16, v16, v20
  s_waitcnt lgkmcnt(9)
  v_add_f32 v148, v148, v24
  v_add_f32 v17, v17, v21
  v_add_f32 v149, v149, v25
  v_add_f32 v18, v18, v22
  v_add_f32 v150, v150, v26
  v_add_f32 v19, v19, v23
  v_add_f32 v151, v151, v27
  v_add_f32 v148, v148, v16
  v_add_f32 v149, v149, v17
  v_add_f32 v150, v150, v18
  v_add_f32 v151, v151, v19
  s_waitcnt lgkmcnt(7)
  v_add_f32 v28, v28, v32
  s_waitcnt lgkmcnt(6)
  v_add_f32 v184, v184, v36
  v_add_f32 v29, v29, v33
  v_add_f32 v185, v185, v37
  v_add_f32 v30, v30, v34
  v_add_f32 v186, v186, v38
  v_add_f32 v31, v31, v35
  v_add_f32 v187, v187, v39
  v_add_f32 v184, v184, v28
  v_add_f32 v185, v185, v29
  v_add_f32 v186, v186, v30
  v_add_f32 v187, v187, v31
  v_cvt_pk_bf16_f32 v10, v148, v149
  v_cvt_pk_bf16_f32 v11, v150, v151
  v_cvt_pk_bf16_f32 v12, v184, v185
  v_cvt_pk_bf16_f32 v13, v186, v187
  s_mov_b32 s26, 122944
  buffer_store_dwordx4 v[10:13], v6, s[16:19], s26 offen
  ds_read_b128 v[16:19], v8 offset:51200
  ds_read_b128 v[20:23], v8 offset:52224
  ds_read_b128 v[24:27], v8 offset:53248
  s_waitcnt lgkmcnt(7)
  v_add_f32 v40, v40, v44
  s_waitcnt lgkmcnt(6)
  v_add_f32 v152, v152, v48
  v_add_f32 v41, v41, v45
  v_add_f32 v153, v153, v49
  v_add_f32 v42, v42, v46
  v_add_f32 v154, v154, v50
  v_add_f32 v43, v43, v47
  v_add_f32 v155, v155, v51
  v_add_f32 v152, v152, v40
  v_add_f32 v153, v153, v41
  v_add_f32 v154, v154, v42
  v_add_f32 v155, v155, v43
  s_waitcnt lgkmcnt(4)
  v_add_f32 v52, v52, v56
  s_waitcnt lgkmcnt(3)
  v_add_f32 v188, v188, v60
  v_add_f32 v53, v53, v57
  v_add_f32 v189, v189, v61
  v_add_f32 v54, v54, v58
  v_add_f32 v190, v190, v62
  v_add_f32 v55, v55, v59
  v_add_f32 v191, v191, v63
  v_add_f32 v188, v188, v52
  v_add_f32 v189, v189, v53
  v_add_f32 v190, v190, v54
  v_add_f32 v191, v191, v55
  v_cvt_pk_bf16_f32 v10, v152, v153
  v_cvt_pk_bf16_f32 v11, v154, v155
  v_cvt_pk_bf16_f32 v12, v188, v189
  v_cvt_pk_bf16_f32 v13, v190, v191
  s_mov_b32 s26, 163904
  buffer_store_dwordx4 v[10:13], v6, s[16:19], s26 offen
  ds_read_b128 v[28:31], v8 offset:54272
  ds_read_b128 v[32:35], v8 offset:55296
  ds_read_b128 v[36:39], v8 offset:56320
  s_waitcnt lgkmcnt(4)
  v_add_f32 v16, v16, v20
  s_waitcnt lgkmcnt(3)
  v_add_f32 v216, v216, v24
  v_add_f32 v17, v17, v21
  v_add_f32 v217, v217, v25
  v_add_f32 v18, v18, v22
  v_add_f32 v218, v218, v26
  v_add_f32 v19, v19, v23
  v_add_f32 v219, v219, v27
  v_add_f32 v216, v216, v16
  v_add_f32 v217, v217, v17
  v_add_f32 v218, v218, v18
  v_add_f32 v219, v219, v19
  v_cvt_pk_bf16_f32 v14, v216, v217
  v_cvt_pk_bf16_f32 v15, v218, v219
  s_mov_b32 s26, 81920
  buffer_store_dwordx2 v[14:15], v7, s[16:19], s26 offen
  ds_read_b128 v[40:43], v8 offset:57344
  ds_read_b128 v[44:47], v8 offset:58368
  ds_read_b128 v[48:51], v8 offset:59392
  s_waitcnt lgkmcnt(4)
  v_add_f32 v28, v28, v32
  s_waitcnt lgkmcnt(3)
  v_add_f32 v220, v220, v36
  v_add_f32 v29, v29, v33
  v_add_f32 v221, v221, v37
  v_add_f32 v30, v30, v34
  v_add_f32 v222, v222, v38
  v_add_f32 v31, v31, v35
  v_add_f32 v223, v223, v39
  v_add_f32 v220, v220, v28
  v_add_f32 v221, v221, v29
  v_add_f32 v222, v222, v30
  v_add_f32 v223, v223, v31
  v_cvt_pk_bf16_f32 v14, v220, v221
  v_cvt_pk_bf16_f32 v15, v222, v223
  s_mov_b32 s26, 122880
  buffer_store_dwordx2 v[14:15], v7, s[16:19], s26 offen
  s_waitcnt lgkmcnt(1)
  v_add_f32 v40, v40, v44
  s_waitcnt lgkmcnt(0)
  v_add_f32 v224, v224, v48
  v_add_f32 v41, v41, v45
  v_add_f32 v225, v225, v49
  v_add_f32 v42, v42, v46
  v_add_f32 v226, v226, v50
  v_add_f32 v43, v43, v47
  v_add_f32 v227, v227, v51
  v_add_f32 v224, v224, v40
  v_add_f32 v225, v225, v41
  v_add_f32 v226, v226, v42
  v_add_f32 v227, v227, v43
  v_cvt_pk_bf16_f32 v14, v224, v225
  v_cvt_pk_bf16_f32 v15, v226, v227
  s_mov_b32 s26, 163840
  buffer_store_dwordx2 v[14:15], v7, s[16:19], s26 offen
  s_endpgm
K2_W3:
  ds_write_b128 v3, v[64:67] offset:2048
  ds_write_b128 v3, v[68:71] offset:5120
  ds_write_b128 v3, v[72:75] offset:8192
  ds_write_b128 v3, v[76:79] offset:11264
  ds_write_b128 v3, v[80:83] offset:14336
  ds_write_b128 v3, v[84:87] offset:17408
  ds_write_b128 v3, v[88:91] offset:20480
  ds_write_b128 v3, v[92:95] offset:23552
  ds_write_b128 v3, v[96:99] offset:26624
  ds_write_b128 v3, v[100:103] offset:29696
  ds_write_b128 v3, v[104:107] offset:32768
  ds_write_b128 v3, v[108:111] offset:35840
  ds_write_b128 v3, v[112:115] offset:38912
  ds_write_b128 v3, v[116:119] offset:41984
  ds_write_b128 v3, v[120:123] offset:45056
  ds_write_b128 v3, v[124:127] offset:48128
  ds_write_b128 v3, v[128:131] offset:51200
  ds_write_b128 v3, v[132:135] offset:54272
  ds_write_b128 v3, v[136:139] offset:57344
  ds_write_b128 v3, v[140:143] offset:60416
  ds_write_b128 v3, v[144:147] offset:63488
  ds_write_b128 v8, v[148:151] offset:1024
  ds_write_b128 v8, v[152:155] offset:4096
  ds_write_b128 v8, v[172:175] offset:19456
  ds_write_b128 v8, v[176:179] offset:22528
  ds_write_b128 v8, v[180:183] offset:25600
  ds_write_b128 v8, v[184:187] offset:28672
  ds_write_b128 v8, v[188:191] offset:31744
  ds_write_b128 v8, v[208:211] offset:47104
  ds_write_b128 v8, v[212:215] offset:50176
  ds_write_b128 v8, v[216:219] offset:53248
  ds_write_b128 v8, v[220:223] offset:56320
  ds_write_b128 v8, v[224:227] offset:59392
  s_waitcnt lgkmcnt(0)
  s_barrier
  ds_read_b128 v[16:19], v8 offset:5120
  ds_read_b128 v[20:23], v8 offset:6144
  ds_read_b128 v[24:27], v8 offset:7168
  ds_read_b128 v[28:31], v8 offset:32768
  ds_read_b128 v[32:35], v8 offset:33792
  ds_read_b128 v[36:39], v8 offset:34816
  ds_read_b128 v[40:43], v8 offset:8192
  ds_read_b128 v[44:47], v8 offset:9216
  ds_read_b128 v[48:51], v8 offset:10240
  ds_read_b128 v[52:55], v8 offset:35840
  ds_read_b128 v[56:59], v8 offset:36864
  ds_read_b128 v[60:63], v8 offset:37888
  s_waitcnt lgkmcnt(10)
  v_add_f32 v16, v16, v20
  s_waitcnt lgkmcnt(9)
  v_add_f32 v156, v156, v24
  v_add_f32 v17, v17, v21
  v_add_f32 v157, v157, v25
  v_add_f32 v18, v18, v22
  v_add_f32 v158, v158, v26
  v_add_f32 v19, v19, v23
  v_add_f32 v159, v159, v27
  v_add_f32 v156, v156, v16
  v_add_f32 v157, v157, v17
  v_add_f32 v158, v158, v18
  v_add_f32 v159, v159, v19
  s_waitcnt lgkmcnt(7)
  v_add_f32 v28, v28, v32
  s_waitcnt lgkmcnt(6)
  v_add_f32 v192, v192, v36
  v_add_f32 v29, v29, v33
  v_add_f32 v193, v193, v37
  v_add_f32 v30, v30, v34
  v_add_f32 v194, v194, v38
  v_add_f32 v31, v31, v35
  v_add_f32 v195, v195, v39
  v_add_f32 v192, v192, v28
  v_add_f32 v193, v193, v29
  v_add_f32 v194, v194, v30
  v_add_f32 v195, v195, v31
  v_cvt_pk_bf16_f32 v10, v156, v157
  v_cvt_pk_bf16_f32 v11, v158, v159
  v_cvt_pk_bf16_f32 v12, v192, v193
  v_cvt_pk_bf16_f32 v13, v194, v195
  s_mov_b32 s26, 204864
  buffer_store_dwordx4 v[10:13], v6, s[16:19], s26 offen
  ds_read_b128 v[16:19], v8 offset:11264
  ds_read_b128 v[20:23], v8 offset:12288
  ds_read_b128 v[24:27], v8 offset:13312
  ds_read_b128 v[28:31], v8 offset:38912
  ds_read_b128 v[32:35], v8 offset:39936
  ds_read_b128 v[36:39], v8 offset:40960
  s_waitcnt lgkmcnt(10)
  v_add_f32 v40, v40, v44
  s_waitcnt lgkmcnt(9)
  v_add_f32 v160, v160, v48
  v_add_f32 v41, v41, v45
  v_add_f32 v161, v161, v49
  v_add_f32 v42, v42, v46
  v_add_f32 v162, v162, v50
  v_add_f32 v43, v43, v47
  v_add_f32 v163, v163, v51
  v_add_f32 v160, v160, v40
  v_add_f32 v161, v161, v41
  v_add_f32 v162, v162, v42
  v_add_f32 v163, v163, v43
  s_waitcnt lgkmcnt(7)
  v_add_f32 v52, v52, v56
  s_waitcnt lgkmcnt(6)
  v_add_f32 v196, v196, v60
  v_add_f32 v53, v53, v57
  v_add_f32 v197, v197, v61
  v_add_f32 v54, v54, v58
  v_add_f32 v198, v198, v62
  v_add_f32 v55, v55, v59
  v_add_f32 v199, v199, v63
  v_add_f32 v196, v196, v52
  v_add_f32 v197, v197, v53
  v_add_f32 v198, v198, v54
  v_add_f32 v199, v199, v55
  v_cvt_pk_bf16_f32 v10, v160, v161
  v_cvt_pk_bf16_f32 v11, v162, v163
  v_cvt_pk_bf16_f32 v12, v196, v197
  v_cvt_pk_bf16_f32 v13, v198, v199
  s_mov_b32 s26, 245824
  buffer_store_dwordx4 v[10:13], v6, s[16:19], s26 offen
  ds_read_b128 v[40:43], v8 offset:14336
  ds_read_b128 v[44:47], v8 offset:15360
  ds_read_b128 v[48:51], v8 offset:16384
  ds_read_b128 v[52:55], v8 offset:41984
  ds_read_b128 v[56:59], v8 offset:43008
  ds_read_b128 v[60:63], v8 offset:44032
  s_waitcnt lgkmcnt(10)
  v_add_f32 v16, v16, v20
  s_waitcnt lgkmcnt(9)
  v_add_f32 v164, v164, v24
  v_add_f32 v17, v17, v21
  v_add_f32 v165, v165, v25
  v_add_f32 v18, v18, v22
  v_add_f32 v166, v166, v26
  v_add_f32 v19, v19, v23
  v_add_f32 v167, v167, v27
  v_add_f32 v164, v164, v16
  v_add_f32 v165, v165, v17
  v_add_f32 v166, v166, v18
  v_add_f32 v167, v167, v19
  s_waitcnt lgkmcnt(7)
  v_add_f32 v28, v28, v32
  s_waitcnt lgkmcnt(6)
  v_add_f32 v200, v200, v36
  v_add_f32 v29, v29, v33
  v_add_f32 v201, v201, v37
  v_add_f32 v30, v30, v34
  v_add_f32 v202, v202, v38
  v_add_f32 v31, v31, v35
  v_add_f32 v203, v203, v39
  v_add_f32 v200, v200, v28
  v_add_f32 v201, v201, v29
  v_add_f32 v202, v202, v30
  v_add_f32 v203, v203, v31
  v_cvt_pk_bf16_f32 v10, v164, v165
  v_cvt_pk_bf16_f32 v11, v166, v167
  v_cvt_pk_bf16_f32 v12, v200, v201
  v_cvt_pk_bf16_f32 v13, v202, v203
  s_mov_b32 s26, 286784
  buffer_store_dwordx4 v[10:13], v6, s[16:19], s26 offen
  ds_read_b128 v[16:19], v8 offset:60416
  ds_read_b128 v[20:23], v8 offset:61440
  ds_read_b128 v[24:27], v8 offset:62464
  s_waitcnt lgkmcnt(7)
  v_add_f32 v40, v40, v44
  s_waitcnt lgkmcnt(6)
  v_add_f32 v168, v168, v48
  v_add_f32 v41, v41, v45
  v_add_f32 v169, v169, v49
  v_add_f32 v42, v42, v46
  v_add_f32 v170, v170, v50
  v_add_f32 v43, v43, v47
  v_add_f32 v171, v171, v51
  v_add_f32 v168, v168, v40
  v_add_f32 v169, v169, v41
  v_add_f32 v170, v170, v42
  v_add_f32 v171, v171, v43
  s_waitcnt lgkmcnt(4)
  v_add_f32 v52, v52, v56
  s_waitcnt lgkmcnt(3)
  v_add_f32 v204, v204, v60
  v_add_f32 v53, v53, v57
  v_add_f32 v205, v205, v61
  v_add_f32 v54, v54, v58
  v_add_f32 v206, v206, v62
  v_add_f32 v55, v55, v59
  v_add_f32 v207, v207, v63
  v_add_f32 v204, v204, v52
  v_add_f32 v205, v205, v53
  v_add_f32 v206, v206, v54
  v_add_f32 v207, v207, v55
  v_cvt_pk_bf16_f32 v10, v168, v169
  v_cvt_pk_bf16_f32 v11, v170, v171
  v_cvt_pk_bf16_f32 v12, v204, v205
  v_cvt_pk_bf16_f32 v13, v206, v207
  s_mov_b32 s26, 327744
  buffer_store_dwordx4 v[10:13], v6, s[16:19], s26 offen
  ds_read_b128 v[28:31], v8 offset:63488
  ds_read_b128 v[32:35], v8 offset:64512
  ds_read_b128 v[36:39], v9 offset:0
  s_waitcnt lgkmcnt(4)
  v_add_f32 v16, v16, v20
  s_waitcnt lgkmcnt(3)
  v_add_f32 v228, v228, v24
  v_add_f32 v17, v17, v21
  v_add_f32 v229, v229, v25
  v_add_f32 v18, v18, v22
  v_add_f32 v230, v230, v26
  v_add_f32 v19, v19, v23
  v_add_f32 v231, v231, v27
  v_add_f32 v228, v228, v16
  v_add_f32 v229, v229, v17
  v_add_f32 v230, v230, v18
  v_add_f32 v231, v231, v19
  v_cvt_pk_bf16_f32 v14, v228, v229
  v_cvt_pk_bf16_f32 v15, v230, v231
  s_mov_b32 s26, 204800
  buffer_store_dwordx2 v[14:15], v7, s[16:19], s26 offen
  ds_read_b128 v[40:43], v9 offset:1024
  ds_read_b128 v[44:47], v9 offset:2048
  ds_read_b128 v[48:51], v9 offset:3072
  s_waitcnt lgkmcnt(4)
  v_add_f32 v28, v28, v32
  s_waitcnt lgkmcnt(3)
  v_add_f32 v232, v232, v36
  v_add_f32 v29, v29, v33
  v_add_f32 v233, v233, v37
  v_add_f32 v30, v30, v34
  v_add_f32 v234, v234, v38
  v_add_f32 v31, v31, v35
  v_add_f32 v235, v235, v39
  v_add_f32 v232, v232, v28
  v_add_f32 v233, v233, v29
  v_add_f32 v234, v234, v30
  v_add_f32 v235, v235, v31
  v_cvt_pk_bf16_f32 v14, v232, v233
  v_cvt_pk_bf16_f32 v15, v234, v235
  s_mov_b32 s26, 245760
  buffer_store_dwordx2 v[14:15], v7, s[16:19], s26 offen
  ds_read_b128 v[52:55], v9 offset:4096
  ds_read_b128 v[56:59], v9 offset:5120
  ds_read_b128 v[60:63], v9 offset:6144
  s_waitcnt lgkmcnt(4)
  v_add_f32 v40, v40, v44
  s_waitcnt lgkmcnt(3)
  v_add_f32 v236, v236, v48
  v_add_f32 v41, v41, v45
  v_add_f32 v237, v237, v49
  v_add_f32 v42, v42, v46
  v_add_f32 v238, v238, v50
  v_add_f32 v43, v43, v47
  v_add_f32 v239, v239, v51
  v_add_f32 v236, v236, v40
  v_add_f32 v237, v237, v41
  v_add_f32 v238, v238, v42
  v_add_f32 v239, v239, v43
  v_cvt_pk_bf16_f32 v14, v236, v237
  v_cvt_pk_bf16_f32 v15, v238, v239
  s_mov_b32 s26, 286720
  buffer_store_dwordx2 v[14:15], v7, s[16:19], s26 offen
  s_waitcnt lgkmcnt(1)
  v_add_f32 v52, v52, v56
  s_waitcnt lgkmcnt(0)
  v_add_f32 v240, v240, v60
  v_add_f32 v53, v53, v57
  v_add_f32 v241, v241, v61
  v_add_f32 v54, v54, v58
  v_add_f32 v242, v242, v62
  v_add_f32 v55, v55, v59
  v_add_f32 v243, v243, v63
  v_add_f32 v240, v240, v52
  v_add_f32 v241, v241, v53
  v_add_f32 v242, v242, v54
  v_add_f32 v243, v243, v55
  v_cvt_pk_bf16_f32 v14, v240, v241
  v_cvt_pk_bf16_f32 v15, v242, v243
  s_mov_b32 s26, 327680
  buffer_store_dwordx2 v[14:15], v7, s[16:19], s26 offen
  s_endpgm
K2_DONE:
  s_endpgm
CODE_END:
.section .rodata,"a"
.p2align 6
.amdhsa_kernel attn_kernel
  .amdhsa_next_free_vgpr 512
  .amdhsa_next_free_sgpr 102
  .amdhsa_accum_offset 256
  .amdhsa_group_segment_fixed_size 0
  .amdhsa_kernarg_size 104
  .amdhsa_user_sgpr_count 2
  .amdhsa_user_sgpr_kernarg_segment_ptr 1
  .amdhsa_system_sgpr_workgroup_id_x 1
.end_amdhsa_kernel
.p2align 6
.amdhsa_kernel oproj_kernel
  .amdhsa_next_free_vgpr 512
  .amdhsa_next_free_sgpr 64
  .amdhsa_accum_offset 256
  .amdhsa_group_segment_fixed_size 0
  .amdhsa_kernarg_size 104
  .amdhsa_user_sgpr_count 2
  .amdhsa_user_sgpr_kernarg_segment_ptr 1
  .amdhsa_system_sgpr_workgroup_id_x 1
.end_amdhsa_kernel
```
